```python
import torch

def _softmax(x, axis=-1):
    return torch.softmax(x, dim=axis)

def _gelu(x):
    return torch.nn.functional.gelu(x, approximate='tanh')

def _silu(x):
    return torch.nn.functional.silu(x)

def _sigmoid(x):
    return torch.sigmoid(x)

def _layernorm(x, axis=-1, eps=1e-05):
    m = x.mean(dim=axis, keepdim=True)
    v = x.var(dim=axis, keepdim=True, unbiased=False)
    return (x - m) / torch.sqrt(v + eps)

def _scatter_add(tgt, idx, src, axis=0):
    return tgt.clone().index_add_(axis, idx, src)

def _segment_sum(src, seg, n):
    out = torch.zeros((n,) + src.shape[1:], dtype=src.dtype)
    return out.index_add_(0, seg, src)

def _pad(x, pw):
    flat = tuple((v for pair in reversed(pw) for v in pair))
    return torch.nn.functional.pad(x, flat)
kernel_name = 'concat_heads__memory_aug_recurrent_mem_tr__ssm_conv_s4__prompt'

def setup_inputs():

    _w = lambda a: (lambda t: t.to(torch.bfloat16) if t.is_floating_point() else t)(torch.as_tensor(a))

    def _A_setup():
        B, S, Dm = (1, 2048, 640)
        H, Dh = (32, 128)
        M, seg = (8, 32)
        seg = min(seg, S)
        S = S // seg * seg
        return {'x': _w((lambda *s: torch.randn(*s, dtype=torch.bfloat16) * 0.05)(B, S, Dm)), 'mem0': _w((lambda *s: torch.randn(*s, dtype=torch.bfloat16) * 0.4)(B, M, Dm)), 'Wq': _w((lambda *s: torch.randn(*s, dtype=torch.bfloat16) * 6.4)(Dm, H, Dh) * Dm ** (-0.5)), 'Wk': _w((lambda *s: torch.randn(*s, dtype=torch.bfloat16) * 6.4)(Dm, H, Dh) * Dm ** (-0.5)), 'Wv': _w((lambda *s: torch.randn(*s, dtype=torch.bfloat16) * 0.4)(Dm, H, Dh) * Dm ** (-0.5)), 'Wo': _w((lambda *s: torch.randn(*s, dtype=torch.bfloat16) * 0.4)(H, Dh, Dm) * (H * Dh) ** (-0.5)), 'seg_len': seg}
    _A_in = _A_setup()

    def _B_setup():
        B, L, D, N = (1, 2048, 640, 128)
        A_re = -(lambda _x: torch.exp(torch.as_tensor(_x)))((lambda *s: torch.randn(*s, dtype=torch.bfloat16) * 6.4)(D, N))
        A_im = torch.pi * (lambda *s: torch.randn(*s, dtype=torch.bfloat16) * 0.05)(D, N)
        B_re = (lambda *s: torch.randn(*s, dtype=torch.bfloat16) * 0.1)(D, N)
        B_im = (lambda *s: torch.randn(*s, dtype=torch.bfloat16) * 0.1)(D, N)
        C_re = (lambda *s: torch.randn(*s, dtype=torch.bfloat16) * 0.1)(D, N)
        C_im = (lambda *s: torch.randn(*s, dtype=torch.bfloat16) * 0.1)(D, N)
        log_dt = (lambda *s: torch.randn(*s, dtype=torch.bfloat16) * 0.05)(D) * 0.5 - 4.0
        Dskip = (lambda *s: torch.randn(*s, dtype=torch.bfloat16) * 0.05)(D)
        return {'u': _w((lambda *s: torch.randn(*s, dtype=torch.bfloat16) * 0.05)(B, L, D)), 'A_re': _w(A_re), 'A_im': _w(A_im), 'B_re': _w(B_re), 'B_im': _w(B_im), 'C_re': _w(C_re), 'C_im': _w(C_im), 'log_dt': _w(log_dt), 'Dskip': _w(Dskip)}
    _B_in = _B_setup()
    return {'A_x': _A_in['x'], 'A_mem0': _A_in['mem0'], 'A_Wq': _A_in['Wq'], 'A_Wk': _A_in['Wk'], 'A_Wv': _A_in['Wv'], 'A_Wo': _A_in['Wo'], 'A_seg_len': _A_in['seg_len'], 'B_u': _B_in['u'], 'B_A_re': _B_in['A_re'], 'B_A_im': _B_in['A_im'], 'B_B_re': _B_in['B_re'], 'B_B_im': _B_in['B_im'], 'B_C_re': _B_in['C_re'], 'B_C_im': _B_in['C_im'], 'B_log_dt': _B_in['log_dt'], 'B_Dskip': _B_in['Dskip']}

def reference(A_x, A_mem0, A_Wq, A_Wk, A_Wv, A_Wo, A_seg_len, B_u, B_A_re, B_A_im, B_B_re, B_B_im, B_C_re, B_C_im, B_log_dt, B_Dskip):

    def _A_ref(x, mem0, Wq, Wk, Wv, Wo, seg_len):
        B, S, Dm = x.shape
        H, Dh = (Wq.shape[1], Wq.shape[2])
        M = mem0.shape[1]
        scale = Dh ** (-0.5)
        n_seg = S // seg_len
        L = M + seg_len
        idx = torch.arange(L)
        mask = (idx[:, None] < M) | (idx[:, None] >= idx[None, :])
        mem = mem0
        outs = []
        for s in range(n_seg):
            xs = x[:, s * seg_len:(s + 1) * seg_len, :].clone()
            h = torch.concatenate([mem, xs], axis=1)
            q = torch.einsum('btd,dhe->bhte', h, Wq)
            k = torch.einsum('btd,dhe->bhte', h, Wk)
            v = torch.einsum('btd,dhe->bhte', h, Wv)
            scores = torch.einsum('bhqe,bhke->bhqk', q, k) * scale
            scores = torch.where(mask[None, None], scores, -1000000000.0)
            p = _softmax(scores, axis=-1)
            o = torch.einsum('bhqk,bhke->bhqe', p, v)
            o = torch.einsum('bhte,hed->btd', o, Wo)
            mem = o[:, :M, :].clone()
            outs.append(o[:, M:, :])
        return torch.concatenate(outs, axis=1)

    def _B_ref(u, A_re, A_im, B_re, B_im, C_re, C_im, log_dt, Dskip):
        Bsz, L, D = u.shape
        dt = torch.exp(log_dt)[:, None]
        A = A_re + 1j * A_im
        Bc = B_re + 1j * B_im
        Cc = C_re + 1j * C_im
        logdA = dt * A
        dB = dt * Bc
        l = (lambda x, dt: x.to(dt))(torch.arange(L), A_re.dtype)
        P = torch.exp(logdA[:, :, None] * l[None, None, :])
        K = torch.einsum('dn,dnl,dn->dl', Cc, P, dB).real
        L2 = 2 * L
        Kp = _pad(K, ((0, 0), (0, L)))
        up = (lambda x, *d: x.permute(*d))(u, 0, 2, 1)
        up = _pad(up, ((0, 0), (0, 0), (0, L)))
        Kf = (lambda x, axes=(-2, -1): torch.fft.rfft2(x.float(), dim=axes))(Kp[:, None, :], axes=(-2, -1))
        Uf = (lambda x, axes=(-2, -1): torch.fft.rfft2(x.float(), dim=axes))(up[:, :, None, :], axes=(-2, -1))
        Yf = Uf * Kf[None, :, :, :]
        y = (lambda x, s, axes=(-2, -1): torch.fft.irfft2(x, s=s, dim=axes).to(torch.bfloat16))(Yf, (1, L2), axes=(-2, -1))[:, :, 0, :L]
        y = (lambda x, *d: x.permute(*d))(y, 0, 2, 1) + u * Dskip[None, None, :]
        return y
    a = _A_ref(A_x, A_mem0, A_Wq, A_Wk, A_Wv, A_Wo, A_seg_len)
    b = _B_ref(B_u, B_A_re, B_A_im, B_B_re, B_B_im, B_C_re, B_C_im, B_log_dt, B_Dskip)
    return torch.concatenate([a, b], axis=-1)
```

```asm
; @launch grid=(256,1,1) block=(256,1,1) lds=163840
.amdgcn_target "amdgcn-amd-amdhsa--gfx950"
.text
.globl concat_heads__memory_aug_recurrent_mem_tr__ssm_conv_s4__prompt_kernel
.p2align 8
.type concat_heads__memory_aug_recurrent_mem_tr__ssm_conv_s4__prompt_kernel,@function
concat_heads__memory_aug_recurrent_mem_tr__ssm_conv_s4__prompt_kernel:
    s_cmp_ge_u32 s2, 256
    s_cbranch_scc1 L_exit
    s_load_dwordx8 s[80:87], s[0:1], 8
    s_load_dwordx2 s[78:79], s[0:1], 0
    s_load_dwordx2 s[88:89], s[0:1], 40
    s_load_dwordx2 s[6:7], s[0:1], 136
    s_load_dwordx2 s[8:9], s[0:1], 144
    s_mov_b32 s10, 140509184
    s_mov_b32 s11, 0x20000
    s_getreg_b32 s28, hwreg(HW_REG_XCC_ID)
    s_and_b32 s28, s28, 7
    s_lshl_b32 s28, s28, 2
    s_lshr_b32 s28, 1985229058, s28
    s_and_b32 s28, s28, 7
    s_lshr_b32 s29, s2, 3
    s_mov_b32 s4, 0
    v_and_b32 v1, 63, v0
    v_lshrrev_b32 v2, 6, v0
    s_nop 0
    v_readfirstlane_b32 s5, v2
    s_waitcnt lgkmcnt(0)
L_dispatch:
    s_cmp_ge_u32 s28, 2
    s_cbranch_scc1 L_dispatch2
L_chain:
    s_mov_b64 s[12:13], s[82:83]
    s_mov_b32 s14, 5242880
    s_mov_b32 s15, 0x20000
    s_mov_b64 s[16:17], s[84:85]
    s_mov_b32 s18, 5242880
    s_mov_b32 s19, 0x20000
    s_mov_b64 s[20:21], s[86:87]
    s_mov_b32 s22, 5242880
    s_mov_b32 s23, 0x20000
    s_mov_b64 s[24:25], s[88:89]
    s_mov_b32 s26, 5242880
    s_mov_b32 s27, 0x20000
    s_mul_i32 s44, s28, 2621440
    s_sub_u32 s47, 2621440, s44
    v_lshrrev_b32 v16, 4, v0
    v_and_b32 v17, 15, v0
    v_lshrrev_b32 v18, 3, v16
    v_and_b32 v19, 7, v16
    v_lshlrev_b32 v20, 4, v18
    v_lshl_add_u32 v20, v19, 1, v20
    v_lshl_add_u32 v21, v19, 3, v18
    s_lshl_b32 s32, s29, 8
    v_lshl_add_u32 v22, v17, 4, s32
    v_lshl_add_u32 v8, v20, 13, v22
    v_lshl_add_u32 v9, v21, 13, v22
    s_waitcnt lgkmcnt(0)
    s_add_u32 s41, s44, 0
    buffer_load_dwordx4 v[40:43], v8, s[12:15], s41 offen
    s_add_u32 s41, s44, 262144
    buffer_load_dwordx4 v[44:47], v8, s[12:15], s41 offen
    s_add_u32 s41, s44, 8192
    buffer_load_dwordx4 v[48:51], v8, s[12:15], s41 offen
    s_add_u32 s41, s44, 270336
    buffer_load_dwordx4 v[52:55], v8, s[12:15], s41 offen
    s_or_b32 s32, s4, s5
    s_cbranch_scc1 Lclr_1
    v_mov_b64 v[136:137], 0
    v_mov_b64 v[138:139], 0
    s_lshl_b32 s32, s2, 12
    v_lshlrev_b32 v140, 4, v1
    buffer_store_dwordx4 v[136:139], v140, s[8:11], s32 offen offset:0 sc1
    buffer_store_dwordx4 v[136:139], v140, s[8:11], s32 offen offset:1024 sc1
    buffer_store_dwordx4 v[136:139], v140, s[8:11], s32 offen offset:2048 sc1
    buffer_store_dwordx4 v[136:139], v140, s[8:11], s32 offen offset:3072 sc1
Lclr_1:
    s_getpc_b64 s[32:33]
    s_add_u32 s32, s32, L_chain_pro-.
    s_addc_u32 s33, s33, 0
    s_lshl_b32 s34, s29, 8
    v_lshl_add_u32 v39, v0, 2, s34
    v_min_u32 v39, L_code_end-L_chain_pro, v39
    global_load_dword v39, v39, s[32:33]
    s_add_u32 s41, s44, 0
    buffer_load_dwordx4 v[56:59], v8, s[16:19], s41 offen
    s_add_u32 s41, s44, 262144
    buffer_load_dwordx4 v[60:63], v8, s[16:19], s41 offen
    s_add_u32 s41, s44, 8192
    buffer_load_dwordx4 v[64:67], v8, s[16:19], s41 offen
    s_add_u32 s41, s44, 270336
    buffer_load_dwordx4 v[68:71], v8, s[16:19], s41 offen
    s_add_u32 s41, s44, 0
    buffer_load_dwordx4 v[72:75], v8, s[20:23], s41 offen
    s_add_u32 s41, s44, 262144
    buffer_load_dwordx4 v[76:79], v8, s[20:23], s41 offen
    s_add_u32 s41, s44, 8192
    buffer_load_dwordx4 v[80:83], v8, s[20:23], s41 offen
    s_add_u32 s41, s44, 270336
    buffer_load_dwordx4 v[84:87], v8, s[20:23], s41 offen
    s_add_u32 s41, s47, 0
    buffer_load_dwordx4 v[88:91], v8, s[12:15], s41 offen
    s_add_u32 s41, s47, 262144
    buffer_load_dwordx4 v[92:95], v8, s[12:15], s41 offen
    s_add_u32 s41, s47, 8192
    buffer_load_dwordx4 v[96:99], v8, s[12:15], s41 offen
    s_add_u32 s41, s47, 270336
    buffer_load_dwordx4 v[100:103], v8, s[12:15], s41 offen
    s_add_u32 s41, s47, 0
    buffer_load_dwordx4 v[104:107], v8, s[16:19], s41 offen
    s_add_u32 s41, s47, 262144
    buffer_load_dwordx4 v[108:111], v8, s[16:19], s41 offen
    s_add_u32 s41, s47, 8192
    buffer_load_dwordx4 v[112:115], v8, s[16:19], s41 offen
    s_add_u32 s41, s47, 270336
    buffer_load_dwordx4 v[116:119], v8, s[16:19], s41 offen
    s_add_u32 s41, s44, 524288
    buffer_load_dwordx4 v[120:123], v8, s[12:15], s41 offen
    s_add_u32 s41, s44, 786432
    buffer_load_dwordx4 v[124:127], v8, s[12:15], s41 offen
    s_add_u32 s41, s44, 532480
    buffer_load_dwordx4 v[128:131], v8, s[12:15], s41 offen
    s_add_u32 s41, s44, 794624
    buffer_load_dwordx4 v[132:135], v8, s[12:15], s41 offen
    s_or_b32 s32, s4, s5
    s_cbranch_scc1 Lreg_2
    s_lshl_b32 s32, 1, s29
    s_mov_b32 s33, 0x100
    s_lshl_b32 s34, s28, 5
    s_waitcnt vmcnt(21)
    s_atomic_add_x2 s[32:33], s[6:7], s34
    s_waitcnt lgkmcnt(0)
Lreg_2:
    s_mul_i32 s32, s29, 163840
    s_mul_i32 s33, s28, 640
    s_add_u32 s32, s32, s33
    v_mul_u32_u24 v20, 1280, v16
    v_add_u32 v20, s32, v20
    v_lshrrev_b32 v21, 2, v17
    v_lshl_add_u32 v10, v21, 7, v20
    v_and_b32 v21, 3, v17
    v_lshl_add_u32 v10, v21, 4, v10
    v_lshrrev_b32 v21, 3, v17
    v_mul_u32_u24 v21, 81920, v21
    v_add_u32 v20, v21, v20
    v_and_b32 v21, 7, v17
    v_lshl_add_u32 v11, v21, 4, v20
    v_mul_u32_u24 v12, 288, v16
    v_lshl_add_u32 v12, v17, 4, v12
    v_bfe_u32 v16, v1, 4, 1
    v_bfe_u32 v17, v1, 5, 1
    v_bfe_u32 v18, v1, 2, 1
    v_bfe_u32 v19, v1, 3, 1
    v_and_b32 v20, 3, v1
    v_lshl_add_u32 v21, v16, 5, v19
    v_lshl_add_u32 v21, v18, 3, v21
    v_lshl_add_u32 v21, v17, 1, v21
    v_mul_u32_u24 v13, 288, v21
    v_lshl_add_u32 v13, v20, 3, v13
    v_lshl_add_u32 v13, s5, 6, v13
    v_lshl_add_u32 v21, v16, 4, v18
    v_lshl_add_u32 v21, v17, 3, v21
    v_lshl_add_u32 v21, v19, 2, v21
    v_mul_u32_u24 v21, 288, v21
    v_lshl_add_u32 v21, v20, 3, v21
    v_lshl_add_u32 v14, s5, 6, v21
    v_lshl_add_u32 v15, s5, 5, v21
    s_lshl_b32 s51, s5, 10
    s_lshl_b32 s52, s5, 8
    s_add_u32 s52, s52, 4096
    v_mov_b32 v150, v1
    v_lshlrev_b32 v0, 4, v150
    v_lshlrev_b32 v148, 3, v150
    v_lshlrev_b32 v2, 2, v150
    s_mul_i32 s32, s5, 30720
    s_add_u32 s32, s32, 40960
    v_add_u32 v1, s32, v0
    s_lshl_b32 s37, s5, 10
    s_lshl_b32 s40, s5, 11
    v_add_u32 v149, s40, v0
    v_and_b32 v24, 15, v150
    v_lshrrev_b32 v25, 4, v150
    v_lshrrev_b32 v26, 2, v24
    v_and_b32 v27, 3, v24
    v_and_b32 v28, 1, v24
    v_bfe_u32 v29, v24, 1, 1
    v_lshrrev_b32 v33, 1, v25
    v_and_b32 v34, 1, v25
    v_and_b32 v30, 1, v26
    v_lshlrev_b32 v30, 1, v30
    v_xor_b32 v30, v30, v25
    v_lshlrev_b32 v30, 5, v30
    v_lshl_add_u32 v30, v26, 7, v30
    v_lshl_add_u32 v30, v27, 2, v30
    s_lshl_b32 s32, s5, 9
    s_add_u32 s33, s32, 10240
    v_add_u32 v4, s33, v30
    v_lshl_add_u32 v31, v26, 1, v28
    v_lshlrev_b32 v30, 2, v34
    v_xor_b32 v30, v30, v31
    v_lshlrev_b32 v30, 4, v30
    v_lshl_add_u32 v7, v25, 7, v30
    v_lshrrev_b32 v35, 3, v24
    v_lshlrev_b32 v30, 8, v35
    v_lshl_add_u32 v30, v25, 6, v30
    v_lshl_add_u32 v30, v28, 5, v30
    v_bfe_u32 v32, v24, 1, 2
    v_lshl_add_u32 v30, v32, 2, v30
    s_add_u32 s33, s32, 12288
    v_add_u32 v5, s33, v30
    v_lshlrev_b32 v30, 8, v33
    v_lshl_add_u32 v30, v26, 6, v30
    v_lshl_add_u32 v30, v34, 5, v30
    v_lshl_add_u32 v30, v28, 4, v30
    v_lshl_add_u32 v30, v29, 3, v30
    s_add_u32 s33, s32, 14336
    v_add_u32 v6, s33, v30
    v_mov_b32 v144, 0x4444
    v_mov_b32 v30, 0xeeee
    v_cmp_eq_u32 vcc, 1, v29
    s_nop 1
    v_cndmask_b32 v144, v144, v30, vcc
    v_and_b32 v30, 4, v24
    v_cmp_eq_u32 vcc, 4, v30
    v_mov_b32 v30, 0x3f80
    s_nop 0
    v_cndmask_b32 v30, v30, 1.0, vcc
    v_cmp_eq_u32 vcc, 1, v28
    s_nop 1
    v_cndmask_b32 v140, v30, 0, vcc
    v_cndmask_b32 v141, 0, v30, vcc
    v_mov_b64 v[142:143], v[140:141]
    s_mul_i32 s32, s28, 172032
    s_add_u32 s32, s32, 131072
    s_lshl_b32 s33, s29, 6
    s_add_u32 s33, s33, s32
    s_mul_i32 s34, s5, 33792
    s_add_u32 s34, s34, s33
    v_lshl_add_u32 v30, v26, 1, v33
    v_mul_u32_u24 v30, 4224, v30
    v_lshl_add_u32 v30, v34, 11, v30
    v_lshl_add_u32 v30, v27, 4, v30
    v_add_u32 v145, s34, v30
    s_add_u32 s35, s32, 135168
    s_lshl_b32 s33, s29, 5
    s_add_u32 s33, s33, s35
    s_mul_i32 s34, s5, 9216
    s_add_u32 s34, s34, s33
    v_lshl_add_u32 v30, v25, 1, v35
    v_mul_u32_u24 v30, 1152, v30
    v_and_b32 v36, 7, v24
    v_lshl_add_u32 v30, v36, 2, v30
    v_add_u32 v146, s34, v30
    s_mul_i32 s33, s29, 4224
    s_add_u32 s33, s33, s32
    s_mul_i32 s34, s29, 1152
    s_add_u32 s34, s34, s35
    s_add_u32 s33, s33, s40
    s_lshl_b32 s35, s29, 1
    s_add_u32 s35, s35, s5
    s_lshl_b32 s35, s35, 6
    s_lshl_b32 s36, s29, 5
    s_add_u32 s36, s36, 4096
    s_cmp_lt_u32 s5, 2
    s_cselect_b32 s60, s33, s34
    s_cselect_b32 s35, s35, s36
    s_cselect_b32 s36, 45, 47
    s_mul_i32 s32, s28, 5120
    s_add_u32 s32, s32, 81920
    s_add_u32 s58, s32, s35
    s_add_u32 s53, s32, s51
    s_add_u32 s54, s32, s52
    s_lshl_b32 s32, s28, 14
    s_add_u32 s32, s32, 0
    s_add_u32 s46, s32, s35
    s_xor_b32 s32, s32, 16384
    s_add_u32 s55, s32, s51
    s_add_u32 s56, s32, s52
    v_lshlrev_b32 v30, 5, v32
    v_lshl_add_u32 v30, v34, 4, v30
    v_and_b32 v36, s36, v150
    v_cmp_eq_u32 vcc, 0, v36
    v_mov_b32 v36, 2147418112
    s_nop 0
    v_cndmask_b32 v147, v36, v30, vcc
    s_lshr_b32 s32, s29, 2
    s_lshl_b32 s32, s32, 14
    s_and_b32 s33, s29, 3
    s_lshl_b32 s33, s33, 11
    s_add_u32 s32, s32, s33
    s_lshl_b32 s33, s5, 9
    s_add_u32 s32, s32, s33
    s_add_u32 s32, s32, 524288
    s_lshl_b32 s34, s28, 17
    s_add_u32 s66, s32, s34
    s_xor_b32 s34, s34, 131072
    s_add_u32 s67, s32, s34
    s_lshl_b32 s32, s29, 14
    s_add_u32 s33, s32, s40
    s_add_u32 s61, s33, 4194304
    s_add_u32 s62, s33, 37748736
    s_lshl_b32 s45, s5, 2
    s_lshl_b32 s34, s28, 10
    s_add_u32 s45, s45, s34
    s_lshl_b32 s34, s28, 12
    s_add_u32 s34, s34, s37
    s_add_u32 s34, s34, s32
    s_add_u32 s64, s34, 71303168
    s_lshl_b32 s32, s29, 5
    s_add_u32 s32, s32, s28
    s_lshl_b32 s32, s32, 2
    s_add_u32 s76, s32, 98304
    s_lshl_b32 s77, s29, 7
    s_add_u32 s77, s77, 94208
    s_mov_b32 s72, 1040356334
    s_mov_b32 s73, 1040356334
    s_mov_b32 s43, 3187839982
    s_mov_b32 s42, 1
    s_mov_b32 s68, 0x3f803f80
    s_mov_b32 s69, 0x3f803f80
    s_mov_b32 s70, 0x3f003f00
    s_mov_b32 s71, 0x3f003f00
    s_mov_b32 s74, 0xcccccccc
    s_mov_b32 s75, 0xcccccccc
    s_mov_b32 s48, 0
    s_mov_b32 s65, 1
    s_add_u32 s31, s40, 24576
    v_xor_b32 v149, 8192, v149
    s_mov_b32 s49, 0
    s_mov_b32 s50, 2
L_chain_pro:
    s_waitcnt vmcnt(21)
    ds_write_b128 v12, v[40:43] offset:0
    ds_write_b128 v12, v[44:47] offset:4608
    ds_write_b128 v12, v[48:51] offset:9216
    ds_write_b128 v12, v[52:55] offset:13824
    s_waitcnt lgkmcnt(0)
    s_add_u32 s41, s44, 524288
    buffer_load_dwordx4 v[40:43], v8, s[16:19], s41 offen
    s_add_u32 s41, s44, 786432
    buffer_load_dwordx4 v[44:47], v8, s[16:19], s41 offen
    s_add_u32 s41, s44, 532480
    buffer_load_dwordx4 v[48:51], v8, s[16:19], s41 offen
    s_add_u32 s41, s44, 794624
    buffer_load_dwordx4 v[52:55], v8, s[16:19], s41 offen
    s_barrier
    ds_read_b64_tr_b16 a[0:1], v13 offset:0
    ds_read_b64_tr_b16 a[2:3], v13 offset:4608
    ds_read_b64_tr_b16 a[4:5], v13 offset:1152
    ds_read_b64_tr_b16 a[6:7], v13 offset:5760
    ds_read_b64_tr_b16 a[8:9], v13 offset:32
    ds_read_b64_tr_b16 a[10:11], v13 offset:4640
    ds_read_b64_tr_b16 a[12:13], v13 offset:1184
    ds_read_b64_tr_b16 a[14:15], v13 offset:5792
    s_waitcnt vmcnt(20)
    ds_write_b128 v12, v[56:59] offset:18432
    ds_write_b128 v12, v[60:63] offset:23040
    ds_write_b128 v12, v[64:67] offset:27648
    ds_write_b128 v12, v[68:71] offset:32256
    s_waitcnt lgkmcnt(0)
    s_add_u32 s41, s44, 524288
    buffer_load_dwordx4 v[56:59], v8, s[20:23], s41 offen
    s_add_u32 s41, s44, 786432
    buffer_load_dwordx4 v[60:63], v8, s[20:23], s41 offen
    s_add_u32 s41, s44, 532480
    buffer_load_dwordx4 v[64:67], v8, s[20:23], s41 offen
    s_add_u32 s41, s44, 794624
    buffer_load_dwordx4 v[68:71], v8, s[20:23], s41 offen
    s_barrier
    ds_read_b64_tr_b16 a[16:17], v13 offset:18432
    ds_read_b64_tr_b16 a[18:19], v13 offset:23040
    ds_read_b64_tr_b16 a[20:21], v13 offset:19584
    ds_read_b64_tr_b16 a[22:23], v13 offset:24192
    ds_read_b64_tr_b16 a[24:25], v13 offset:18464
    ds_read_b64_tr_b16 a[26:27], v13 offset:23072
    ds_read_b64_tr_b16 a[28:29], v13 offset:19616
    ds_read_b64_tr_b16 a[30:31], v13 offset:24224
    s_waitcnt vmcnt(20)
    ds_write_b128 v12, v[72:75] offset:0
    ds_write_b128 v12, v[76:79] offset:4608
    ds_write_b128 v12, v[80:83] offset:9216
    ds_write_b128 v12, v[84:87] offset:13824
    s_waitcnt lgkmcnt(0)
    s_add_u32 s41, s47, 524288
    buffer_load_dwordx4 v[72:75], v8, s[12:15], s41 offen
    s_add_u32 s41, s47, 786432
    buffer_load_dwordx4 v[76:79], v8, s[12:15], s41 offen
    s_add_u32 s41, s47, 532480
    buffer_load_dwordx4 v[80:83], v8, s[12:15], s41 offen
    s_add_u32 s41, s47, 794624
    buffer_load_dwordx4 v[84:87], v8, s[12:15], s41 offen
    s_barrier
    ds_read_b64_tr_b16 v[24:25], v13 offset:0
    ds_read_b64_tr_b16 v[26:27], v13 offset:4608
    ds_read_b64_tr_b16 v[28:29], v13 offset:1152
    ds_read_b64_tr_b16 v[30:31], v13 offset:5760
    s_waitcnt lgkmcnt(0)
    ds_write_b128 v1, v[24:27] offset:0
    ds_write_b128 v1, v[28:31] offset:1024
    ds_read_b64_tr_b16 v[32:33], v13 offset:32
    ds_read_b64_tr_b16 v[34:35], v13 offset:4640
    ds_read_b64_tr_b16 v[36:37], v13 offset:1184
    ds_read_b64_tr_b16 v[38:39], v13 offset:5792
    s_waitcnt lgkmcnt(0)
    ds_write_b128 v1, v[32:35] offset:2048
    ds_write_b128 v1, v[36:39] offset:3072
    s_waitcnt vmcnt(20)
    ds_write_b128 v12, v[88:91] offset:18432
    ds_write_b128 v12, v[92:95] offset:23040
    ds_write_b128 v12, v[96:99] offset:27648
    ds_write_b128 v12, v[100:103] offset:32256
    s_waitcnt lgkmcnt(0)
    s_add_u32 s41, s47, 524288
    buffer_load_dwordx4 v[88:91], v8, s[16:19], s41 offen
    s_add_u32 s41, s47, 786432
    buffer_load_dwordx4 v[92:95], v8, s[16:19], s41 offen
    s_add_u32 s41, s47, 532480
    buffer_load_dwordx4 v[96:99], v8, s[16:19], s41 offen
    s_add_u32 s41, s47, 794624
    buffer_load_dwordx4 v[100:103], v8, s[16:19], s41 offen
    s_barrier
    ds_read_b64_tr_b16 a[176:177], v13 offset:18432
    ds_read_b64_tr_b16 a[178:179], v13 offset:23040
    ds_read_b64_tr_b16 a[180:181], v13 offset:19584
    ds_read_b64_tr_b16 a[182:183], v13 offset:24192
    ds_read_b64_tr_b16 a[184:185], v13 offset:18464
    ds_read_b64_tr_b16 a[186:187], v13 offset:23072
    ds_read_b64_tr_b16 a[188:189], v13 offset:19616
    ds_read_b64_tr_b16 a[190:191], v13 offset:24224
    s_waitcnt vmcnt(20)
    ds_write_b128 v12, v[104:107] offset:0
    ds_write_b128 v12, v[108:111] offset:4608
    ds_write_b128 v12, v[112:115] offset:9216
    ds_write_b128 v12, v[116:119] offset:13824
    s_waitcnt lgkmcnt(0)
    s_add_u32 s41, s44, 1048576
    buffer_load_dwordx4 v[104:107], v8, s[12:15], s41 offen
    s_add_u32 s41, s44, 1310720
    buffer_load_dwordx4 v[108:111], v8, s[12:15], s41 offen
    s_add_u32 s41, s44, 1056768
    buffer_load_dwordx4 v[112:115], v8, s[12:15], s41 offen
    s_add_u32 s41, s44, 1318912
    buffer_load_dwordx4 v[116:119], v8, s[12:15], s41 offen
    s_barrier
    ds_read_b64_tr_b16 a[192:193], v13 offset:0
    ds_read_b64_tr_b16 a[194:195], v13 offset:4608
    ds_read_b64_tr_b16 a[196:197], v13 offset:1152
    ds_read_b64_tr_b16 a[198:199], v13 offset:5760
    ds_read_b64_tr_b16 a[200:201], v13 offset:32
    ds_read_b64_tr_b16 a[202:203], v13 offset:4640
    ds_read_b64_tr_b16 a[204:205], v13 offset:1184
    ds_read_b64_tr_b16 a[206:207], v13 offset:5792
    s_waitcnt vmcnt(20)
    ds_write_b128 v12, v[120:123] offset:18432
    ds_write_b128 v12, v[124:127] offset:23040
    ds_write_b128 v12, v[128:131] offset:27648
    ds_write_b128 v12, v[132:135] offset:32256
    s_waitcnt lgkmcnt(0)
    s_add_u32 s41, s44, 1048576
    buffer_load_dwordx4 v[120:123], v8, s[16:19], s41 offen
    s_add_u32 s41, s44, 1310720
    buffer_load_dwordx4 v[124:127], v8, s[16:19], s41 offen
    s_add_u32 s41, s44, 1056768
    buffer_load_dwordx4 v[128:131], v8, s[16:19], s41 offen
    s_add_u32 s41, s44, 1318912
    buffer_load_dwordx4 v[132:135], v8, s[16:19], s41 offen
    s_barrier
    ds_read_b64_tr_b16 a[32:33], v13 offset:18432
    ds_read_b64_tr_b16 a[34:35], v13 offset:23040
    ds_read_b64_tr_b16 a[36:37], v13 offset:19584
    ds_read_b64_tr_b16 a[38:39], v13 offset:24192
    ds_read_b64_tr_b16 a[40:41], v13 offset:18464
    ds_read_b64_tr_b16 a[42:43], v13 offset:23072
    ds_read_b64_tr_b16 a[44:45], v13 offset:19616
    ds_read_b64_tr_b16 a[46:47], v13 offset:24224
    s_waitcnt vmcnt(20)
    ds_write_b128 v12, v[40:43] offset:0
    ds_write_b128 v12, v[44:47] offset:4608
    ds_write_b128 v12, v[48:51] offset:9216
    ds_write_b128 v12, v[52:55] offset:13824
    s_waitcnt lgkmcnt(0)
    s_add_u32 s41, s44, 1048576
    buffer_load_dwordx4 v[40:43], v8, s[20:23], s41 offen
    s_add_u32 s41, s44, 1310720
    buffer_load_dwordx4 v[44:47], v8, s[20:23], s41 offen
    s_add_u32 s41, s44, 1056768
    buffer_load_dwordx4 v[48:51], v8, s[20:23], s41 offen
    s_add_u32 s41, s44, 1318912
    buffer_load_dwordx4 v[52:55], v8, s[20:23], s41 offen
    s_barrier
    ds_read_b64_tr_b16 a[48:49], v13 offset:0
    ds_read_b64_tr_b16 a[50:51], v13 offset:4608
    ds_read_b64_tr_b16 a[52:53], v13 offset:1152
    ds_read_b64_tr_b16 a[54:55], v13 offset:5760
    ds_read_b64_tr_b16 a[56:57], v13 offset:32
    ds_read_b64_tr_b16 a[58:59], v13 offset:4640
    ds_read_b64_tr_b16 a[60:61], v13 offset:1184
    ds_read_b64_tr_b16 a[62:63], v13 offset:5792
    s_waitcnt vmcnt(20)
    ds_write_b128 v12, v[56:59] offset:18432
    ds_write_b128 v12, v[60:63] offset:23040
    ds_write_b128 v12, v[64:67] offset:27648
    ds_write_b128 v12, v[68:71] offset:32256
    s_waitcnt lgkmcnt(0)
    s_add_u32 s41, s47, 1048576
    buffer_load_dwordx4 v[56:59], v8, s[12:15], s41 offen
    s_add_u32 s41, s47, 1310720
    buffer_load_dwordx4 v[60:63], v8, s[12:15], s41 offen
    s_add_u32 s41, s47, 1056768
    buffer_load_dwordx4 v[64:67], v8, s[12:15], s41 offen
    s_add_u32 s41, s47, 1318912
    buffer_load_dwordx4 v[68:71], v8, s[12:15], s41 offen
    s_barrier
    ds_read_b64_tr_b16 v[24:25], v13 offset:18432
    ds_read_b64_tr_b16 v[26:27], v13 offset:23040
    ds_read_b64_tr_b16 v[28:29], v13 offset:19584
    ds_read_b64_tr_b16 v[30:31], v13 offset:24192
    s_waitcnt lgkmcnt(0)
    ds_write_b128 v1, v[24:27] offset:4096
    ds_write_b128 v1, v[28:31] offset:5120
    ds_read_b64_tr_b16 v[32:33], v13 offset:18464
    ds_read_b64_tr_b16 v[34:35], v13 offset:23072
    ds_read_b64_tr_b16 v[36:37], v13 offset:19616
    ds_read_b64_tr_b16 v[38:39], v13 offset:24224
    s_waitcnt lgkmcnt(0)
    ds_write_b128 v1, v[32:35] offset:6144
    ds_write_b128 v1, v[36:39] offset:7168
    s_waitcnt vmcnt(20)
    ds_write_b128 v12, v[72:75] offset:0
    ds_write_b128 v12, v[76:79] offset:4608
    ds_write_b128 v12, v[80:83] offset:9216
    ds_write_b128 v12, v[84:87] offset:13824
    s_waitcnt lgkmcnt(0)
    s_add_u32 s41, s47, 1048576
    buffer_load_dwordx4 v[72:75], v8, s[16:19], s41 offen
    s_add_u32 s41, s47, 1310720
    buffer_load_dwordx4 v[76:79], v8, s[16:19], s41 offen
    s_add_u32 s41, s47, 1056768
    buffer_load_dwordx4 v[80:83], v8, s[16:19], s41 offen
    s_add_u32 s41, s47, 1318912
    buffer_load_dwordx4 v[84:87], v8, s[16:19], s41 offen
    s_barrier
    ds_read_b64_tr_b16 a[208:209], v13 offset:0
    ds_read_b64_tr_b16 a[210:211], v13 offset:4608
    ds_read_b64_tr_b16 a[212:213], v13 offset:1152
    ds_read_b64_tr_b16 a[214:215], v13 offset:5760
    ds_read_b64_tr_b16 a[216:217], v13 offset:32
    ds_read_b64_tr_b16 a[218:219], v13 offset:4640
    ds_read_b64_tr_b16 a[220:221], v13 offset:1184
    ds_read_b64_tr_b16 a[222:223], v13 offset:5792
    s_waitcnt vmcnt(20)
    ds_write_b128 v12, v[88:91] offset:18432
    ds_write_b128 v12, v[92:95] offset:23040
    ds_write_b128 v12, v[96:99] offset:27648
    ds_write_b128 v12, v[100:103] offset:32256
    s_waitcnt lgkmcnt(0)
    s_add_u32 s41, s44, 1572864
    buffer_load_dwordx4 v[88:91], v8, s[12:15], s41 offen
    s_add_u32 s41, s44, 1835008
    buffer_load_dwordx4 v[92:95], v8, s[12:15], s41 offen
    s_add_u32 s41, s44, 1581056
    buffer_load_dwordx4 v[96:99], v8, s[12:15], s41 offen
    s_add_u32 s41, s44, 1843200
    buffer_load_dwordx4 v[100:103], v8, s[12:15], s41 offen
    s_barrier
    ds_read_b64_tr_b16 a[224:225], v13 offset:18432
    ds_read_b64_tr_b16 a[226:227], v13 offset:23040
    ds_read_b64_tr_b16 a[228:229], v13 offset:19584
    ds_read_b64_tr_b16 a[230:231], v13 offset:24192
    ds_read_b64_tr_b16 a[232:233], v13 offset:18464
    ds_read_b64_tr_b16 a[234:235], v13 offset:23072
    ds_read_b64_tr_b16 a[236:237], v13 offset:19616
    ds_read_b64_tr_b16 a[238:239], v13 offset:24224
    s_waitcnt vmcnt(20)
    ds_write_b128 v12, v[104:107] offset:0
    ds_write_b128 v12, v[108:111] offset:4608
    ds_write_b128 v12, v[112:115] offset:9216
    ds_write_b128 v12, v[116:119] offset:13824
    s_waitcnt lgkmcnt(0)
    s_add_u32 s41, s44, 1572864
    buffer_load_dwordx4 v[104:107], v8, s[16:19], s41 offen
    s_add_u32 s41, s44, 1835008
    buffer_load_dwordx4 v[108:111], v8, s[16:19], s41 offen
    s_add_u32 s41, s44, 1581056
    buffer_load_dwordx4 v[112:115], v8, s[16:19], s41 offen
    s_add_u32 s41, s44, 1843200
    buffer_load_dwordx4 v[116:119], v8, s[16:19], s41 offen
    s_barrier
    ds_read_b64_tr_b16 a[64:65], v13 offset:0
    ds_read_b64_tr_b16 a[66:67], v13 offset:4608
    ds_read_b64_tr_b16 a[68:69], v13 offset:1152
    ds_read_b64_tr_b16 a[70:71], v13 offset:5760
    ds_read_b64_tr_b16 a[72:73], v13 offset:32
    ds_read_b64_tr_b16 a[74:75], v13 offset:4640
    ds_read_b64_tr_b16 a[76:77], v13 offset:1184
    ds_read_b64_tr_b16 a[78:79], v13 offset:5792
    s_waitcnt vmcnt(20)
    ds_write_b128 v12, v[120:123] offset:18432
    ds_write_b128 v12, v[124:127] offset:23040
    ds_write_b128 v12, v[128:131] offset:27648
    ds_write_b128 v12, v[132:135] offset:32256
    s_waitcnt lgkmcnt(0)
    s_add_u32 s41, s44, 1572864
    buffer_load_dwordx4 v[120:123], v8, s[20:23], s41 offen
    s_add_u32 s41, s44, 1835008
    buffer_load_dwordx4 v[124:127], v8, s[20:23], s41 offen
    s_add_u32 s41, s44, 1581056
    buffer_load_dwordx4 v[128:131], v8, s[20:23], s41 offen
    s_add_u32 s41, s44, 1843200
    buffer_load_dwordx4 v[132:135], v8, s[20:23], s41 offen
    s_barrier
    ds_read_b64_tr_b16 a[80:81], v13 offset:18432
    ds_read_b64_tr_b16 a[82:83], v13 offset:23040
    ds_read_b64_tr_b16 a[84:85], v13 offset:19584
    ds_read_b64_tr_b16 a[86:87], v13 offset:24192
    ds_read_b64_tr_b16 a[88:89], v13 offset:18464
    ds_read_b64_tr_b16 a[90:91], v13 offset:23072
    ds_read_b64_tr_b16 a[92:93], v13 offset:19616
    ds_read_b64_tr_b16 a[94:95], v13 offset:24224
    s_waitcnt vmcnt(20)
    ds_write_b128 v12, v[40:43] offset:0
    ds_write_b128 v12, v[44:47] offset:4608
    ds_write_b128 v12, v[48:51] offset:9216
    ds_write_b128 v12, v[52:55] offset:13824
    s_waitcnt lgkmcnt(0)
    s_add_u32 s41, s47, 1572864
    buffer_load_dwordx4 v[40:43], v8, s[12:15], s41 offen
    s_add_u32 s41, s47, 1835008
    buffer_load_dwordx4 v[44:47], v8, s[12:15], s41 offen
    s_add_u32 s41, s47, 1581056
    buffer_load_dwordx4 v[48:51], v8, s[12:15], s41 offen
    s_add_u32 s41, s47, 1843200
    buffer_load_dwordx4 v[52:55], v8, s[12:15], s41 offen
    s_barrier
    ds_read_b64_tr_b16 v[24:25], v13 offset:0
    ds_read_b64_tr_b16 v[26:27], v13 offset:4608
    ds_read_b64_tr_b16 v[28:29], v13 offset:1152
    ds_read_b64_tr_b16 v[30:31], v13 offset:5760
    s_waitcnt lgkmcnt(0)
    ds_write_b128 v1, v[24:27] offset:8192
    ds_write_b128 v1, v[28:31] offset:9216
    ds_read_b64_tr_b16 v[32:33], v13 offset:32
    ds_read_b64_tr_b16 v[34:35], v13 offset:4640
    ds_read_b64_tr_b16 v[36:37], v13 offset:1184
    ds_read_b64_tr_b16 v[38:39], v13 offset:5792
    s_waitcnt lgkmcnt(0)
    ds_write_b128 v1, v[32:35] offset:10240
    ds_write_b128 v1, v[36:39] offset:11264
    s_waitcnt vmcnt(20)
    ds_write_b128 v12, v[56:59] offset:18432
    ds_write_b128 v12, v[60:63] offset:23040
    ds_write_b128 v12, v[64:67] offset:27648
    ds_write_b128 v12, v[68:71] offset:32256
    s_waitcnt lgkmcnt(0)
    s_add_u32 s41, s47, 1572864
    buffer_load_dwordx4 v[56:59], v8, s[16:19], s41 offen
    s_add_u32 s41, s47, 1835008
    buffer_load_dwordx4 v[60:63], v8, s[16:19], s41 offen
    s_add_u32 s41, s47, 1581056
    buffer_load_dwordx4 v[64:67], v8, s[16:19], s41 offen
    s_add_u32 s41, s47, 1843200
    buffer_load_dwordx4 v[68:71], v8, s[16:19], s41 offen
    s_barrier
    ds_read_b64_tr_b16 a[240:241], v13 offset:18432
    ds_read_b64_tr_b16 a[242:243], v13 offset:23040
    ds_read_b64_tr_b16 a[244:245], v13 offset:19584
    ds_read_b64_tr_b16 a[246:247], v13 offset:24192
    ds_read_b64_tr_b16 a[248:249], v13 offset:18464
    ds_read_b64_tr_b16 a[250:251], v13 offset:23072
    ds_read_b64_tr_b16 a[252:253], v13 offset:19616
    ds_read_b64_tr_b16 a[254:255], v13 offset:24224
    s_waitcnt vmcnt(20)
    ds_write_b128 v12, v[72:75] offset:0
    ds_write_b128 v12, v[76:79] offset:4608
    ds_write_b128 v12, v[80:83] offset:9216
    ds_write_b128 v12, v[84:87] offset:13824
    s_waitcnt lgkmcnt(0)
    s_add_u32 s41, s44, 2097152
    buffer_load_dwordx4 v[72:75], v9, s[12:15], s41 offen
    s_add_u32 s41, s44, 2113536
    buffer_load_dwordx4 v[76:79], v9, s[12:15], s41 offen
    s_add_u32 s41, s44, 2129920
    buffer_load_dwordx4 v[80:83], v9, s[12:15], s41 offen
    s_add_u32 s41, s44, 2146304
    buffer_load_dwordx4 v[84:87], v9, s[12:15], s41 offen
    s_barrier
    ds_read_b64_tr_b16 v[152:153], v13 offset:0
    ds_read_b64_tr_b16 v[154:155], v13 offset:4608
    ds_read_b64_tr_b16 v[156:157], v13 offset:1152
    ds_read_b64_tr_b16 v[158:159], v13 offset:5760
    ds_read_b64_tr_b16 v[160:161], v13 offset:32
    ds_read_b64_tr_b16 v[162:163], v13 offset:4640
    ds_read_b64_tr_b16 v[164:165], v13 offset:1184
    ds_read_b64_tr_b16 v[166:167], v13 offset:5792
    s_waitcnt vmcnt(20)
    ds_write_b128 v12, v[88:91] offset:18432
    ds_write_b128 v12, v[92:95] offset:23040
    ds_write_b128 v12, v[96:99] offset:27648
    ds_write_b128 v12, v[100:103] offset:32256
    s_waitcnt lgkmcnt(0)
    s_add_u32 s41, s44, 2097152
    buffer_load_dwordx4 v[88:91], v9, s[16:19], s41 offen
    s_add_u32 s41, s44, 2113536
    buffer_load_dwordx4 v[92:95], v9, s[16:19], s41 offen
    s_add_u32 s41, s44, 2129920
    buffer_load_dwordx4 v[96:99], v9, s[16:19], s41 offen
    s_add_u32 s41, s44, 2146304
    buffer_load_dwordx4 v[100:103], v9, s[16:19], s41 offen
    s_barrier
    ds_read_b64_tr_b16 a[96:97], v13 offset:18432
    ds_read_b64_tr_b16 a[98:99], v13 offset:23040
    ds_read_b64_tr_b16 a[100:101], v13 offset:19584
    ds_read_b64_tr_b16 a[102:103], v13 offset:24192
    ds_read_b64_tr_b16 a[104:105], v13 offset:18464
    ds_read_b64_tr_b16 a[106:107], v13 offset:23072
    ds_read_b64_tr_b16 a[108:109], v13 offset:19616
    ds_read_b64_tr_b16 a[110:111], v13 offset:24224
    s_waitcnt vmcnt(20)
    ds_write_b128 v12, v[104:107] offset:0
    ds_write_b128 v12, v[108:111] offset:4608
    ds_write_b128 v12, v[112:115] offset:9216
    ds_write_b128 v12, v[116:119] offset:13824
    s_waitcnt lgkmcnt(0)
    s_add_u32 s41, s44, 2097152
    buffer_load_dwordx4 v[104:107], v9, s[20:23], s41 offen
    s_add_u32 s41, s44, 2113536
    buffer_load_dwordx4 v[108:111], v9, s[20:23], s41 offen
    s_add_u32 s41, s44, 2129920
    buffer_load_dwordx4 v[112:115], v9, s[20:23], s41 offen
    s_add_u32 s41, s44, 2146304
    buffer_load_dwordx4 v[116:119], v9, s[20:23], s41 offen
    s_barrier
    ds_read_b64_tr_b16 a[112:113], v13 offset:0
    ds_read_b64_tr_b16 a[114:115], v13 offset:4608
    ds_read_b64_tr_b16 a[116:117], v13 offset:1152
    ds_read_b64_tr_b16 a[118:119], v13 offset:5760
    ds_read_b64_tr_b16 a[120:121], v13 offset:32
    ds_read_b64_tr_b16 a[122:123], v13 offset:4640
    ds_read_b64_tr_b16 a[124:125], v13 offset:1184
    ds_read_b64_tr_b16 a[126:127], v13 offset:5792
    s_waitcnt vmcnt(20)
    ds_write_b128 v12, v[120:123] offset:18432
    ds_write_b128 v12, v[124:127] offset:23040
    ds_write_b128 v12, v[128:131] offset:27648
    ds_write_b128 v12, v[132:135] offset:32256
    s_waitcnt lgkmcnt(0)
    s_add_u32 s41, s47, 2097152
    buffer_load_dwordx4 v[120:123], v9, s[12:15], s41 offen
    s_add_u32 s41, s47, 2113536
    buffer_load_dwordx4 v[124:127], v9, s[12:15], s41 offen
    s_add_u32 s41, s47, 2129920
    buffer_load_dwordx4 v[128:131], v9, s[12:15], s41 offen
    s_add_u32 s41, s47, 2146304
    buffer_load_dwordx4 v[132:135], v9, s[12:15], s41 offen
    s_barrier
    ds_read_b64_tr_b16 v[24:25], v13 offset:18432
    ds_read_b64_tr_b16 v[26:27], v13 offset:23040
    ds_read_b64_tr_b16 v[28:29], v13 offset:19584
    ds_read_b64_tr_b16 v[30:31], v13 offset:24192
    s_waitcnt lgkmcnt(0)
    ds_write_b128 v1, v[24:27] offset:12288
    ds_write_b128 v1, v[28:31] offset:13312
    ds_read_b64_tr_b16 v[32:33], v13 offset:18464
    ds_read_b64_tr_b16 v[34:35], v13 offset:23072
    ds_read_b64_tr_b16 v[36:37], v13 offset:19616
    ds_read_b64_tr_b16 v[38:39], v13 offset:24224
    s_waitcnt lgkmcnt(0)
    ds_write_b128 v1, v[32:35] offset:14336
    ds_write_b128 v1, v[36:39] offset:15360
    s_waitcnt vmcnt(20)
    ds_write_b128 v12, v[40:43] offset:0
    ds_write_b128 v12, v[44:47] offset:4608
    ds_write_b128 v12, v[48:51] offset:9216
    ds_write_b128 v12, v[52:55] offset:13824
    s_waitcnt lgkmcnt(0)
    s_add_u32 s41, s47, 2097152
    buffer_load_dwordx4 v[40:43], v9, s[16:19], s41 offen
    s_add_u32 s41, s47, 2113536
    buffer_load_dwordx4 v[44:47], v9, s[16:19], s41 offen
    s_add_u32 s41, s47, 2129920
    buffer_load_dwordx4 v[48:51], v9, s[16:19], s41 offen
    s_add_u32 s41, s47, 2146304
    buffer_load_dwordx4 v[52:55], v9, s[16:19], s41 offen
    s_barrier
    ds_read_b64_tr_b16 v[168:169], v13 offset:0
    ds_read_b64_tr_b16 v[170:171], v13 offset:4608
    ds_read_b64_tr_b16 v[172:173], v13 offset:1152
    ds_read_b64_tr_b16 v[174:175], v13 offset:5760
    ds_read_b64_tr_b16 v[176:177], v13 offset:32
    ds_read_b64_tr_b16 v[178:179], v13 offset:4640
    ds_read_b64_tr_b16 v[180:181], v13 offset:1184
    ds_read_b64_tr_b16 v[182:183], v13 offset:5792
    s_waitcnt vmcnt(20)
    ds_write_b128 v12, v[56:59] offset:18432
    ds_write_b128 v12, v[60:63] offset:23040
    ds_write_b128 v12, v[64:67] offset:27648
    ds_write_b128 v12, v[68:71] offset:32256
    s_waitcnt lgkmcnt(0)
    s_mov_b32 s41, 0
    buffer_load_dwordx4 v[56:59], v10, s[24:27], s41 offen
    s_mov_b32 s41, 20480
    buffer_load_dwordx4 v[60:63], v10, s[24:27], s41 offen
    s_mov_b32 s41, 40960
    buffer_load_dwordx4 v[64:67], v10, s[24:27], s41 offen
    s_mov_b32 s41, 61440
    buffer_load_dwordx4 v[68:71], v10, s[24:27], s41 offen
    s_barrier
    ds_read_b64_tr_b16 v[184:185], v13 offset:18432
    ds_read_b64_tr_b16 v[186:187], v13 offset:23040
    ds_read_b64_tr_b16 v[188:189], v13 offset:19584
    ds_read_b64_tr_b16 v[190:191], v13 offset:24192
    ds_read_b64_tr_b16 v[192:193], v13 offset:18464
    ds_read_b64_tr_b16 v[194:195], v13 offset:23072
    ds_read_b64_tr_b16 v[196:197], v13 offset:19616
    ds_read_b64_tr_b16 v[198:199], v13 offset:24224
    s_waitcnt vmcnt(20)
    ds_write_b128 v12, v[72:75] offset:0
    ds_write_b128 v12, v[76:79] offset:4608
    ds_write_b128 v12, v[80:83] offset:9216
    ds_write_b128 v12, v[84:87] offset:13824
    s_waitcnt lgkmcnt(0)
    s_mov_b32 s41, 64
    buffer_load_dwordx4 v[72:75], v10, s[24:27], s41 offen
    s_mov_b32 s41, 20544
    buffer_load_dwordx4 v[76:79], v10, s[24:27], s41 offen
    s_mov_b32 s41, 41024
    buffer_load_dwordx4 v[80:83], v10, s[24:27], s41 offen
    s_mov_b32 s41, 61504
    buffer_load_dwordx4 v[84:87], v10, s[24:27], s41 offen
    s_barrier
    ds_read_b64_tr_b16 a[128:129], v13 offset:0
    ds_read_b64_tr_b16 a[130:131], v13 offset:4608
    ds_read_b64_tr_b16 a[132:133], v13 offset:1152
    ds_read_b64_tr_b16 a[134:135], v13 offset:5760
    ds_read_b64_tr_b16 a[136:137], v13 offset:32
    ds_read_b64_tr_b16 a[138:139], v13 offset:4640
    ds_read_b64_tr_b16 a[140:141], v13 offset:1184
    ds_read_b64_tr_b16 a[142:143], v13 offset:5792
    s_waitcnt vmcnt(20)
    ds_write_b128 v12, v[88:91] offset:18432
    ds_write_b128 v12, v[92:95] offset:23040
    ds_write_b128 v12, v[96:99] offset:27648
    ds_write_b128 v12, v[100:103] offset:32256
    s_waitcnt lgkmcnt(0)
    s_mov_b32 s41, 81920
    buffer_load_dwordx4 v[88:91], v10, s[24:27], s41 offen
    s_mov_b32 s41, 102400
    buffer_load_dwordx4 v[92:95], v10, s[24:27], s41 offen
    s_mov_b32 s41, 122880
    buffer_load_dwordx4 v[96:99], v10, s[24:27], s41 offen
    s_mov_b32 s41, 143360
    buffer_load_dwordx4 v[100:103], v10, s[24:27], s41 offen
    s_barrier
    ds_read_b64_tr_b16 a[144:145], v13 offset:18432
    ds_read_b64_tr_b16 a[146:147], v13 offset:23040
    ds_read_b64_tr_b16 a[148:149], v13 offset:19584
    ds_read_b64_tr_b16 a[150:151], v13 offset:24192
    ds_read_b64_tr_b16 a[152:153], v13 offset:18464
    ds_read_b64_tr_b16 a[154:155], v13 offset:23072
    ds_read_b64_tr_b16 a[156:157], v13 offset:19616
    ds_read_b64_tr_b16 a[158:159], v13 offset:24224
    s_waitcnt vmcnt(20)
    ds_write_b128 v12, v[104:107] offset:0
    ds_write_b128 v12, v[108:111] offset:4608
    ds_write_b128 v12, v[112:115] offset:9216
    ds_write_b128 v12, v[116:119] offset:13824
    s_waitcnt lgkmcnt(0)
    s_mov_b32 s41, 81984
    buffer_load_dwordx4 v[104:107], v10, s[24:27], s41 offen
    s_mov_b32 s41, 102464
    buffer_load_dwordx4 v[108:111], v10, s[24:27], s41 offen
    s_mov_b32 s41, 122944
    buffer_load_dwordx4 v[112:115], v10, s[24:27], s41 offen
    s_mov_b32 s41, 143424
    buffer_load_dwordx4 v[116:119], v10, s[24:27], s41 offen
    s_getpc_b64 s[32:33]
    s_add_u32 s32, s32, L_chain_go-.
    s_addc_u32 s33, s33, 0
    s_lshl_b32 s34, s29, 8
    v_lshl_add_u32 v20, v150, 2, s34
    v_min_u32 v20, L_code_end-L_chain_go, v20
    global_load_dword v20, v20, s[32:33]
    s_barrier
    ds_read_b64_tr_b16 a[160:161], v13 offset:0
    ds_read_b64_tr_b16 a[162:163], v13 offset:4608
    ds_read_b64_tr_b16 a[164:165], v13 offset:1152
    ds_read_b64_tr_b16 a[166:167], v13 offset:5760
    ds_read_b64_tr_b16 a[168:169], v13 offset:32
    ds_read_b64_tr_b16 a[170:171], v13 offset:4640
    ds_read_b64_tr_b16 a[172:173], v13 offset:1184
    ds_read_b64_tr_b16 a[174:175], v13 offset:5792
    s_waitcnt vmcnt(21)
    ds_write_b128 v12, v[120:123] offset:18432
    ds_write_b128 v12, v[124:127] offset:23040
    ds_write_b128 v12, v[128:131] offset:27648
    ds_write_b128 v12, v[132:135] offset:32256
    s_waitcnt lgkmcnt(0)
    s_mov_b32 s41, 512
    buffer_load_dwordx4 v[120:123], v11, s[24:27], s41 offen
    s_mov_b32 s41, 20992
    buffer_load_dwordx4 v[124:127], v11, s[24:27], s41 offen
    s_mov_b32 s41, 41472
    buffer_load_dwordx4 v[128:131], v11, s[24:27], s41 offen
    s_mov_b32 s41, 61952
    buffer_load_dwordx4 v[132:135], v11, s[24:27], s41 offen
    s_barrier
    ds_read_b64_tr_b16 v[200:201], v13 offset:18432
    ds_read_b64_tr_b16 v[202:203], v13 offset:23040
    ds_read_b64_tr_b16 v[204:205], v13 offset:19584
    ds_read_b64_tr_b16 v[206:207], v13 offset:24192
    ds_read_b64_tr_b16 v[208:209], v13 offset:18464
    ds_read_b64_tr_b16 v[210:211], v13 offset:23072
    ds_read_b64_tr_b16 v[212:213], v13 offset:19616
    ds_read_b64_tr_b16 v[214:215], v13 offset:24224
    s_waitcnt vmcnt(21)
    ds_write_b128 v12, v[40:43] offset:0
    ds_write_b128 v12, v[44:47] offset:4608
    ds_write_b128 v12, v[48:51] offset:9216
    ds_write_b128 v12, v[52:55] offset:13824
    s_waitcnt lgkmcnt(0)
    s_barrier
    ds_read_b64_tr_b16 v[216:217], v13 offset:0
    ds_read_b64_tr_b16 v[218:219], v13 offset:4608
    ds_read_b64_tr_b16 v[220:221], v13 offset:1152
    ds_read_b64_tr_b16 v[222:223], v13 offset:5760
    ds_read_b64_tr_b16 v[224:225], v13 offset:32
    ds_read_b64_tr_b16 v[226:227], v13 offset:4640
    ds_read_b64_tr_b16 v[228:229], v13 offset:1184
    ds_read_b64_tr_b16 v[230:231], v13 offset:5792
    s_waitcnt vmcnt(17)
    ds_write_b128 v12, v[56:59] offset:18432
    ds_write_b128 v12, v[60:63] offset:23040
    ds_write_b128 v12, v[64:67] offset:27648
    ds_write_b128 v12, v[68:71] offset:32256
    s_waitcnt lgkmcnt(0)
    s_barrier
    ds_read_b64_tr_b16 v[248:249], v14 offset:18432
    ds_read_b64_tr_b16 v[250:251], v14 offset:19008
    ds_read_b64_tr_b16 v[252:253], v14 offset:27648
    ds_read_b64_tr_b16 v[254:255], v14 offset:28224
    ds_read_b64_tr_b16 v[32:33], v14 offset:18464
    ds_read_b64_tr_b16 v[34:35], v14 offset:19040
    ds_read_b64_tr_b16 v[36:37], v14 offset:27680
    ds_read_b64_tr_b16 v[38:39], v14 offset:28256
    s_waitcnt lgkmcnt(0)
    ds_write_b128 v1, v[32:35] offset:18432
    ds_write_b128 v1, v[36:39] offset:19456
    s_waitcnt vmcnt(13)
    ds_write_b128 v12, v[72:75] offset:0
    ds_write_b128 v12, v[76:79] offset:4608
    ds_write_b128 v12, v[80:83] offset:9216
    ds_write_b128 v12, v[84:87] offset:13824
    s_waitcnt lgkmcnt(0)
    s_barrier
    ds_read_b64_tr_b16 v[32:33], v14 offset:0
    ds_read_b64_tr_b16 v[34:35], v14 offset:576
    ds_read_b64_tr_b16 v[36:37], v14 offset:9216
    ds_read_b64_tr_b16 v[38:39], v14 offset:9792
    s_waitcnt lgkmcnt(0)
    ds_write_b128 v1, v[32:35] offset:22528
    ds_write_b128 v1, v[36:39] offset:23552
    ds_read_b64_tr_b16 v[32:33], v14 offset:32
    ds_read_b64_tr_b16 v[34:35], v14 offset:608
    ds_read_b64_tr_b16 v[36:37], v14 offset:9248
    ds_read_b64_tr_b16 v[38:39], v14 offset:9824
    s_waitcnt lgkmcnt(0)
    ds_write_b128 v1, v[32:35] offset:26624
    ds_write_b128 v1, v[36:39] offset:27648
    s_waitcnt vmcnt(9)
    ds_write_b128 v12, v[88:91] offset:18432
    ds_write_b128 v12, v[92:95] offset:23040
    ds_write_b128 v12, v[96:99] offset:27648
    ds_write_b128 v12, v[100:103] offset:32256
    s_waitcnt lgkmcnt(0)
    s_barrier
    ds_read_b64_tr_b16 v[24:25], v14 offset:18432
    ds_read_b64_tr_b16 v[26:27], v14 offset:19008
    ds_read_b64_tr_b16 v[28:29], v14 offset:27648
    ds_read_b64_tr_b16 v[30:31], v14 offset:28224
    s_waitcnt lgkmcnt(0)
    ds_write_b128 v1, v[24:27] offset:16384
    ds_write_b128 v1, v[28:31] offset:17408
    ds_read_b64_tr_b16 v[24:25], v14 offset:18464
    ds_read_b64_tr_b16 v[26:27], v14 offset:19040
    ds_read_b64_tr_b16 v[28:29], v14 offset:27680
    ds_read_b64_tr_b16 v[30:31], v14 offset:28256
    s_waitcnt lgkmcnt(0)
    ds_write_b128 v1, v[24:27] offset:20480
    ds_write_b128 v1, v[28:31] offset:21504
    s_waitcnt vmcnt(5)
    ds_write_b128 v12, v[104:107] offset:0
    ds_write_b128 v12, v[108:111] offset:4608
    ds_write_b128 v12, v[112:115] offset:9216
    ds_write_b128 v12, v[116:119] offset:13824
    s_waitcnt lgkmcnt(0)
    v_min_u32 v16, 8, v150
    v_lshlrev_b32 v16, 5, v16
    v_cmp_eq_u32 vcc, 0x100, v16
    s_nop 1
    v_cndmask_b32 v16, v16, 16, vcc
    global_load_dwordx2 v[18:19], v16, s[6:7] sc1
    buffer_load_dword v17, v148, s[8:11], s77 offen sc1
    s_barrier
    ds_read_b64_tr_b16 v[24:25], v14 offset:0
    ds_read_b64_tr_b16 v[26:27], v14 offset:576
    ds_read_b64_tr_b16 v[28:29], v14 offset:9216
    ds_read_b64_tr_b16 v[30:31], v14 offset:9792
    s_waitcnt lgkmcnt(0)
    ds_write_b128 v1, v[24:27] offset:24576
    ds_write_b128 v1, v[28:31] offset:25600
    ds_read_b64_tr_b16 v[24:25], v14 offset:32
    ds_read_b64_tr_b16 v[26:27], v14 offset:608
    ds_read_b64_tr_b16 v[28:29], v14 offset:9248
    ds_read_b64_tr_b16 v[30:31], v14 offset:9824
    s_waitcnt lgkmcnt(0)
    ds_write_b128 v1, v[24:27] offset:28672
    ds_write_b128 v1, v[28:31] offset:29696
    s_waitcnt vmcnt(2)
    ds_write_b128 v12, v[120:123] offset:18432
    ds_write_b128 v12, v[124:127] offset:23040
    ds_write_b128 v12, v[128:131] offset:27648
    ds_write_b128 v12, v[132:135] offset:32256
    s_waitcnt lgkmcnt(0)
    s_barrier
    ds_read_b64_tr_b16 v[232:233], v15 offset:18432
    ds_read_b64_tr_b16 v[234:235], v15 offset:19008
    ds_read_b64_tr_b16 v[236:237], v15 offset:27648
    ds_read_b64_tr_b16 v[238:239], v15 offset:28224
    ds_read_b64_tr_b16 v[240:241], v15 offset:18560
    ds_read_b64_tr_b16 v[242:243], v15 offset:19136
    ds_read_b64_tr_b16 v[244:245], v15 offset:27776
    ds_read_b64_tr_b16 v[246:247], v15 offset:28352
    s_waitcnt lgkmcnt(0)
    s_barrier
    s_waitcnt vmcnt(0)
    s_mov_b32 s32, 0x2000
    v_cmp_ne_u32 vcc, -1, v18
    v_cmp_ne_u32 s[34:35], s32, v19
    v_readlane_b32 s36, v17, 0
    v_readlane_b32 s38, v17, 1
    v_readlane_b32 s32, v18, 8
    s_or_b32 s34, s34, vcc_lo
    s_and_b32 s34, s34, 0xff
    s_cbranch_scc1 L_chain_slow
    s_cmp_eq_u32 s32, 0
    s_cbranch_scc1 L_chain_slow
    s_and_b32 s32, s32, 2
    s_lshl_b32 s32, s32, 12
    s_min_u32 s49, s36, s38
    s_cmp_ge_u32 s49, s50
    s_cbranch_scc1 L_chain_go
L_chain_slow:
    s_cmp_lg_u32 s4, 0
    s_cbranch_scc1 Lverd_3_ok
    v_and_b32 v18, 7, v150
    v_lshlrev_b32 v18, 5, v18
    s_mov_b32 s30, 131072
Lverd_3:
    global_load_dwordx2 v[16:17], v18, s[6:7] sc1
    s_sub_u32 s30, s30, 1
    s_cbranch_scc1 L_abort
    s_mov_b32 s32, 0x2000
    s_waitcnt vmcnt(0)
    v_cmp_ne_u32 vcc, -1, v16
    v_cmp_ne_u32 s[34:35], s32, v17
    s_nop 0
    s_or_b64 vcc, vcc, s[34:35]
    s_cbranch_scc0 Lverd_3_ok
    v_lshrrev_b32 v17, 8, v17
    s_mov_b32 s32, 0
    v_readlane_b32 s33, v17, 0
    s_nop 0
    s_add_u32 s32, s32, s33
    v_readlane_b32 s33, v17, 1
    s_nop 0
    s_add_u32 s32, s32, s33
    v_readlane_b32 s33, v17, 2
    s_nop 0
    s_add_u32 s32, s32, s33
    v_readlane_b32 s33, v17, 3
    s_nop 0
    s_add_u32 s32, s32, s33
    v_readlane_b32 s33, v17, 4
    s_nop 0
    s_add_u32 s32, s32, s33
    v_readlane_b32 s33, v17, 5
    s_nop 0
    s_add_u32 s32, s32, s33
    v_readlane_b32 s33, v17, 6
    s_nop 0
    s_add_u32 s32, s32, s33
    v_readlane_b32 s33, v17, 7
    s_nop 0
    s_add_u32 s32, s32, s33
    s_cmp_eq_u32 s32, 256
    s_cbranch_scc1 L_restart_safe
    s_sleep 8
    s_branch Lverd_3
Lverd_3_ok:
    s_mov_b32 s30, 131072
Lsf_4:
    s_load_dwordx4 s[36:39], s[8:9], s77 glc
    s_sub_u32 s30, s30, 1
    s_cbranch_scc1 L_abort
    s_waitcnt lgkmcnt(0)
    s_min_u32 s49, s36, s38
    s_cmp_lt_u32 s49, s50
    s_cbranch_scc1 Lsf_4
    s_mov_b32 s30, 131072
    v_mov_b32 v16, 16
Lpol_5:
    global_load_dword v17, v16, s[6:7] sc1
    s_sub_u32 s30, s30, 1
    s_cbranch_scc1 L_abort
    s_waitcnt vmcnt(0)
    v_readfirstlane_b32 s32, v17
    s_nop 0
    s_cmp_lg_u32 s32, 0
    s_cbranch_scc1 Lpol_5_ok
    s_sleep 4
    s_branch Lpol_5
Lpol_5_ok:
    s_and_b32 s32, s32, 2
    s_lshl_b32 s32, s32, 12
L_chain_go:
    s_add_u32 s66, s66, s32
    s_add_u32 s67, s67, s32
    s_add_u32 s61, s61, s32
    s_add_u32 s62, s62, s32
    s_add_u32 s64, s64, s32
    s_add_u32 s76, s76, s32
    s_add_u32 s55, s55, s32
    s_add_u32 s56, s56, s32
    s_add_u32 s46, s46, s32
    s_add_u32 m0, s40, 24576
    s_nop 0
    buffer_load_dwordx4 v0, s[8:11], s62 offen lds
    buffer_load_dwordx4 v0, s[8:11], s62 offen offset:1024 lds
    s_add_u32 m0, s40, 16384
    s_nop 0
    buffer_load_dwordx4 v0, s[8:11], s61 offen lds
    buffer_load_dwordx4 v0, s[8:11], s61 offen offset:1024 lds
    s_add_u32 s61, s61, 524288
    s_add_u32 s62, s62, 524288
    s_cmp_lg_u32 s4, 0
    s_cbranch_scc1 L_top_s0
L_top_f0:
    ds_read_b128 v[48:51], v1 offset:0
    v_mov_b64 v[116:117], 0
    ds_read_b128 v[52:55], v1 offset:1024
    v_mov_b64 v[118:119], 0
    ds_read_b128 v[56:59], v1 offset:2048
    v_mov_b64 v[120:121], 0
    ds_read_b128 v[60:63], v1 offset:3072
    v_mov_b64 v[122:123], 0
    ds_read_b128 v[64:67], v1 offset:4096
    v_mov_b64 v[124:125], 0
    ds_read_b128 v[68:71], v1 offset:5120
    v_mov_b64 v[126:127], 0
    ds_read_b128 v[72:75], v1 offset:6144
    v_mov_b64 v[128:129], 0
    ds_read_b128 v[76:79], v1 offset:7168
    v_mov_b64 v[130:131], 0
    ds_read_b128 v[80:83], v1 offset:8192
    v_mov_b64 v[132:133], 0
    ds_read_b128 v[84:87], v1 offset:9216
    v_mov_b64 v[134:135], 0
    ds_read_b128 v[88:91], v1 offset:10240
    v_mov_b64 v[136:137], 0
    ds_read_b128 v[92:95], v1 offset:11264
    v_mov_b64 v[138:139], 0
    s_waitcnt lgkmcnt(8)
    ds_read_b128 v[96:99], v1 offset:12288
    ds_read_b128 v[100:103], v1 offset:13312
    ds_read_b128 v[104:107], v1 offset:14336
    ds_read_b128 v[108:111], v1 offset:15360
    s_branch L_top3_f0
L_top2_f0:
    s_waitcnt lgkmcnt(8)
    ds_read_b128 v[96:99], v1 offset:12288
    ds_read_b128 v[100:103], v1 offset:13312
    ds_read_b128 v[104:107], v1 offset:14336
    ds_read_b128 v[108:111], v1 offset:15360
    s_nop 7
    s_nop 7
    s_nop 7
    s_nop 7
    s_nop 7
    s_nop 7
L_top3_f0:
    s_add_u32 m0, s51, 0
    s_nop 0
    buffer_load_dwordx4 v0, s[8:11], s53 offen sc1 lds
    s_add_u32 m0, s52, 0
    s_nop 0
    buffer_load_dword v2, s[8:11], s54 offen sc1 lds
    v_add_u32 v115, s45, v0
    s_and_b32 s59, s48, 1
    s_xor_b32 s57, s59, 1
    s_mov_b32 s63, s65
    s_xor_b32 s65, s65, s59
    s_xor_b32 s31, s31, 57344
    v_xor_b32 v149, 8192, v149
    s_nop 7
    s_nop 7
    s_nop 7
    s_nop 7
    s_add_u32 m0, s51, 5120
    s_nop 0
    buffer_load_dwordx4 v0, s[8:11], s55 offen sc1 lds
    s_add_u32 m0, s52, 5120
    s_nop 0
    buffer_load_dword v2, s[8:11], s56 offen sc1 lds
    s_add_u32 m0, s51, 5120
    s_waitcnt vmcnt(2)
    s_barrier
    ds_read_b128 v[8:11], v0 offset:0
    ds_read_b128 v[12:15], v0 offset:1024
    ds_read_b128 v[16:19], v0 offset:2048
    ds_read_b128 v[20:23], v0 offset:3072
    ds_read_b128 v[24:27], v0 offset:4096
    s_waitcnt lgkmcnt(4)
    v_smfmac_f32_16x16x64_bf16 v[132:135], v[8:11], v[48:55], v144
    buffer_load_dwordx4 v0, s[8:11], s55 offen sc1 lds
    s_add_u32 m0, s52, 5120
    v_smfmac_f32_16x16x64_bf16 v[136:139], v[8:11], v[56:63], v144
    s_waitcnt lgkmcnt(3)
    buffer_load_dword v2, s[8:11], s56 offen sc1 lds
    v_smfmac_f32_16x16x64_bf16 v[132:135], v[12:15], v[64:71], v144
    v_smfmac_f32_16x16x64_bf16 v[136:139], v[12:15], v[72:79], v144
    s_waitcnt lgkmcnt(2)
    v_smfmac_f32_16x16x64_bf16 v[132:135], v[16:19], v[80:87], v144
    v_smfmac_f32_16x16x64_bf16 v[136:139], v[16:19], v[88:95], v144
    s_waitcnt lgkmcnt(1)
    v_smfmac_f32_16x16x64_bf16 v[132:135], v[20:23], v[96:103], v144
    s_waitcnt lgkmcnt(0)
    v_bitop3_b32 v151, v8, v12, s57 bitop3:0x7e
    v_smfmac_f32_16x16x64_bf16 v[136:139], v[20:23], v[104:111], v144
    v_bitop3_b32 v151, v151, v16, s57 bitop3:0xf6
    v_smfmac_f32_16x16x64_bf16 v[132:135], v[24:27], a[160:167], v144
    v_bitop3_b32 v150, v20, v24, s57 bitop3:0x7e
    v_smfmac_f32_16x16x64_bf16 v[136:139], v[24:27], a[168:175], v144
    v_bitop3_b32 v151, v151, v150, 1 bitop3:0xa8
    v_smfmac_f32_16x16x64_bf16 v[116:119], v[8:11], a[0:7], v144
    v_cmp_ne_u32 vcc, 0, v151
    v_smfmac_f32_16x16x64_bf16 v[120:123], v[8:11], a[8:15], v144
    v_smfmac_f32_16x16x64_bf16 v[116:119], v[12:15], a[32:39], v144
    s_cbranch_vccnz L_rl_f0
L_okl_f0:
    v_add_f32 v132, v132, v134
    v_smfmac_f32_16x16x64_bf16 v[120:123], v[12:15], a[40:47], v144
    ds_read_b128 v[48:51], v0 offset:16384
    v_add_f32 v133, v133, v135
    v_smfmac_f32_16x16x64_bf16 v[116:119], v[16:19], a[64:71], v144
    ds_read_b128 v[52:55], v0 offset:17408
    v_add_f32 v136, v136, v138
    v_smfmac_f32_16x16x64_bf16 v[120:123], v[16:19], a[72:79], v144
    ds_read_b128 v[56:59], v0 offset:18432
    v_add_f32 v137, v137, v139
    v_smfmac_f32_16x16x64_bf16 v[116:119], v[20:23], a[96:103], v144
    ds_read_b128 v[60:63], v0 offset:19456
    v_cvt_pk_bf16_f32 v137, v136, v137
    v_smfmac_f32_16x16x64_bf16 v[120:123], v[20:23], a[104:111], v144
    ds_read_b128 v[64:67], v0 offset:20480
    v_cvt_pk_bf16_f32 v136, v132, v133
    v_smfmac_f32_16x16x64_bf16 v[116:119], v[24:27], a[128:135], v144
    ds_read_b128 v[68:71], v0 offset:21504
    v_and_or_b32 v136, v136, -2, s63
    v_smfmac_f32_16x16x64_bf16 v[120:123], v[24:27], a[136:143], v144
    buffer_store_dwordx2 v[136:137], v148, s[8:11], s66 offen sc1
    v_smfmac_f32_16x16x64_bf16 v[124:127], v[8:11], a[16:23], v144
    ds_read_b128 v[72:75], v0 offset:22528
    v_mov_b64 v[112:113], v[136:137]
    v_smfmac_f32_16x16x64_bf16 v[128:131], v[8:11], a[24:31], v144
    ds_read_b128 v[76:79], v0 offset:23552
    v_mov_b64 v[132:133], 0
    v_smfmac_f32_16x16x64_bf16 v[124:127], v[12:15], a[48:55], v144
    v_mov_b64 v[134:135], 0
    v_smfmac_f32_16x16x64_bf16 v[128:131], v[12:15], a[56:63], v144
    s_waitcnt vmcnt(1)
    s_barrier
    ds_read_b128 v[28:31], v0 offset:5120
    ds_read_b128 v[32:35], v0 offset:6144
    v_smfmac_f32_16x16x64_bf16 v[124:127], v[16:19], a[80:87], v144
    ds_read_b128 v[36:39], v0 offset:7168
    v_smfmac_f32_16x16x64_bf16 v[128:131], v[16:19], a[88:95], v144
    ds_read_b128 v[40:43], v0 offset:8192
    v_smfmac_f32_16x16x64_bf16 v[124:127], v[20:23], a[112:119], v144
    ds_read_b128 v[44:47], v0 offset:9216
    v_smfmac_f32_16x16x64_bf16 v[128:131], v[20:23], a[120:127], v144
    s_waitcnt lgkmcnt(3)
    v_bitop3_b32 v151, v28, v32, s63 bitop3:0x7e
    v_and_b32 v151, 1, v151
    v_cmp_ne_u32 vcc, 0, v151
    v_smfmac_f32_16x16x64_bf16 v[124:127], v[24:27], a[144:151], v144
    v_smfmac_f32_16x16x64_bf16 v[128:131], v[24:27], a[152:159], v144
    s_cbranch_vccnz L_ra_f0
L_oka_f0:
    v_smfmac_f32_16x16x64_bf16 v[116:119], v[28:31], a[176:183], v144
    s_mov_b32 m0, s31
    v_smfmac_f32_16x16x64_bf16 v[120:123], v[28:31], a[184:191], v144
    buffer_load_dwordx4 v0, s[8:11], s62 offen lds
    v_smfmac_f32_16x16x64_bf16 v[116:119], v[32:35], a[208:215], v144
    s_waitcnt lgkmcnt(0)
    v_bitop3_b32 v151, v36, v40, s63 bitop3:0x7e
    v_smfmac_f32_16x16x64_bf16 v[120:123], v[32:35], a[216:223], v144
    ds_read_b128 v[8:11], v1 offset:16384
    v_bitop3_b32 v151, v151, v44, s63 bitop3:0xf6
    v_smfmac_f32_16x16x64_bf16 v[124:127], v[28:31], a[192:199], v144
    ds_read_b128 v[12:15], v1 offset:17408
    s_mov_b32 m0, s31
    v_and_b32 v151, 1, v151
    v_smfmac_f32_16x16x64_bf16 v[128:131], v[28:31], a[200:207], v144
    ds_read_b128 v[16:19], v1 offset:18432
    buffer_load_dwordx4 v0, s[8:11], s62 offen offset:1024 lds
    v_cmp_ne_u32 vcc, 0, v151
    v_smfmac_f32_16x16x64_bf16 v[124:127], v[32:35], a[224:231], v144
    ds_read_b128 v[20:23], v1 offset:19456
    v_smfmac_f32_16x16x64_bf16 v[128:131], v[32:35], a[232:239], v144
    s_cbranch_vccnz L_rb_f0
L_okb_f0:
    v_smfmac_f32_16x16x64_bf16 v[116:119], v[36:39], a[240:247], v144
    v_smfmac_f32_16x16x64_bf16 v[120:123], v[36:39], a[248:255], v144
    ds_read_b128 v[24:27], v1 offset:20480
    v_smfmac_f32_16x16x64_bf16 v[116:119], v[40:43], v[168:175], v144
    ds_read_b128 v[28:31], v1 offset:21504
    v_smfmac_f32_16x16x64_bf16 v[120:123], v[40:43], v[176:183], v144
    ds_read_b128 v[32:35], v1 offset:22528
    v_smfmac_f32_16x16x64_bf16 v[116:119], v[44:47], v[200:207], v144
    v_smfmac_f32_16x16x64_bf16 v[120:123], v[44:47], v[208:215], v144
    v_smfmac_f32_16x16x64_bf16 v[124:127], v[36:39], v[152:159], v144
    v_add_f32 v116, v116, v118
    v_add_f32 v117, v117, v119
    v_smfmac_f32_16x16x64_bf16 v[128:131], v[36:39], v[160:167], v144
    v_add_f32 v120, v120, v122
    v_add_f32 v121, v121, v123
    v_cvt_pk_bf16_f32 v116, v116, v120
    v_cvt_pk_bf16_f32 v117, v117, v121
    v_smfmac_f32_16x16x64_bf16 v[124:127], v[40:43], v[184:191], v144
    ds_write2_b32 v4, v116, v117 offset0:0 offset1:4
    v_smfmac_f32_16x16x64_bf16 v[128:131], v[40:43], v[192:199], v144
    buffer_load_dwordx2 v[138:139], v148, s[8:11], s67 offen sc1
    v_smfmac_f32_16x16x64_bf16 v[124:127], v[44:47], v[216:223], v144
    v_mov_b64 v[40:41], 0
    v_smfmac_f32_16x16x64_bf16 v[128:131], v[44:47], v[224:231], v144
    v_mov_b64 v[42:43], 0
    v_mfma_f32_16x16x32_bf16 v[96:99], v[140:143], v[140:143], 0
    s_waitcnt lgkmcnt(0)
    s_barrier
    ds_read_b128 v[80:83], v7 offset:10240
    ds_read_b128 v[84:87], v7 offset:10752
    v_add_f32 v124, v124, v126
    v_add_f32 v125, v125, v127
    v_add_f32 v128, v128, v130
    v_add_f32 v129, v129, v131
    v_cvt_pk_bf16_f32 v124, v124, v128
    v_cvt_pk_bf16_f32 v125, v125, v129
    ds_write2_b32 v5, v124, v125 offset0:0 offset1:4
    ds_read_b128 v[88:91], v7 offset:11264
    s_waitcnt lgkmcnt(3)
    v_mfma_f32_16x16x32_bf16 v[104:107], v[48:51], v[80:83], 0
    ds_read_b128 v[92:95], v7 offset:11776
    v_mfma_f32_16x16x32_bf16 v[108:111], v[64:67], v[80:83], 0
    s_waitcnt lgkmcnt(3)
    v_mfma_f32_16x16x32_bf16 v[104:107], v[52:55], v[84:87], v[104:107]
    buffer_load_dwordx2 v[138:139], v148, s[8:11], s67 offen sc1
    v_mfma_f32_16x16x32_bf16 v[108:111], v[68:71], v[84:87], v[108:111]
    s_add_u32 m0, s40, 16384
    s_waitcnt lgkmcnt(1)
    s_barrier
    ds_read_b128 v[96:99], v0 offset:12288
    v_mfma_f32_16x16x32_bf16 v[104:107], v[56:59], v[88:91], v[104:107]
    ds_read_b128 v[100:103], v0 offset:13312
    ds_read_b32 v114, v115 offset:12288
    v_mfma_f32_16x16x32_bf16 v[108:111], v[72:75], v[88:91], v[108:111]
    buffer_load_dwordx4 v0, s[8:11], s61 offen lds
    s_add_u32 m0, s40, 16384
    s_waitcnt lgkmcnt(3)
    v_mfma_f32_16x16x32_bf16 v[104:107], v[60:63], v[92:95], v[104:107]
    ds_read_b128 v[48:51], v149 offset:24576
    s_cmp_eq_u32 s48, 63
    v_mfma_f32_16x16x32_bf16 v[108:111], v[76:79], v[92:95], v[108:111]
    ds_read_b128 v[52:55], v149 offset:25600
    s_cbranch_scc1 L_chain_final
    s_waitcnt lgkmcnt(4)
    v_smfmac_f32_16x16x64_bf16 v[40:43], v[96:99], v[80:87], v144
    buffer_load_dwordx4 v0, s[8:11], s61 offen offset:1024 lds
    s_waitcnt lgkmcnt(2)
    v_smfmac_f32_16x16x64_bf16 v[40:43], v[100:103], v[88:95], v144
    buffer_store_dwordx4 v[112:115], v0, s[8:11], s64 offen sc1
    v_max3_f32 v150, v104, v105, v106
    v_max3_f32 v150, v150, v107, v108
    v_max3_f32 v150, v150, v109, v110
    v_max_f32 v150, v150, v111
    v_mov_b64 v[92:93], s[70:71]
    s_nop 1
    v_add_f32 v40, v40, v42
    v_add_f32 v41, v41, v43
    v_max3_f32 v42, v150, v40, v41
    v_max3_f32 v43, v150, v40, v41
    v_mov_b64 v[88:89], s[68:69]
    v_mov_b64 v[90:91], s[68:69]
    v_permlane32_swap_b32 v42, v43
    v_max_f32 v150, v42, v43
    v_max_f32 v42, v42, v43
    s_add_u32 s50, s48, 3
    s_min_u32 s50, s50, 64
    v_permlane16_swap_b32 v150, v42
    v_max_f32 v150, v150, v42
    v_mul_f32 v150, s43, v150
    v_pk_fma_f32 v[104:105], v[104:105], s[72:73], v[150:151] op_sel_hi:[1,1,0]
    v_pk_fma_f32 v[106:107], v[106:107], s[72:73], v[150:151] op_sel_hi:[1,1,0]
    v_pk_fma_f32 v[108:109], v[108:109], s[72:73], v[150:151] op_sel_hi:[1,1,0]
    v_pk_fma_f32 v[110:111], v[110:111], s[72:73], v[150:151] op_sel_hi:[1,1,0]
    v_pk_fma_f32 v[40:41], v[40:41], s[72:73], v[150:151] op_sel_hi:[1,1,0]
    v_exp_f32 v104, v104
    v_exp_f32 v105, v105
    v_exp_f32 v106, v106
    v_exp_f32 v107, v107
    v_exp_f32 v108, v108
    v_exp_f32 v109, v109
    v_exp_f32 v110, v110
    v_exp_f32 v111, v111
    v_cvt_pk_bf16_f32 v104, v104, v105
    v_cvt_pk_bf16_f32 v105, v106, v107
    v_cvt_pk_bf16_f32 v106, v108, v109
    v_cvt_pk_bf16_f32 v107, v110, v111
    v_exp_f32 v40, v40
    s_waitcnt lgkmcnt(0)
    v_mfma_f32_16x16x32_bf16 v[96:99], v[88:91], v[104:107], 0
    ds_read_b128 v[36:39], v1 offset:23552
    v_exp_f32 v41, v41
    v_mfma_f32_16x16x32_bf16 v[80:83], v[48:51], v[104:107], 0
    ds_read_b128 v[56:59], v1 offset:24576
    v_cvt_pk_bf16_f32 v42, v40, v41
    v_cvt_pk_bf16_f32 v43, v40, v41
    v_mfma_f32_16x16x32_bf16 v[84:87], v[52:55], v[104:107], 0
    s_waitcnt vmcnt(3)
    v_and_b32 v151, 1, v138
    v_swap_b32 v137, v138
    v_mfma_f32_16x16x16_bf16 v[96:99], v[92:93], v[42:43], v[96:99]
    ds_read_b128 v[60:63], v1 offset:25600
    v_cmp_ne_u32 vcc, s63, v151
    v_mfma_f32_16x16x16_bf16 v[80:83], v[136:137], v[42:43], v[80:83]
    ds_read_b128 v[64:67], v1 offset:26624
    v_mfma_f32_16x16x16_bf16 v[84:87], v[138:139], v[42:43], v[84:87]
    s_cbranch_vccnz L_rv_f0
L_okv_f0:
    v_rcp_f32 v96, v96
    s_nop 1
    v_mul_f32 v80, v80, v96
    v_mul_f32 v81, v81, v96
    v_mul_f32 v82, v82, v96
    v_mul_f32 v83, v83, v96
    s_mov_b64 exec, s[74:75]
    v_pk_mul_f32 v[80:81], v[84:85], v[96:97] op_sel_hi:[1,0]
    v_pk_mul_f32 v[82:83], v[86:87], v[96:97] op_sel_hi:[1,0]
    s_mov_b64 exec, -1
    v_cvt_pk_bf16_f32 v80, v80, v81
    v_cvt_pk_bf16_f32 v81, v82, v83
    ds_write_b64 v6, v[80:81]
    v_mfma_f32_16x16x32_bf16 v[116:119], v[132:135], v[140:143], 0
    s_add_u32 s48, s48, 1
    s_xor_b32 s46, s46, 32768
    s_xor_b32 s55, s55, 32768
    v_mfma_f32_16x16x32_bf16 v[120:123], v[132:135], v[140:143], 0
    s_xor_b32 s56, s56, 32768
    s_xor_b32 s66, s66, 262144
    s_xor_b32 s67, s67, 262144
    v_mfma_f32_16x16x32_bf16 v[124:127], v[132:135], v[140:143], 0
    s_cmp_lt_u32 s5, 2
    v_mfma_f32_16x16x32_bf16 v[128:131], v[132:135], v[140:143], 0
    s_waitcnt lgkmcnt(0)
    s_barrier
    ds_read_b128 v[40:43], v0 offset:14336
    ds_read_b128 v[44:47], v0 offset:15360
    v_mfma_f32_16x16x32_bf16 v[96:99], v[140:143], v[140:143], 0
    ds_read_b128 v[68:71], v1 offset:27648
    v_mfma_f32_16x16x32_bf16 v[96:99], v[140:143], v[140:143], 0
    ds_read_b128 v[72:75], v1 offset:28672
    ds_read_b128 v[76:79], v1 offset:29696
    s_waitcnt lgkmcnt(4)
    v_smfmac_f32_16x16x64_bf16 v[132:135], v[40:43], v[232:239], v144
    s_waitcnt lgkmcnt(3)
    v_smfmac_f32_16x16x64_bf16 v[132:135], v[44:47], v[240:247], v144
    v_smfmac_f32_16x16x64_bf16 v[116:119], v[40:43], v[248:255], v144
    v_smfmac_f32_16x16x64_bf16 v[116:119], v[44:47], v[8:15], v144
    v_add_f32 v132, v132, v134
    v_smfmac_f32_16x16x64_bf16 v[120:123], v[40:43], v[16:23], v144
    v_add_f32 v133, v133, v135
    v_smfmac_f32_16x16x64_bf16 v[120:123], v[44:47], v[24:31], v144
    v_cvt_pk_bf16_f32 v112, v132, v133
    v_smfmac_f32_16x16x64_bf16 v[124:127], v[40:43], v[32:39], v144
    s_waitcnt lgkmcnt(0)
    v_and_or_b32 v112, v112, -2, s57
    v_smfmac_f32_16x16x64_bf16 v[124:127], v[44:47], v[56:63], v144
    buffer_store_dword v112, v146, s[8:11], 0 offen
    v_add_f32 v116, v116, v118
    v_smfmac_f32_16x16x64_bf16 v[128:131], v[40:43], v[64:71], v144
    v_add_f32 v117, v117, v119
    v_smfmac_f32_16x16x64_bf16 v[128:131], v[44:47], v[72:79], v144
    v_cvt_pk_bf16_f32 v104, v116, v117
    v_and_or_b32 v104, v104, -2, s57
    v_add_f32 v120, v120, v122
    v_add_f32 v121, v121, v123
    v_cvt_pk_bf16_f32 v105, v120, v121
    v_add_f32 v124, v124, v126
    v_add_f32 v125, v125, v127
    v_cvt_pk_bf16_f32 v106, v124, v125
    v_add_f32 v128, v128, v130
    v_add_f32 v129, v129, v131
    v_cvt_pk_bf16_f32 v107, v128, v129
    buffer_store_dwordx4 v[104:107], v145, s[8:11], 0 offen
    s_cbranch_scc0 L_n0_f0
    v_mov_b64 v[40:41], 0
    v_mov_b64 v[42:43], 0
    s_mov_b32 s30, 131072
    ds_read_b128 v[48:51], v1 offset:0
    v_mov_b64 v[116:117], 0
    ds_read_b128 v[52:55], v1 offset:1024
    v_mov_b64 v[118:119], 0
    ds_read_b128 v[56:59], v1 offset:2048
    v_mov_b64 v[120:121], 0
    ds_read_b128 v[60:63], v1 offset:3072
    v_mov_b64 v[122:123], 0
    s_nop 7
    s_nop 7
    s_nop 7
    buffer_load_dwordx4 v[8:11], v0, s[8:11], s60 offen offset:0 sc1
    buffer_load_dwordx4 v[12:15], v0, s[8:11], s60 offen offset:1024 sc1
    ds_read_b128 v[64:67], v1 offset:4096
    v_mov_b64 v[124:125], 0
    ds_read_b128 v[68:71], v1 offset:5120
    v_mov_b64 v[126:127], 0
    ds_read_b128 v[72:75], v1 offset:6144
    v_mov_b64 v[128:129], 0
    ds_read_b128 v[76:79], v1 offset:7168
    v_mov_b64 v[130:131], 0
    s_nop 7
    buffer_load_dwordx4 v[16:19], v0, s[8:11], s60 offen offset:0 sc1
    buffer_load_dwordx4 v[20:23], v0, s[8:11], s60 offen offset:1024 sc1
    ds_read_b128 v[80:83], v1 offset:8192
    v_mov_b64 v[132:133], 0
    ds_read_b128 v[84:87], v1 offset:9216
    v_mov_b64 v[134:135], 0
    ds_read_b128 v[88:91], v1 offset:10240
    v_mov_b64 v[136:137], 0
    ds_read_b128 v[92:95], v1 offset:11264
    v_mov_b64 v[138:139], 0
    s_nop 7
    buffer_load_dwordx4 v[24:27], v0, s[8:11], s60 offen offset:0 sc1
    buffer_load_dwordx4 v[28:31], v0, s[8:11], s60 offen offset:1024 sc1
L_p1_f0:
    s_waitcnt vmcnt(4)
    v_smfmac_f32_16x16x64_bf16 v[40:43], v[140:143], v[8:15], v144
    v_bitop3_b32 v151, v8, v12, s57 bitop3:0x7e
    v_and_b32 v151, 1, v151
    v_cmp_ne_u32 vcc, 0, v151
    s_nop 3
    s_cbranch_vccz L_p1_f0_ok
    buffer_load_dwordx4 v[8:11], v0, s[8:11], s60 offen offset:0 sc1
    buffer_load_dwordx4 v[12:15], v0, s[8:11], s60 offen offset:1024 sc1
    v_mov_b64 v[40:41], 0
    v_mov_b64 v[42:43], 0
    s_waitcnt vmcnt(4)
    s_nop 0
    v_smfmac_f32_16x16x64_bf16 v[40:43], v[140:143], v[16:23], v144
    v_bitop3_b32 v151, v16, v20, s57 bitop3:0x7e
    v_and_b32 v151, 1, v151
    v_cmp_ne_u32 vcc, 0, v151
    s_nop 3
    s_cbranch_vccz L_p1_f0_ok
    buffer_load_dwordx4 v[16:19], v0, s[8:11], s60 offen offset:0 sc1
    buffer_load_dwordx4 v[20:23], v0, s[8:11], s60 offen offset:1024 sc1
    v_mov_b64 v[40:41], 0
    v_mov_b64 v[42:43], 0
    s_waitcnt vmcnt(4)
    s_nop 0
    v_smfmac_f32_16x16x64_bf16 v[40:43], v[140:143], v[24:31], v144
    v_bitop3_b32 v151, v24, v28, s57 bitop3:0x7e
    v_and_b32 v151, 1, v151
    v_cmp_ne_u32 vcc, 0, v151
    s_nop 3
    s_cbranch_vccz L_p1_f0_ok
    buffer_load_dwordx4 v[24:27], v0, s[8:11], s60 offen offset:0 sc1
    buffer_load_dwordx4 v[28:31], v0, s[8:11], s60 offen offset:1024 sc1
    v_mov_b64 v[40:41], 0
    v_mov_b64 v[42:43], 0
    s_sub_u32 s30, s30, 1
    s_cbranch_scc0 L_p1_f0
    s_branch L_abort
L_p1_f0_ok:
    v_add_f32_dpp v40, v40, v40 row_ror:4 row_mask:0xf bank_mask:0xf
    v_add_f32_dpp v41, v41, v41 row_ror:4 row_mask:0xf bank_mask:0xf
    v_add_f32_dpp v42, v42, v42 row_ror:4 row_mask:0xf bank_mask:0xf
    v_add_f32_dpp v43, v43, v43 row_ror:4 row_mask:0xf bank_mask:0xf
    v_add_f32_dpp v40, v40, v40 row_ror:8 row_mask:0xf bank_mask:0xf
    v_add_f32_dpp v41, v41, v41 row_ror:8 row_mask:0xf bank_mask:0xf
    v_add_f32_dpp v42, v42, v42 row_ror:8 row_mask:0xf bank_mask:0xf
    v_add_f32_dpp v43, v43, v43 row_ror:8 row_mask:0xf bank_mask:0xf
    v_cvt_pk_bf16_f32 v44, v40, v42
    v_cvt_pk_bf16_f32 v45, v41, v43
    s_nop 0
    v_mov_b32_dpp v46, v44 quad_perm:[1,0,3,2] row_mask:0xf bank_mask:0xf
    v_mov_b32_dpp v47, v45 quad_perm:[1,0,3,2] row_mask:0xf bank_mask:0xf
    v_and_or_b32 v44, v44, -2, s59
    buffer_store_dwordx4 v[44:47], v147, s[8:11], s58 offen
    s_nop 1
    v_and_or_b32 v44, v44, -2, s65
    s_barrier
    buffer_store_dwordx4 v[44:47], v147, s[8:11], s46 offen sc1
L_upd_f0:
    s_add_u32 s61, s61, 524288
    s_add_u32 s62, s62, 524288
    s_add_u32 s64, s64, 524288
    s_and_b32 s32, s61, 1572864
    s_cselect_b32 s32, 0, 8192
    s_xor_b32 s61, s61, s32
    s_xor_b32 s62, s62, s32
    s_and_b32 s32, s64, 1572864
    s_cselect_b32 s32, 0, 8192
    s_xor_b32 s64, s64, s32
    s_branch L_top2_f0
L_rl_f0:
    s_mov_b32 s30, 131072
L_rl_f0_l:
    s_waitcnt lgkmcnt(0)
    s_barrier
    s_add_u32 m0, s51, 0
    s_nop 0
    buffer_load_dwordx4 v0, s[8:11], s53 offen sc1 lds
    s_add_u32 m0, s52, 0
    s_nop 0
    buffer_load_dword v2, s[8:11], s54 offen sc1 lds
    s_sub_u32 s30, s30, 1
    s_cbranch_scc1 L_abort
    s_waitcnt vmcnt(0)
    s_barrier
    ds_read_b128 v[8:11], v0 offset:0
    ds_read_b128 v[12:15], v0 offset:1024
    ds_read_b128 v[16:19], v0 offset:2048
    ds_read_b128 v[20:23], v0 offset:3072
    ds_read_b128 v[24:27], v0 offset:4096
    s_waitcnt lgkmcnt(0)
    v_bitop3_b32 v151, v8, v12, s57 bitop3:0x7e
    v_bitop3_b32 v151, v151, v16, s57 bitop3:0xf6
    v_bitop3_b32 v150, v20, v24, s57 bitop3:0x7e
    v_bitop3_b32 v151, v151, v150, 1 bitop3:0xa8
    v_cmp_ne_u32 vcc, 0, v151
    s_cbranch_vccnz L_rl_f0_l
    v_mov_b64 v[116:117], 0
    v_mov_b64 v[118:119], 0
    v_mov_b64 v[120:121], 0
    v_mov_b64 v[122:123], 0
    v_mov_b64 v[124:125], 0
    v_mov_b64 v[126:127], 0
    v_mov_b64 v[128:129], 0
    v_mov_b64 v[130:131], 0
    v_mov_b64 v[132:133], 0
    v_mov_b64 v[134:135], 0
    v_mov_b64 v[136:137], 0
    v_mov_b64 v[138:139], 0
    v_smfmac_f32_16x16x64_bf16 v[132:135], v[8:11], v[48:55], v144
    v_smfmac_f32_16x16x64_bf16 v[136:139], v[8:11], v[56:63], v144
    v_smfmac_f32_16x16x64_bf16 v[132:135], v[12:15], v[64:71], v144
    v_smfmac_f32_16x16x64_bf16 v[136:139], v[12:15], v[72:79], v144
    v_smfmac_f32_16x16x64_bf16 v[132:135], v[16:19], v[80:87], v144
    v_smfmac_f32_16x16x64_bf16 v[136:139], v[16:19], v[88:95], v144
    v_smfmac_f32_16x16x64_bf16 v[132:135], v[20:23], v[96:103], v144
    v_smfmac_f32_16x16x64_bf16 v[136:139], v[20:23], v[104:111], v144
    v_smfmac_f32_16x16x64_bf16 v[132:135], v[24:27], a[160:167], v144
    v_smfmac_f32_16x16x64_bf16 v[136:139], v[24:27], a[168:175], v144
    v_smfmac_f32_16x16x64_bf16 v[116:119], v[8:11], a[0:7], v144
    v_smfmac_f32_16x16x64_bf16 v[120:123], v[8:11], a[8:15], v144
    v_smfmac_f32_16x16x64_bf16 v[116:119], v[12:15], a[32:39], v144
    s_branch L_okl_f0
L_ra_f0:
L_ra_f0x:
    s_mov_b32 s30, 131072
L_ra_f0x_l:
    s_waitcnt lgkmcnt(0)
    s_barrier
    s_add_u32 m0, s51, 5120
    s_nop 0
    buffer_load_dwordx4 v0, s[8:11], s55 offen sc1 lds
    s_add_u32 m0, s52, 5120
    s_nop 0
    buffer_load_dword v2, s[8:11], s56 offen sc1 lds
    s_sub_u32 s30, s30, 1
    s_cbranch_scc1 L_abort
    s_waitcnt vmcnt(0)
    s_barrier
    ds_read_b128 v[28:31], v0 offset:5120
    ds_read_b128 v[32:35], v0 offset:6144
    ds_read_b128 v[36:39], v0 offset:7168
    ds_read_b128 v[40:43], v0 offset:8192
    ds_read_b128 v[44:47], v0 offset:9216
    s_waitcnt lgkmcnt(0)
    v_bitop3_b32 v151, v28, v32, s63 bitop3:0x7e
    v_bitop3_b32 v151, v151, v36, s63 bitop3:0xf6
    v_bitop3_b32 v150, v40, v44, s63 bitop3:0x7e
    v_bitop3_b32 v151, v151, v150, 1 bitop3:0xa8
    v_cmp_ne_u32 vcc, 0, v151
    s_cbranch_vccnz L_ra_f0x_l
    s_branch L_oka_f0
L_rb_f0:
L_rb_f0x:
    s_mov_b32 s30, 131072
L_rb_f0x_l:
    s_waitcnt lgkmcnt(0)
    s_barrier
    s_add_u32 m0, s51, 5120
    s_nop 0
    buffer_load_dwordx4 v0, s[8:11], s55 offen sc1 lds
    s_add_u32 m0, s52, 5120
    s_nop 0
    buffer_load_dword v2, s[8:11], s56 offen sc1 lds
    s_sub_u32 s30, s30, 1
    s_cbranch_scc1 L_abort
    s_waitcnt vmcnt(0)
    s_barrier
    ds_read_b128 v[36:39], v0 offset:7168
    ds_read_b128 v[40:43], v0 offset:8192
    ds_read_b128 v[44:47], v0 offset:9216
    s_waitcnt lgkmcnt(0)
    v_bitop3_b32 v151, v36, v40, s63 bitop3:0x7e
    v_bitop3_b32 v151, v151, v44, s63 bitop3:0xf6
    v_and_b32 v151, 1, v151
    v_cmp_ne_u32 vcc, 0, v151
    s_cbranch_vccnz L_rb_f0x_l
    s_branch L_okb_f0
L_rv_f0:
    v_swap_b32 v137, v138
    s_mov_b32 s30, 131072
L_rv_f0_l:
    s_mov_b64 exec, vcc
    buffer_load_dwordx2 v[138:139], v148, s[8:11], s67 offen sc1
    s_sub_u32 s30, s30, 1
    s_cbranch_scc1 L_abort
    s_waitcnt vmcnt(0)
    v_and_b32 v151, 1, v138
    v_cmp_ne_u32 vcc, s63, v151
    s_cbranch_vccnz L_rv_f0_l
    s_mov_b64 exec, -1
    v_swap_b32 v137, v138
    v_mfma_f32_16x16x32_bf16 v[80:83], v[48:51], v[104:107], 0
    v_mfma_f32_16x16x32_bf16 v[84:87], v[52:55], v[104:107], 0
    v_mfma_f32_16x16x16_bf16 v[80:83], v[136:137], v[42:43], v[80:83]
    v_mfma_f32_16x16x16_bf16 v[84:87], v[138:139], v[42:43], v[84:87]
    s_nop 7
    s_branch L_okv_f0
L_n0_f0:
    s_cmp_eq_u32 s5, 3
    s_cbranch_scc1 L_n3_f0
    v_cmp_eq_u32 vcc, 0x4444, v144
    s_nop 1
    v_cndmask_b32 v32, 0, v140, vcc
    v_cndmask_b32 v34, 0, v141, vcc
    v_sub_u32 v33, v140, v32
    v_sub_u32 v35, v141, v34
    s_mov_b32 s30, 131072
    ds_read_b128 v[48:51], v1 offset:0
    v_mov_b64 v[116:117], 0
    ds_read_b128 v[52:55], v1 offset:1024
    v_mov_b64 v[118:119], 0
    ds_read_b128 v[56:59], v1 offset:2048
    v_mov_b64 v[120:121], 0
    ds_read_b128 v[60:63], v1 offset:3072
    v_mov_b64 v[122:123], 0
    s_nop 7
    s_nop 7
    s_nop 7
    buffer_load_dwordx4 v[8:11], v0, s[8:11], s60 offen offset:0 sc1
    ds_read_b128 v[64:67], v1 offset:4096
    v_mov_b64 v[124:125], 0
    ds_read_b128 v[68:71], v1 offset:5120
    v_mov_b64 v[126:127], 0
    ds_read_b128 v[72:75], v1 offset:6144
    v_mov_b64 v[128:129], 0
    ds_read_b128 v[76:79], v1 offset:7168
    v_mov_b64 v[130:131], 0
    s_nop 7
    buffer_load_dwordx4 v[16:19], v0, s[8:11], s60 offen offset:0 sc1
    ds_read_b128 v[80:83], v1 offset:8192
    v_mov_b64 v[132:133], 0
    ds_read_b128 v[84:87], v1 offset:9216
    v_mov_b64 v[134:135], 0
    ds_read_b128 v[88:91], v1 offset:10240
    v_mov_b64 v[136:137], 0
    ds_read_b128 v[92:95], v1 offset:11264
    v_mov_b64 v[138:139], 0
    s_nop 7
    buffer_load_dwordx4 v[24:27], v0, s[8:11], s60 offen offset:0 sc1
L_pq_f0:
    s_waitcnt vmcnt(2)
    v_mfma_f32_16x16x32_bf16 v[40:43], v[32:35], v[8:11], 0
    v_and_b32 v151, 1, v8
    v_cmp_ne_u32 vcc, s57, v151
    s_nop 4
    s_cbranch_vccz L_pq_f0_ok
    buffer_load_dwordx4 v[8:11], v0, s[8:11], s60 offen offset:0 sc1
    s_waitcnt vmcnt(2)
    v_mfma_f32_16x16x32_bf16 v[40:43], v[32:35], v[16:19], 0
    v_and_b32 v151, 1, v16
    v_cmp_ne_u32 vcc, s57, v151
    s_nop 4
    s_cbranch_vccz L_pq_f0_ok
    buffer_load_dwordx4 v[16:19], v0, s[8:11], s60 offen offset:0 sc1
    s_waitcnt vmcnt(2)
    v_mfma_f32_16x16x32_bf16 v[40:43], v[32:35], v[24:27], 0
    v_and_b32 v151, 1, v24
    v_cmp_ne_u32 vcc, s57, v151
    s_nop 4
    s_cbranch_vccz L_pq_f0_ok
    buffer_load_dwordx4 v[24:27], v0, s[8:11], s60 offen offset:0 sc1
    s_sub_u32 s30, s30, 1
    s_cbranch_scc0 L_pq_f0
    s_branch L_abort
L_pq_f0_ok:
    v_add_f32_dpp v40, v40, v40 row_ror:2 row_mask:0xf bank_mask:0xf
    v_add_f32_dpp v41, v41, v41 row_ror:2 row_mask:0xf bank_mask:0xf
    v_add_f32_dpp v42, v42, v42 row_ror:2 row_mask:0xf bank_mask:0xf
    v_add_f32_dpp v43, v43, v43 row_ror:2 row_mask:0xf bank_mask:0xf
    v_add_f32_dpp v40, v40, v40 row_ror:4 row_mask:0xf bank_mask:0xf
    v_add_f32_dpp v41, v41, v41 row_ror:4 row_mask:0xf bank_mask:0xf
    v_add_f32_dpp v42, v42, v42 row_ror:4 row_mask:0xf bank_mask:0xf
    v_add_f32_dpp v43, v43, v43 row_ror:4 row_mask:0xf bank_mask:0xf
    v_add_f32_dpp v40, v40, v40 row_ror:8 row_mask:0xf bank_mask:0xf
    v_add_f32_dpp v41, v41, v41 row_ror:8 row_mask:0xf bank_mask:0xf
    v_add_f32_dpp v42, v42, v42 row_ror:8 row_mask:0xf bank_mask:0xf
    v_add_f32_dpp v43, v43, v43 row_ror:8 row_mask:0xf bank_mask:0xf
    v_cvt_pk_bf16_f32 v44, v40, v42
    v_cvt_pk_bf16_f32 v45, v41, v43
    s_nop 0
    v_mov_b32_dpp v46, v44 quad_perm:[1,0,3,2] row_mask:0xf bank_mask:0xf
    v_mov_b32_dpp v47, v45 quad_perm:[1,0,3,2] row_mask:0xf bank_mask:0xf
    v_and_or_b32 v44, v44, -2, s59
    buffer_store_dwordx4 v[44:47], v147, s[8:11], s58 offen
    s_nop 1
    v_and_or_b32 v44, v44, -2, s65
    s_barrier
    buffer_store_dwordx4 v[44:47], v147, s[8:11], s46 offen sc1
    s_branch L_upd_f0
L_n3_f0:
    ds_read_b128 v[48:51], v1 offset:0
    v_mov_b64 v[116:117], 0
    ds_read_b128 v[52:55], v1 offset:1024
    v_mov_b64 v[118:119], 0
    ds_read_b128 v[56:59], v1 offset:2048
    v_mov_b64 v[120:121], 0
    ds_read_b128 v[60:63], v1 offset:3072
    v_mov_b64 v[122:123], 0
    ds_read_b128 v[64:67], v1 offset:4096
    v_mov_b64 v[124:125], 0
    ds_read_b128 v[68:71], v1 offset:5120
    v_mov_b64 v[126:127], 0
    ds_read_b128 v[72:75], v1 offset:6144
    v_mov_b64 v[128:129], 0
    ds_read_b128 v[76:79], v1 offset:7168
    v_mov_b64 v[130:131], 0
    ds_read_b128 v[80:83], v1 offset:8192
    v_mov_b64 v[132:133], 0
    ds_read_b128 v[84:87], v1 offset:9216
    v_mov_b64 v[134:135], 0
    ds_read_b128 v[88:91], v1 offset:10240
    v_mov_b64 v[136:137], 0
    ds_read_b128 v[92:95], v1 offset:11264
    v_mov_b64 v[138:139], 0
    s_min_u32 s49, s36, s38
    s_cmp_ge_u32 s49, s50
    s_cbranch_scc1 L_n4_f0
    s_mov_b32 s30, 131072
Lsf_6:
    s_load_dwordx4 s[36:39], s[8:9], s77 glc
    s_sub_u32 s30, s30, 1
    s_cbranch_scc1 L_abort
    s_waitcnt lgkmcnt(0)
    s_min_u32 s49, s36, s38
    s_cmp_lt_u32 s49, s50
    s_cbranch_scc1 Lsf_6
L_n4_f0:
    s_waitcnt lgkmcnt(4)
    s_load_dwordx4 s[36:39], s[8:9], s77 glc
    v_mov_b32 v151, 0
    s_nop 2
    v_mov_b32 v151, 0
    s_nop 2
    v_mov_b32 v151, 0
    s_nop 2
    v_mov_b32 v151, 0
    s_nop 2
    v_mov_b32 v151, 0
    s_nop 2
    v_mov_b32 v151, 0
    s_nop 2
    v_mov_b32 v151, 0
    s_nop 2
    v_mov_b32 v151, 0
    s_nop 2
    v_mov_b32 v151, 0
    s_nop 2
    v_mov_b32 v151, 0
    s_nop 2
    v_mov_b32 v151, 0
    s_nop 2
    v_mov_b32 v151, 0
    s_nop 2
    v_mov_b32 v151, 0
    s_nop 2
    v_mov_b32 v151, 0
    s_nop 2
    s_waitcnt vmcnt(0)
    s_barrier
    s_atomic_add s42, s[8:9], s76
    s_branch L_upd_f0
L_top_s0:
    ds_read_b128 v[48:51], v1 offset:0
    v_mov_b64 v[116:117], 0
    ds_read_b128 v[52:55], v1 offset:1024
    v_mov_b64 v[118:119], 0
    ds_read_b128 v[56:59], v1 offset:2048
    v_mov_b64 v[120:121], 0
    ds_read_b128 v[60:63], v1 offset:3072
    v_mov_b64 v[122:123], 0
    ds_read_b128 v[64:67], v1 offset:4096
    v_mov_b64 v[124:125], 0
    ds_read_b128 v[68:71], v1 offset:5120
    v_mov_b64 v[126:127], 0
    ds_read_b128 v[72:75], v1 offset:6144
    v_mov_b64 v[128:129], 0
    ds_read_b128 v[76:79], v1 offset:7168
    v_mov_b64 v[130:131], 0
    ds_read_b128 v[80:83], v1 offset:8192
    v_mov_b64 v[132:133], 0
    ds_read_b128 v[84:87], v1 offset:9216
    v_mov_b64 v[134:135], 0
    ds_read_b128 v[88:91], v1 offset:10240
    v_mov_b64 v[136:137], 0
    ds_read_b128 v[92:95], v1 offset:11264
    v_mov_b64 v[138:139], 0
    s_waitcnt lgkmcnt(8)
    ds_read_b128 v[96:99], v1 offset:12288
    ds_read_b128 v[100:103], v1 offset:13312
    ds_read_b128 v[104:107], v1 offset:14336
    ds_read_b128 v[108:111], v1 offset:15360
    s_branch L_top3_s0
L_top2_s0:
    s_waitcnt lgkmcnt(8)
    ds_read_b128 v[96:99], v1 offset:12288
    ds_read_b128 v[100:103], v1 offset:13312
    ds_read_b128 v[104:107], v1 offset:14336
    ds_read_b128 v[108:111], v1 offset:15360
    s_nop 7
    s_nop 7
    s_nop 7
    s_nop 7
    s_nop 7
    s_nop 7
L_top3_s0:
    s_add_u32 m0, s51, 0
    s_nop 0
    buffer_load_dwordx4 v0, s[8:11], s53 offen sc1 lds
    s_add_u32 m0, s52, 0
    s_nop 0
    buffer_load_dword v2, s[8:11], s54 offen sc1 lds
    v_add_u32 v115, s45, v0
    s_and_b32 s59, s48, 1
    s_xor_b32 s57, s59, 1
    s_mov_b32 s63, s65
    s_xor_b32 s65, s65, s59
    s_xor_b32 s31, s31, 57344
    v_xor_b32 v149, 8192, v149
    s_nop 7
    s_nop 7
    s_nop 7
    s_nop 7
    s_add_u32 m0, s51, 5120
    s_nop 0
    buffer_load_dwordx4 v0, s[8:11], s55 offen sc1 lds
    s_add_u32 m0, s52, 5120
    s_nop 0
    buffer_load_dword v2, s[8:11], s56 offen sc1 lds
    s_add_u32 m0, s51, 5120
    s_waitcnt vmcnt(2)
    s_barrier
    ds_read_b128 v[8:11], v0 offset:0
    ds_read_b128 v[12:15], v0 offset:1024
    ds_read_b128 v[16:19], v0 offset:2048
    ds_read_b128 v[20:23], v0 offset:3072
    ds_read_b128 v[24:27], v0 offset:4096
    s_waitcnt lgkmcnt(4)
    v_smfmac_f32_16x16x64_bf16 v[132:135], v[8:11], v[48:55], v144
    buffer_load_dwordx4 v0, s[8:11], s55 offen sc1 lds
    s_add_u32 m0, s52, 5120
    v_smfmac_f32_16x16x64_bf16 v[136:139], v[8:11], v[56:63], v144
    s_waitcnt lgkmcnt(3)
    buffer_load_dword v2, s[8:11], s56 offen sc1 lds
    v_smfmac_f32_16x16x64_bf16 v[132:135], v[12:15], v[64:71], v144
    v_smfmac_f32_16x16x64_bf16 v[136:139], v[12:15], v[72:79], v144
    s_waitcnt lgkmcnt(2)
    v_smfmac_f32_16x16x64_bf16 v[132:135], v[16:19], v[80:87], v144
    v_smfmac_f32_16x16x64_bf16 v[136:139], v[16:19], v[88:95], v144
    s_waitcnt lgkmcnt(1)
    v_smfmac_f32_16x16x64_bf16 v[132:135], v[20:23], v[96:103], v144
    s_waitcnt lgkmcnt(0)
    v_bitop3_b32 v151, v8, v12, s57 bitop3:0x7e
    v_smfmac_f32_16x16x64_bf16 v[136:139], v[20:23], v[104:111], v144
    v_bitop3_b32 v151, v151, v16, s57 bitop3:0xf6
    v_smfmac_f32_16x16x64_bf16 v[132:135], v[24:27], a[160:167], v144
    v_bitop3_b32 v150, v20, v24, s57 bitop3:0x7e
    v_smfmac_f32_16x16x64_bf16 v[136:139], v[24:27], a[168:175], v144
    v_bitop3_b32 v151, v151, v150, 1 bitop3:0xa8
    v_smfmac_f32_16x16x64_bf16 v[116:119], v[8:11], a[0:7], v144
    v_cmp_ne_u32 vcc, 0, v151
    v_smfmac_f32_16x16x64_bf16 v[120:123], v[8:11], a[8:15], v144
    v_smfmac_f32_16x16x64_bf16 v[116:119], v[12:15], a[32:39], v144
    s_cbranch_vccnz L_rl_s0
L_okl_s0:
    v_add_f32 v132, v132, v134
    v_smfmac_f32_16x16x64_bf16 v[120:123], v[12:15], a[40:47], v144
    ds_read_b128 v[48:51], v0 offset:16384
    v_add_f32 v133, v133, v135
    v_smfmac_f32_16x16x64_bf16 v[116:119], v[16:19], a[64:71], v144
    ds_read_b128 v[52:55], v0 offset:17408
    v_add_f32 v136, v136, v138
    v_smfmac_f32_16x16x64_bf16 v[120:123], v[16:19], a[72:79], v144
    ds_read_b128 v[56:59], v0 offset:18432
    v_add_f32 v137, v137, v139
    v_smfmac_f32_16x16x64_bf16 v[116:119], v[20:23], a[96:103], v144
    ds_read_b128 v[60:63], v0 offset:19456
    v_cvt_pk_bf16_f32 v137, v136, v137
    v_smfmac_f32_16x16x64_bf16 v[120:123], v[20:23], a[104:111], v144
    ds_read_b128 v[64:67], v0 offset:20480
    v_cvt_pk_bf16_f32 v136, v132, v133
    v_smfmac_f32_16x16x64_bf16 v[116:119], v[24:27], a[128:135], v144
    ds_read_b128 v[68:71], v0 offset:21504
    v_and_or_b32 v136, v136, -2, s63
    v_smfmac_f32_16x16x64_bf16 v[120:123], v[24:27], a[136:143], v144
    buffer_store_dwordx2 v[136:137], v148, s[8:11], s66 offen sc1
    v_smfmac_f32_16x16x64_bf16 v[124:127], v[8:11], a[16:23], v144
    ds_read_b128 v[72:75], v0 offset:22528
    v_mov_b64 v[112:113], v[136:137]
    v_smfmac_f32_16x16x64_bf16 v[128:131], v[8:11], a[24:31], v144
    ds_read_b128 v[76:79], v0 offset:23552
    v_mov_b64 v[132:133], 0
    v_smfmac_f32_16x16x64_bf16 v[124:127], v[12:15], a[48:55], v144
    v_mov_b64 v[134:135], 0
    v_smfmac_f32_16x16x64_bf16 v[128:131], v[12:15], a[56:63], v144
    s_waitcnt vmcnt(1)
    s_barrier
    ds_read_b128 v[28:31], v0 offset:5120
    ds_read_b128 v[32:35], v0 offset:6144
    v_smfmac_f32_16x16x64_bf16 v[124:127], v[16:19], a[80:87], v144
    ds_read_b128 v[36:39], v0 offset:7168
    v_smfmac_f32_16x16x64_bf16 v[128:131], v[16:19], a[88:95], v144
    ds_read_b128 v[40:43], v0 offset:8192
    v_smfmac_f32_16x16x64_bf16 v[124:127], v[20:23], a[112:119], v144
    ds_read_b128 v[44:47], v0 offset:9216
    v_smfmac_f32_16x16x64_bf16 v[128:131], v[20:23], a[120:127], v144
    s_waitcnt lgkmcnt(3)
    v_bitop3_b32 v151, v28, v32, s63 bitop3:0x7e
    v_and_b32 v151, 1, v151
    v_cmp_ne_u32 vcc, 0, v151
    v_smfmac_f32_16x16x64_bf16 v[124:127], v[24:27], a[144:151], v144
    v_smfmac_f32_16x16x64_bf16 v[128:131], v[24:27], a[152:159], v144
    s_cbranch_vccnz L_ra_s0
L_oka_s0:
    v_smfmac_f32_16x16x64_bf16 v[116:119], v[28:31], a[176:183], v144
    s_mov_b32 m0, s31
    v_smfmac_f32_16x16x64_bf16 v[120:123], v[28:31], a[184:191], v144
    buffer_load_dwordx4 v0, s[8:11], s62 offen lds
    v_smfmac_f32_16x16x64_bf16 v[116:119], v[32:35], a[208:215], v144
    s_waitcnt lgkmcnt(0)
    v_bitop3_b32 v151, v36, v40, s63 bitop3:0x7e
    v_smfmac_f32_16x16x64_bf16 v[120:123], v[32:35], a[216:223], v144
    ds_read_b128 v[8:11], v1 offset:16384
    v_bitop3_b32 v151, v151, v44, s63 bitop3:0xf6
    v_smfmac_f32_16x16x64_bf16 v[124:127], v[28:31], a[192:199], v144
    ds_read_b128 v[12:15], v1 offset:17408
    s_mov_b32 m0, s31
    v_and_b32 v151, 1, v151
    v_smfmac_f32_16x16x64_bf16 v[128:131], v[28:31], a[200:207], v144
    ds_read_b128 v[16:19], v1 offset:18432
    buffer_load_dwordx4 v0, s[8:11], s62 offen offset:1024 lds
    v_cmp_ne_u32 vcc, 0, v151
    v_smfmac_f32_16x16x64_bf16 v[124:127], v[32:35], a[224:231], v144
    ds_read_b128 v[20:23], v1 offset:19456
    v_smfmac_f32_16x16x64_bf16 v[128:131], v[32:35], a[232:239], v144
    s_cbranch_vccnz L_rb_s0
L_okb_s0:
    v_smfmac_f32_16x16x64_bf16 v[116:119], v[36:39], a[240:247], v144
    v_smfmac_f32_16x16x64_bf16 v[120:123], v[36:39], a[248:255], v144
    ds_read_b128 v[24:27], v1 offset:20480
    v_smfmac_f32_16x16x64_bf16 v[116:119], v[40:43], v[168:175], v144
    ds_read_b128 v[28:31], v1 offset:21504
    v_smfmac_f32_16x16x64_bf16 v[120:123], v[40:43], v[176:183], v144
    ds_read_b128 v[32:35], v1 offset:22528
    v_smfmac_f32_16x16x64_bf16 v[116:119], v[44:47], v[200:207], v144
    v_smfmac_f32_16x16x64_bf16 v[120:123], v[44:47], v[208:215], v144
    v_smfmac_f32_16x16x64_bf16 v[124:127], v[36:39], v[152:159], v144
    v_add_f32 v116, v116, v118
    v_add_f32 v117, v117, v119
    v_smfmac_f32_16x16x64_bf16 v[128:131], v[36:39], v[160:167], v144
    v_add_f32 v120, v120, v122
    v_add_f32 v121, v121, v123
    v_cvt_pk_bf16_f32 v116, v116, v120
    v_cvt_pk_bf16_f32 v117, v117, v121
    v_smfmac_f32_16x16x64_bf16 v[124:127], v[40:43], v[184:191], v144
    ds_write2_b32 v4, v116, v117 offset0:0 offset1:4
    v_smfmac_f32_16x16x64_bf16 v[128:131], v[40:43], v[192:199], v144
    buffer_load_dwordx2 v[138:139], v148, s[8:11], s67 offen sc1
    v_smfmac_f32_16x16x64_bf16 v[124:127], v[44:47], v[216:223], v144
    v_mov_b64 v[40:41], 0
    v_smfmac_f32_16x16x64_bf16 v[128:131], v[44:47], v[224:231], v144
    v_mov_b64 v[42:43], 0
    v_mfma_f32_16x16x32_bf16 v[96:99], v[140:143], v[140:143], 0
    s_waitcnt lgkmcnt(0)
    s_barrier
    ds_read_b128 v[80:83], v7 offset:10240
    ds_read_b128 v[84:87], v7 offset:10752
    v_add_f32 v124, v124, v126
    v_add_f32 v125, v125, v127
    v_add_f32 v128, v128, v130
    v_add_f32 v129, v129, v131
    v_cvt_pk_bf16_f32 v124, v124, v128
    v_cvt_pk_bf16_f32 v125, v125, v129
    ds_write2_b32 v5, v124, v125 offset0:0 offset1:4
    ds_read_b128 v[88:91], v7 offset:11264
    s_waitcnt lgkmcnt(3)
    v_mfma_f32_16x16x32_bf16 v[104:107], v[48:51], v[80:83], 0
    ds_read_b128 v[92:95], v7 offset:11776
    v_mfma_f32_16x16x32_bf16 v[108:111], v[64:67], v[80:83], 0
    s_waitcnt lgkmcnt(3)
    v_mfma_f32_16x16x32_bf16 v[104:107], v[52:55], v[84:87], v[104:107]
    buffer_load_dwordx2 v[138:139], v148, s[8:11], s67 offen sc1
    v_mfma_f32_16x16x32_bf16 v[108:111], v[68:71], v[84:87], v[108:111]
    s_add_u32 m0, s40, 16384
    s_waitcnt lgkmcnt(1)
    s_barrier
    ds_read_b128 v[96:99], v0 offset:12288
    v_mfma_f32_16x16x32_bf16 v[104:107], v[56:59], v[88:91], v[104:107]
    ds_read_b128 v[100:103], v0 offset:13312
    ds_read_b32 v114, v115 offset:12288
    v_mfma_f32_16x16x32_bf16 v[108:111], v[72:75], v[88:91], v[108:111]
    buffer_load_dwordx4 v0, s[8:11], s61 offen lds
    s_add_u32 m0, s40, 16384
    s_waitcnt lgkmcnt(3)
    v_mfma_f32_16x16x32_bf16 v[104:107], v[60:63], v[92:95], v[104:107]
    ds_read_b128 v[48:51], v149 offset:24576
    s_cmp_eq_u32 s48, 63
    v_mfma_f32_16x16x32_bf16 v[108:111], v[76:79], v[92:95], v[108:111]
    ds_read_b128 v[52:55], v149 offset:25600
    s_cbranch_scc1 L_chain_final
    s_waitcnt lgkmcnt(4)
    v_smfmac_f32_16x16x64_bf16 v[40:43], v[96:99], v[80:87], v144
    buffer_load_dwordx4 v0, s[8:11], s61 offen offset:1024 lds
    s_waitcnt lgkmcnt(2)
    v_smfmac_f32_16x16x64_bf16 v[40:43], v[100:103], v[88:95], v144
    buffer_store_dwordx4 v[112:115], v0, s[8:11], s64 offen sc1
    v_max3_f32 v150, v104, v105, v106
    v_max3_f32 v150, v150, v107, v108
    v_max3_f32 v150, v150, v109, v110
    v_max_f32 v150, v150, v111
    v_mov_b64 v[92:93], s[70:71]
    s_nop 1
    v_add_f32 v40, v40, v42
    v_add_f32 v41, v41, v43
    v_max3_f32 v42, v150, v40, v41
    v_max3_f32 v43, v150, v40, v41
    v_mov_b64 v[88:89], s[68:69]
    v_mov_b64 v[90:91], s[68:69]
    v_permlane32_swap_b32 v42, v43
    v_max_f32 v150, v42, v43
    v_max_f32 v42, v42, v43
    s_add_u32 s50, s48, 3
    s_min_u32 s50, s50, 64
    v_permlane16_swap_b32 v150, v42
    v_max_f32 v150, v150, v42
    v_mul_f32 v150, s43, v150
    v_pk_fma_f32 v[104:105], v[104:105], s[72:73], v[150:151] op_sel_hi:[1,1,0]
    v_pk_fma_f32 v[106:107], v[106:107], s[72:73], v[150:151] op_sel_hi:[1,1,0]
    v_pk_fma_f32 v[108:109], v[108:109], s[72:73], v[150:151] op_sel_hi:[1,1,0]
    v_pk_fma_f32 v[110:111], v[110:111], s[72:73], v[150:151] op_sel_hi:[1,1,0]
    v_pk_fma_f32 v[40:41], v[40:41], s[72:73], v[150:151] op_sel_hi:[1,1,0]
    v_exp_f32 v104, v104
    v_exp_f32 v105, v105
    v_exp_f32 v106, v106
    v_exp_f32 v107, v107
    v_exp_f32 v108, v108
    v_exp_f32 v109, v109
    v_exp_f32 v110, v110
    v_exp_f32 v111, v111
    v_cvt_pk_bf16_f32 v104, v104, v105
    v_cvt_pk_bf16_f32 v105, v106, v107
    v_cvt_pk_bf16_f32 v106, v108, v109
    v_cvt_pk_bf16_f32 v107, v110, v111
    v_exp_f32 v40, v40
    s_waitcnt lgkmcnt(0)
    v_mfma_f32_16x16x32_bf16 v[96:99], v[88:91], v[104:107], 0
    ds_read_b128 v[36:39], v1 offset:23552
    v_exp_f32 v41, v41
    v_mfma_f32_16x16x32_bf16 v[80:83], v[48:51], v[104:107], 0
    ds_read_b128 v[56:59], v1 offset:24576
    v_cvt_pk_bf16_f32 v42, v40, v41
    v_cvt_pk_bf16_f32 v43, v40, v41
    v_mfma_f32_16x16x32_bf16 v[84:87], v[52:55], v[104:107], 0
    s_waitcnt vmcnt(3)
    v_and_b32 v151, 1, v138
    v_swap_b32 v137, v138
    v_mfma_f32_16x16x16_bf16 v[96:99], v[92:93], v[42:43], v[96:99]
    ds_read_b128 v[60:63], v1 offset:25600
    v_cmp_ne_u32 vcc, s63, v151
    v_mfma_f32_16x16x16_bf16 v[80:83], v[136:137], v[42:43], v[80:83]
    ds_read_b128 v[64:67], v1 offset:26624
    v_mfma_f32_16x16x16_bf16 v[84:87], v[138:139], v[42:43], v[84:87]
    s_cbranch_vccnz L_rv_s0
L_okv_s0:
    v_rcp_f32 v96, v96
    s_nop 1
    v_mul_f32 v80, v80, v96
    v_mul_f32 v81, v81, v96
    v_mul_f32 v82, v82, v96
    v_mul_f32 v83, v83, v96
    s_mov_b64 exec, s[74:75]
    v_pk_mul_f32 v[80:81], v[84:85], v[96:97] op_sel_hi:[1,0]
    v_pk_mul_f32 v[82:83], v[86:87], v[96:97] op_sel_hi:[1,0]
    s_mov_b64 exec, -1
    v_cvt_pk_bf16_f32 v80, v80, v81
    v_cvt_pk_bf16_f32 v81, v82, v83
    ds_write_b64 v6, v[80:81]
    v_mfma_f32_16x16x32_bf16 v[116:119], v[132:135], v[140:143], 0
    s_add_u32 s48, s48, 1
    s_xor_b32 s46, s46, 32768
    s_xor_b32 s55, s55, 32768
    v_mfma_f32_16x16x32_bf16 v[120:123], v[132:135], v[140:143], 0
    s_xor_b32 s56, s56, 32768
    s_xor_b32 s66, s66, 262144
    s_xor_b32 s67, s67, 262144
    v_mfma_f32_16x16x32_bf16 v[124:127], v[132:135], v[140:143], 0
    s_cmp_lt_u32 s5, 2
    v_mfma_f32_16x16x32_bf16 v[128:131], v[132:135], v[140:143], 0
    s_waitcnt lgkmcnt(0)
    s_barrier
    ds_read_b128 v[40:43], v0 offset:14336
    ds_read_b128 v[44:47], v0 offset:15360
    v_mfma_f32_16x16x32_bf16 v[96:99], v[140:143], v[140:143], 0
    ds_read_b128 v[68:71], v1 offset:27648
    v_mfma_f32_16x16x32_bf16 v[96:99], v[140:143], v[140:143], 0
    ds_read_b128 v[72:75], v1 offset:28672
    ds_read_b128 v[76:79], v1 offset:29696
    s_waitcnt lgkmcnt(4)
    v_smfmac_f32_16x16x64_bf16 v[132:135], v[40:43], v[232:239], v144
    s_waitcnt lgkmcnt(3)
    v_smfmac_f32_16x16x64_bf16 v[132:135], v[44:47], v[240:247], v144
    v_smfmac_f32_16x16x64_bf16 v[116:119], v[40:43], v[248:255], v144
    v_smfmac_f32_16x16x64_bf16 v[116:119], v[44:47], v[8:15], v144
    v_add_f32 v132, v132, v134
    v_smfmac_f32_16x16x64_bf16 v[120:123], v[40:43], v[16:23], v144
    v_add_f32 v133, v133, v135
    v_smfmac_f32_16x16x64_bf16 v[120:123], v[44:47], v[24:31], v144
    v_cvt_pk_bf16_f32 v112, v132, v133
    v_smfmac_f32_16x16x64_bf16 v[124:127], v[40:43], v[32:39], v144
    s_waitcnt lgkmcnt(0)
    v_and_or_b32 v112, v112, -2, s57
    v_smfmac_f32_16x16x64_bf16 v[124:127], v[44:47], v[56:63], v144
    buffer_store_dword v112, v146, s[8:11], 0 offen sc1
    v_add_f32 v116, v116, v118
    v_smfmac_f32_16x16x64_bf16 v[128:131], v[40:43], v[64:71], v144
    v_add_f32 v117, v117, v119
    v_smfmac_f32_16x16x64_bf16 v[128:131], v[44:47], v[72:79], v144
    v_cvt_pk_bf16_f32 v104, v116, v117
    v_and_or_b32 v104, v104, -2, s57
    v_add_f32 v120, v120, v122
    v_add_f32 v121, v121, v123
    v_cvt_pk_bf16_f32 v105, v120, v121
    v_add_f32 v124, v124, v126
    v_add_f32 v125, v125, v127
    v_cvt_pk_bf16_f32 v106, v124, v125
    v_add_f32 v128, v128, v130
    v_add_f32 v129, v129, v131
    v_cvt_pk_bf16_f32 v107, v128, v129
    buffer_store_dwordx4 v[104:107], v145, s[8:11], 0 offen sc1
    s_cbranch_scc0 L_n0_s0
    v_mov_b64 v[40:41], 0
    v_mov_b64 v[42:43], 0
    s_mov_b32 s30, 131072
    ds_read_b128 v[48:51], v1 offset:0
    v_mov_b64 v[116:117], 0
    ds_read_b128 v[52:55], v1 offset:1024
    v_mov_b64 v[118:119], 0
    ds_read_b128 v[56:59], v1 offset:2048
    v_mov_b64 v[120:121], 0
    ds_read_b128 v[60:63], v1 offset:3072
    v_mov_b64 v[122:123], 0
    s_nop 7
    s_nop 7
    s_nop 7
    buffer_load_dwordx4 v[8:11], v0, s[8:11], s60 offen offset:0 sc1
    buffer_load_dwordx4 v[12:15], v0, s[8:11], s60 offen offset:1024 sc1
    ds_read_b128 v[64:67], v1 offset:4096
    v_mov_b64 v[124:125], 0
    ds_read_b128 v[68:71], v1 offset:5120
    v_mov_b64 v[126:127], 0
    ds_read_b128 v[72:75], v1 offset:6144
    v_mov_b64 v[128:129], 0
    ds_read_b128 v[76:79], v1 offset:7168
    v_mov_b64 v[130:131], 0
    s_nop 7
    buffer_load_dwordx4 v[16:19], v0, s[8:11], s60 offen offset:0 sc1
    buffer_load_dwordx4 v[20:23], v0, s[8:11], s60 offen offset:1024 sc1
    ds_read_b128 v[80:83], v1 offset:8192
    v_mov_b64 v[132:133], 0
    ds_read_b128 v[84:87], v1 offset:9216
    v_mov_b64 v[134:135], 0
    ds_read_b128 v[88:91], v1 offset:10240
    v_mov_b64 v[136:137], 0
    ds_read_b128 v[92:95], v1 offset:11264
    v_mov_b64 v[138:139], 0
    s_nop 7
    buffer_load_dwordx4 v[24:27], v0, s[8:11], s60 offen offset:0 sc1
    buffer_load_dwordx4 v[28:31], v0, s[8:11], s60 offen offset:1024 sc1
L_p1_s0:
    s_waitcnt vmcnt(4)
    v_smfmac_f32_16x16x64_bf16 v[40:43], v[140:143], v[8:15], v144
    v_bitop3_b32 v151, v8, v12, s57 bitop3:0x7e
    v_and_b32 v151, 1, v151
    v_cmp_ne_u32 vcc, 0, v151
    s_nop 3
    s_cbranch_vccz L_p1_s0_ok
    buffer_load_dwordx4 v[8:11], v0, s[8:11], s60 offen offset:0 sc1
    buffer_load_dwordx4 v[12:15], v0, s[8:11], s60 offen offset:1024 sc1
    v_mov_b64 v[40:41], 0
    v_mov_b64 v[42:43], 0
    s_waitcnt vmcnt(4)
    s_nop 0
    v_smfmac_f32_16x16x64_bf16 v[40:43], v[140:143], v[16:23], v144
    v_bitop3_b32 v151, v16, v20, s57 bitop3:0x7e
    v_and_b32 v151, 1, v151
    v_cmp_ne_u32 vcc, 0, v151
    s_nop 3
    s_cbranch_vccz L_p1_s0_ok
    buffer_load_dwordx4 v[16:19], v0, s[8:11], s60 offen offset:0 sc1
    buffer_load_dwordx4 v[20:23], v0, s[8:11], s60 offen offset:1024 sc1
    v_mov_b64 v[40:41], 0
    v_mov_b64 v[42:43], 0
    s_waitcnt vmcnt(4)
    s_nop 0
    v_smfmac_f32_16x16x64_bf16 v[40:43], v[140:143], v[24:31], v144
    v_bitop3_b32 v151, v24, v28, s57 bitop3:0x7e
    v_and_b32 v151, 1, v151
    v_cmp_ne_u32 vcc, 0, v151
    s_nop 3
    s_cbranch_vccz L_p1_s0_ok
    buffer_load_dwordx4 v[24:27], v0, s[8:11], s60 offen offset:0 sc1
    buffer_load_dwordx4 v[28:31], v0, s[8:11], s60 offen offset:1024 sc1
    v_mov_b64 v[40:41], 0
    v_mov_b64 v[42:43], 0
    s_sub_u32 s30, s30, 1
    s_cbranch_scc0 L_p1_s0
    s_branch L_abort
L_p1_s0_ok:
    v_add_f32_dpp v40, v40, v40 row_ror:4 row_mask:0xf bank_mask:0xf
    v_add_f32_dpp v41, v41, v41 row_ror:4 row_mask:0xf bank_mask:0xf
    v_add_f32_dpp v42, v42, v42 row_ror:4 row_mask:0xf bank_mask:0xf
    v_add_f32_dpp v43, v43, v43 row_ror:4 row_mask:0xf bank_mask:0xf
    v_add_f32_dpp v40, v40, v40 row_ror:8 row_mask:0xf bank_mask:0xf
    v_add_f32_dpp v41, v41, v41 row_ror:8 row_mask:0xf bank_mask:0xf
    v_add_f32_dpp v42, v42, v42 row_ror:8 row_mask:0xf bank_mask:0xf
    v_add_f32_dpp v43, v43, v43 row_ror:8 row_mask:0xf bank_mask:0xf
    v_cvt_pk_bf16_f32 v44, v40, v42
    v_cvt_pk_bf16_f32 v45, v41, v43
    s_nop 0
    v_mov_b32_dpp v46, v44 quad_perm:[1,0,3,2] row_mask:0xf bank_mask:0xf
    v_mov_b32_dpp v47, v45 quad_perm:[1,0,3,2] row_mask:0xf bank_mask:0xf
    v_and_or_b32 v44, v44, -2, s59
    buffer_store_dwordx4 v[44:47], v147, s[8:11], s58 offen sc1
    s_nop 1
    v_and_or_b32 v44, v44, -2, s65
    s_barrier
    buffer_store_dwordx4 v[44:47], v147, s[8:11], s46 offen sc1
L_upd_s0:
    s_add_u32 s61, s61, 524288
    s_add_u32 s62, s62, 524288
    s_add_u32 s64, s64, 524288
    s_and_b32 s32, s61, 1572864
    s_cselect_b32 s32, 0, 8192
    s_xor_b32 s61, s61, s32
    s_xor_b32 s62, s62, s32
    s_and_b32 s32, s64, 1572864
    s_cselect_b32 s32, 0, 8192
    s_xor_b32 s64, s64, s32
    s_branch L_top2_s0
L_rl_s0:
    s_mov_b32 s30, 131072
L_rl_s0_l:
    s_waitcnt lgkmcnt(0)
    s_barrier
    s_add_u32 m0, s51, 0
    s_nop 0
    buffer_load_dwordx4 v0, s[8:11], s53 offen sc1 lds
    s_add_u32 m0, s52, 0
    s_nop 0
    buffer_load_dword v2, s[8:11], s54 offen sc1 lds
    s_sub_u32 s30, s30, 1
    s_cbranch_scc1 L_abort
    s_waitcnt vmcnt(0)
    s_barrier
    ds_read_b128 v[8:11], v0 offset:0
    ds_read_b128 v[12:15], v0 offset:1024
    ds_read_b128 v[16:19], v0 offset:2048
    ds_read_b128 v[20:23], v0 offset:3072
    ds_read_b128 v[24:27], v0 offset:4096
    s_waitcnt lgkmcnt(0)
    v_bitop3_b32 v151, v8, v12, s57 bitop3:0x7e
    v_bitop3_b32 v151, v151, v16, s57 bitop3:0xf6
    v_bitop3_b32 v150, v20, v24, s57 bitop3:0x7e
    v_bitop3_b32 v151, v151, v150, 1 bitop3:0xa8
    v_cmp_ne_u32 vcc, 0, v151
    s_cbranch_vccnz L_rl_s0_l
    v_mov_b64 v[116:117], 0
    v_mov_b64 v[118:119], 0
    v_mov_b64 v[120:121], 0
    v_mov_b64 v[122:123], 0
    v_mov_b64 v[124:125], 0
    v_mov_b64 v[126:127], 0
    v_mov_b64 v[128:129], 0
    v_mov_b64 v[130:131], 0
    v_mov_b64 v[132:133], 0
    v_mov_b64 v[134:135], 0
    v_mov_b64 v[136:137], 0
    v_mov_b64 v[138:139], 0
    v_smfmac_f32_16x16x64_bf16 v[132:135], v[8:11], v[48:55], v144
    v_smfmac_f32_16x16x64_bf16 v[136:139], v[8:11], v[56:63], v144
    v_smfmac_f32_16x16x64_bf16 v[132:135], v[12:15], v[64:71], v144
    v_smfmac_f32_16x16x64_bf16 v[136:139], v[12:15], v[72:79], v144
    v_smfmac_f32_16x16x64_bf16 v[132:135], v[16:19], v[80:87], v144
    v_smfmac_f32_16x16x64_bf16 v[136:139], v[16:19], v[88:95], v144
    v_smfmac_f32_16x16x64_bf16 v[132:135], v[20:23], v[96:103], v144
    v_smfmac_f32_16x16x64_bf16 v[136:139], v[20:23], v[104:111], v144
    v_smfmac_f32_16x16x64_bf16 v[132:135], v[24:27], a[160:167], v144
    v_smfmac_f32_16x16x64_bf16 v[136:139], v[24:27], a[168:175], v144
    v_smfmac_f32_16x16x64_bf16 v[116:119], v[8:11], a[0:7], v144
    v_smfmac_f32_16x16x64_bf16 v[120:123], v[8:11], a[8:15], v144
    v_smfmac_f32_16x16x64_bf16 v[116:119], v[12:15], a[32:39], v144
    s_branch L_okl_s0
L_ra_s0:
L_ra_s0x:
    s_mov_b32 s30, 131072
L_ra_s0x_l:
    s_waitcnt lgkmcnt(0)
    s_barrier
    s_add_u32 m0, s51, 5120
    s_nop 0
    buffer_load_dwordx4 v0, s[8:11], s55 offen sc1 lds
    s_add_u32 m0, s52, 5120
    s_nop 0
    buffer_load_dword v2, s[8:11], s56 offen sc1 lds
    s_sub_u32 s30, s30, 1
    s_cbranch_scc1 L_abort
    s_waitcnt vmcnt(0)
    s_barrier
    ds_read_b128 v[28:31], v0 offset:5120
    ds_read_b128 v[32:35], v0 offset:6144
    ds_read_b128 v[36:39], v0 offset:7168
    ds_read_b128 v[40:43], v0 offset:8192
    ds_read_b128 v[44:47], v0 offset:9216
    s_waitcnt lgkmcnt(0)
    v_bitop3_b32 v151, v28, v32, s63 bitop3:0x7e
    v_bitop3_b32 v151, v151, v36, s63 bitop3:0xf6
    v_bitop3_b32 v150, v40, v44, s63 bitop3:0x7e
    v_bitop3_b32 v151, v151, v150, 1 bitop3:0xa8
    v_cmp_ne_u32 vcc, 0, v151
    s_cbranch_vccnz L_ra_s0x_l
    s_branch L_oka_s0
L_rb_s0:
L_rb_s0x:
    s_mov_b32 s30, 131072
L_rb_s0x_l:
    s_waitcnt lgkmcnt(0)
    s_barrier
    s_add_u32 m0, s51, 5120
    s_nop 0
    buffer_load_dwordx4 v0, s[8:11], s55 offen sc1 lds
    s_add_u32 m0, s52, 5120
    s_nop 0
    buffer_load_dword v2, s[8:11], s56 offen sc1 lds
    s_sub_u32 s30, s30, 1
    s_cbranch_scc1 L_abort
    s_waitcnt vmcnt(0)
    s_barrier
    ds_read_b128 v[36:39], v0 offset:7168
    ds_read_b128 v[40:43], v0 offset:8192
    ds_read_b128 v[44:47], v0 offset:9216
    s_waitcnt lgkmcnt(0)
    v_bitop3_b32 v151, v36, v40, s63 bitop3:0x7e
    v_bitop3_b32 v151, v151, v44, s63 bitop3:0xf6
    v_and_b32 v151, 1, v151
    v_cmp_ne_u32 vcc, 0, v151
    s_cbranch_vccnz L_rb_s0x_l
    s_branch L_okb_s0
L_rv_s0:
    v_swap_b32 v137, v138
    s_mov_b32 s30, 131072
L_rv_s0_l:
    s_mov_b64 exec, vcc
    buffer_load_dwordx2 v[138:139], v148, s[8:11], s67 offen sc1
    s_sub_u32 s30, s30, 1
    s_cbranch_scc1 L_abort
    s_waitcnt vmcnt(0)
    v_and_b32 v151, 1, v138
    v_cmp_ne_u32 vcc, s63, v151
    s_cbranch_vccnz L_rv_s0_l
    s_mov_b64 exec, -1
    v_swap_b32 v137, v138
    v_mfma_f32_16x16x32_bf16 v[80:83], v[48:51], v[104:107], 0
    v_mfma_f32_16x16x32_bf16 v[84:87], v[52:55], v[104:107], 0
    v_mfma_f32_16x16x16_bf16 v[80:83], v[136:137], v[42:43], v[80:83]
    v_mfma_f32_16x16x16_bf16 v[84:87], v[138:139], v[42:43], v[84:87]
    s_nop 7
    s_branch L_okv_s0
L_n0_s0:
    s_cmp_eq_u32 s5, 3
    s_cbranch_scc1 L_n3_s0
    v_cmp_eq_u32 vcc, 0x4444, v144
    s_nop 1
    v_cndmask_b32 v32, 0, v140, vcc
    v_cndmask_b32 v34, 0, v141, vcc
    v_sub_u32 v33, v140, v32
    v_sub_u32 v35, v141, v34
    s_mov_b32 s30, 131072
    ds_read_b128 v[48:51], v1 offset:0
    v_mov_b64 v[116:117], 0
    ds_read_b128 v[52:55], v1 offset:1024
    v_mov_b64 v[118:119], 0
    ds_read_b128 v[56:59], v1 offset:2048
    v_mov_b64 v[120:121], 0
    ds_read_b128 v[60:63], v1 offset:3072
    v_mov_b64 v[122:123], 0
    s_nop 7
    s_nop 7
    s_nop 7
    buffer_load_dwordx4 v[8:11], v0, s[8:11], s60 offen offset:0 sc1
    ds_read_b128 v[64:67], v1 offset:4096
    v_mov_b64 v[124:125], 0
    ds_read_b128 v[68:71], v1 offset:5120
    v_mov_b64 v[126:127], 0
    ds_read_b128 v[72:75], v1 offset:6144
    v_mov_b64 v[128:129], 0
    ds_read_b128 v[76:79], v1 offset:7168
    v_mov_b64 v[130:131], 0
    s_nop 7
    buffer_load_dwordx4 v[16:19], v0, s[8:11], s60 offen offset:0 sc1
    ds_read_b128 v[80:83], v1 offset:8192
    v_mov_b64 v[132:133], 0
    ds_read_b128 v[84:87], v1 offset:9216
    v_mov_b64 v[134:135], 0
    ds_read_b128 v[88:91], v1 offset:10240
    v_mov_b64 v[136:137], 0
    ds_read_b128 v[92:95], v1 offset:11264
    v_mov_b64 v[138:139], 0
    s_nop 7
    buffer_load_dwordx4 v[24:27], v0, s[8:11], s60 offen offset:0 sc1
L_pq_s0:
    s_waitcnt vmcnt(2)
    v_mfma_f32_16x16x32_bf16 v[40:43], v[32:35], v[8:11], 0
    v_and_b32 v151, 1, v8
    v_cmp_ne_u32 vcc, s57, v151
    s_nop 4
    s_cbranch_vccz L_pq_s0_ok
    buffer_load_dwordx4 v[8:11], v0, s[8:11], s60 offen offset:0 sc1
    s_waitcnt vmcnt(2)
    v_mfma_f32_16x16x32_bf16 v[40:43], v[32:35], v[16:19], 0
    v_and_b32 v151, 1, v16
    v_cmp_ne_u32 vcc, s57, v151
    s_nop 4
    s_cbranch_vccz L_pq_s0_ok
    buffer_load_dwordx4 v[16:19], v0, s[8:11], s60 offen offset:0 sc1
    s_waitcnt vmcnt(2)
    v_mfma_f32_16x16x32_bf16 v[40:43], v[32:35], v[24:27], 0
    v_and_b32 v151, 1, v24
    v_cmp_ne_u32 vcc, s57, v151
    s_nop 4
    s_cbranch_vccz L_pq_s0_ok
    buffer_load_dwordx4 v[24:27], v0, s[8:11], s60 offen offset:0 sc1
    s_sub_u32 s30, s30, 1
    s_cbranch_scc0 L_pq_s0
    s_branch L_abort
L_pq_s0_ok:
    v_add_f32_dpp v40, v40, v40 row_ror:2 row_mask:0xf bank_mask:0xf
    v_add_f32_dpp v41, v41, v41 row_ror:2 row_mask:0xf bank_mask:0xf
    v_add_f32_dpp v42, v42, v42 row_ror:2 row_mask:0xf bank_mask:0xf
    v_add_f32_dpp v43, v43, v43 row_ror:2 row_mask:0xf bank_mask:0xf
    v_add_f32_dpp v40, v40, v40 row_ror:4 row_mask:0xf bank_mask:0xf
    v_add_f32_dpp v41, v41, v41 row_ror:4 row_mask:0xf bank_mask:0xf
    v_add_f32_dpp v42, v42, v42 row_ror:4 row_mask:0xf bank_mask:0xf
    v_add_f32_dpp v43, v43, v43 row_ror:4 row_mask:0xf bank_mask:0xf
    v_add_f32_dpp v40, v40, v40 row_ror:8 row_mask:0xf bank_mask:0xf
    v_add_f32_dpp v41, v41, v41 row_ror:8 row_mask:0xf bank_mask:0xf
    v_add_f32_dpp v42, v42, v42 row_ror:8 row_mask:0xf bank_mask:0xf
    v_add_f32_dpp v43, v43, v43 row_ror:8 row_mask:0xf bank_mask:0xf
    v_cvt_pk_bf16_f32 v44, v40, v42
    v_cvt_pk_bf16_f32 v45, v41, v43
    s_nop 0
    v_mov_b32_dpp v46, v44 quad_perm:[1,0,3,2] row_mask:0xf bank_mask:0xf
    v_mov_b32_dpp v47, v45 quad_perm:[1,0,3,2] row_mask:0xf bank_mask:0xf
    v_and_or_b32 v44, v44, -2, s59
    buffer_store_dwordx4 v[44:47], v147, s[8:11], s58 offen sc1
    s_nop 1
    v_and_or_b32 v44, v44, -2, s65
    s_barrier
    buffer_store_dwordx4 v[44:47], v147, s[8:11], s46 offen sc1
    s_branch L_upd_s0
L_n3_s0:
    ds_read_b128 v[48:51], v1 offset:0
    v_mov_b64 v[116:117], 0
    ds_read_b128 v[52:55], v1 offset:1024
    v_mov_b64 v[118:119], 0
    ds_read_b128 v[56:59], v1 offset:2048
    v_mov_b64 v[120:121], 0
    ds_read_b128 v[60:63], v1 offset:3072
    v_mov_b64 v[122:123], 0
    ds_read_b128 v[64:67], v1 offset:4096
    v_mov_b64 v[124:125], 0
    ds_read_b128 v[68:71], v1 offset:5120
    v_mov_b64 v[126:127], 0
    ds_read_b128 v[72:75], v1 offset:6144
    v_mov_b64 v[128:129], 0
    ds_read_b128 v[76:79], v1 offset:7168
    v_mov_b64 v[130:131], 0
    ds_read_b128 v[80:83], v1 offset:8192
    v_mov_b64 v[132:133], 0
    ds_read_b128 v[84:87], v1 offset:9216
    v_mov_b64 v[134:135], 0
    ds_read_b128 v[88:91], v1 offset:10240
    v_mov_b64 v[136:137], 0
    ds_read_b128 v[92:95], v1 offset:11264
    v_mov_b64 v[138:139], 0
    s_min_u32 s49, s36, s38
    s_cmp_ge_u32 s49, s50
    s_cbranch_scc1 L_n4_s0
    s_mov_b32 s30, 131072
Lsf_7:
    s_load_dwordx4 s[36:39], s[8:9], s77 glc
    s_sub_u32 s30, s30, 1
    s_cbranch_scc1 L_abort
    s_waitcnt lgkmcnt(0)
    s_min_u32 s49, s36, s38
    s_cmp_lt_u32 s49, s50
    s_cbranch_scc1 Lsf_7
L_n4_s0:
    s_waitcnt lgkmcnt(4)
    s_load_dwordx4 s[36:39], s[8:9], s77 glc
    v_mov_b32 v151, 0
    s_nop 2
    v_mov_b32 v151, 0
    s_nop 2
    v_mov_b32 v151, 0
    s_nop 2
    v_mov_b32 v151, 0
    s_nop 2
    v_mov_b32 v151, 0
    s_nop 2
    v_mov_b32 v151, 0
    s_nop 2
    v_mov_b32 v151, 0
    s_nop 2
    v_mov_b32 v151, 0
    s_nop 2
    v_mov_b32 v151, 0
    s_nop 2
    v_mov_b32 v151, 0
    s_nop 2
    v_mov_b32 v151, 0
    s_nop 2
    v_mov_b32 v151, 0
    s_nop 2
    v_mov_b32 v151, 0
    s_nop 2
    v_mov_b32 v151, 0
    s_nop 2
    s_waitcnt vmcnt(0)
    s_barrier
    s_atomic_add s42, s[8:9], s76
    s_branch L_upd_s0
L_chain_final:
    s_waitcnt lgkmcnt(0)
    buffer_store_dwordx4 v[112:115], v0, s[8:11], s64 offen sc1
    s_cmp_eq_u32 s5, 3
    s_cbranch_scc1 L_chain_f3
    s_waitcnt vmcnt(0)
    s_barrier
    s_branch L_chain_f4
L_chain_f3:
    s_waitcnt vmcnt(0)
    s_barrier
    s_atomic_add s42, s[8:9], s76
    s_waitcnt lgkmcnt(0)
L_chain_f4:
    s_endpgm
L_restart_safe:
    s_waitcnt vmcnt(0) lgkmcnt(0)
    s_barrier
    s_mov_b32 s4, 1
    s_and_b32 s28, s2, 7
    v_mbcnt_lo_u32_b32 v1, -1, 0
    v_mbcnt_hi_u32_b32 v1, -1, v1
    v_lshl_add_u32 v0, s5, 6, v1
    s_load_dwordx2 s[78:79], s[0:1], 0
    s_load_dwordx8 s[80:87], s[0:1], 8
    s_load_dwordx2 s[88:89], s[0:1], 40
    s_waitcnt lgkmcnt(0)
    s_branch L_dispatch
L_abort:
L_exit:
    s_endpgm
L_dispatch2:
    s_or_b32 s32, s4, s5
    s_cbranch_scc1 Lclr_8
    v_mov_b64 v[4:5], 0
    v_mov_b64 v[6:7], 0
    s_lshl_b32 s32, s2, 12
    v_lshlrev_b32 v2, 4, v1
    buffer_store_dwordx4 v[4:7], v2, s[8:11], s32 offen offset:0 sc1
    buffer_store_dwordx4 v[4:7], v2, s[8:11], s32 offen offset:1024 sc1
    buffer_store_dwordx4 v[4:7], v2, s[8:11], s32 offen offset:2048 sc1
    buffer_store_dwordx4 v[4:7], v2, s[8:11], s32 offen offset:3072 sc1
Lclr_8:
    s_cmp_ge_u32 s28, 5
    s_cbranch_scc1 L_proj
    s_cmp_lg_u32 s28, 2
    s_cbranch_scc1 L_s4
    s_cmp_lt_u32 s29, 16
    s_cbranch_scc1 L_attn
    s_branch L_s4
L_proj:
    s_mov_b64 s[16:17], s[78:79]
    s_mov_b32 s18, 2621440
    s_mov_b32 s19, 0x20000
    s_mov_b32 s14, 5242880
    s_mov_b32 s15, 0x20000
    s_waitcnt lgkmcnt(0)
    s_cmp_eq_u32 s28, 5
    s_cselect_b64 s[12:13], s[84:85], s[86:87]
    s_cmp_eq_u32 s28, 7
    s_cselect_b64 s[12:13], s[82:83], s[12:13]
    v_and_b32 v10, 15, v1
    v_lshrrev_b32 v11, 4, v1
    s_mul_i32 s32, s5, 40
    v_add_u32 v12, s32, v11
    v_mul_u32_u24 v13, 52429, v12
    v_bfe_u32 v13, v13, 18, 4
    v_xor_b32 v13, v13, v10
    v_lshlrev_b32 v13, 4, v13
    v_lshl_add_u32 v16, v12, 8, v13
    v_add_u32 v12, 4, v12
    v_mul_u32_u24 v13, 52429, v12
    v_bfe_u32 v13, v13, 18, 4
    v_xor_b32 v13, v13, v10
    v_lshlrev_b32 v13, 4, v13
    v_lshl_add_u32 v17, v12, 8, v13
    v_add_u32 v12, 4, v12
    v_mul_u32_u24 v13, 52429, v12
    v_bfe_u32 v13, v13, 18, 4
    v_xor_b32 v13, v13, v10
    v_lshlrev_b32 v13, 4, v13
    v_lshl_add_u32 v18, v12, 8, v13
    v_add_u32 v12, 4, v12
    v_mul_u32_u24 v13, 52429, v12
    v_bfe_u32 v13, v13, 18, 4
    v_xor_b32 v13, v13, v10
    v_lshlrev_b32 v13, 4, v13
    v_lshl_add_u32 v19, v12, 8, v13
    v_add_u32 v12, 4, v12
    v_mul_u32_u24 v13, 52429, v12
    v_bfe_u32 v13, v13, 18, 4
    v_xor_b32 v13, v13, v10
    v_lshlrev_b32 v13, 4, v13
    v_lshl_add_u32 v20, v12, 8, v13
    v_add_u32 v12, 4, v12
    v_mul_u32_u24 v13, 52429, v12
    v_bfe_u32 v13, v13, 18, 4
    v_xor_b32 v13, v13, v10
    v_lshlrev_b32 v13, 4, v13
    v_lshl_add_u32 v21, v12, 8, v13
    v_add_u32 v12, 4, v12
    v_mul_u32_u24 v13, 52429, v12
    v_bfe_u32 v13, v13, 18, 4
    v_xor_b32 v13, v13, v10
    v_lshlrev_b32 v13, 4, v13
    v_lshl_add_u32 v22, v12, 8, v13
    v_add_u32 v12, 4, v12
    v_mul_u32_u24 v13, 52429, v12
    v_bfe_u32 v13, v13, 18, 4
    v_xor_b32 v13, v13, v10
    v_lshlrev_b32 v13, 4, v13
    v_lshl_add_u32 v23, v12, 8, v13
    v_add_u32 v12, 4, v12
    v_mul_u32_u24 v13, 52429, v12
    v_bfe_u32 v13, v13, 18, 4
    v_xor_b32 v13, v13, v10
    v_lshlrev_b32 v13, 4, v13
    v_lshl_add_u32 v24, v12, 8, v13
    v_add_u32 v12, 4, v12
    v_mul_u32_u24 v13, 52429, v12
    v_bfe_u32 v13, v13, 18, 4
    v_xor_b32 v13, v13, v10
    v_lshlrev_b32 v13, 4, v13
    v_lshl_add_u32 v25, v12, 8, v13
    v_add_u32 v12, 4, v12
    v_add_u32 v13, 0, v11
    v_xor_b32 v13, v13, v10
    v_mul_u32_u24 v88, 1280, v10
    v_lshl_add_u32 v88, v13, 4, v88
    v_add_u32 v13, 4, v11
    v_xor_b32 v13, v13, v10
    v_mul_u32_u24 v89, 1280, v10
    v_lshl_add_u32 v89, v13, 4, v89
    v_add_u32 v13, 8, v11
    v_xor_b32 v13, v13, v10
    v_mul_u32_u24 v90, 1280, v10
    v_lshl_add_u32 v90, v13, 4, v90
    v_add_u32 v13, 12, v11
    v_xor_b32 v13, v13, v10
    v_mul_u32_u24 v91, 1280, v10
    v_lshl_add_u32 v91, v13, 4, v91
    s_mul_i32 s49, s5, 10240
    s_mov_b32 s51, 0
    s_add_u32 m0, s49, 0
    s_nop 0
    buffer_load_dwordx4 v16, s[16:19], s51 offen lds
    s_add_u32 m0, s49, 1024
    s_nop 0
    buffer_load_dwordx4 v17, s[16:19], s51 offen lds
    s_add_u32 m0, s49, 2048
    s_nop 0
    buffer_load_dwordx4 v18, s[16:19], s51 offen lds
    s_add_u32 m0, s49, 3072
    s_nop 0
    buffer_load_dwordx4 v19, s[16:19], s51 offen lds
    s_add_u32 m0, s49, 4096
    s_nop 0
    buffer_load_dwordx4 v20, s[16:19], s51 offen lds
    s_add_u32 m0, s49, 5120
    s_nop 0
    buffer_load_dwordx4 v21, s[16:19], s51 offen lds
    s_add_u32 m0, s49, 6144
    s_nop 0
    buffer_load_dwordx4 v22, s[16:19], s51 offen lds
    s_add_u32 m0, s49, 7168
    s_nop 0
    buffer_load_dwordx4 v23, s[16:19], s51 offen lds
    s_add_u32 m0, s49, 8192
    s_nop 0
    buffer_load_dwordx4 v24, s[16:19], s51 offen lds
    s_add_u32 m0, s49, 9216
    s_nop 0
    buffer_load_dwordx4 v25, s[16:19], s51 offen lds
    s_add_u32 s49, s49, 40960
    s_mov_b32 s51, 40960
    s_add_u32 m0, s49, 0
    s_nop 0
    buffer_load_dwordx4 v16, s[16:19], s51 offen lds
    s_add_u32 m0, s49, 1024
    s_nop 0
    buffer_load_dwordx4 v17, s[16:19], s51 offen lds
    s_add_u32 m0, s49, 2048
    s_nop 0
    buffer_load_dwordx4 v18, s[16:19], s51 offen lds
    s_add_u32 m0, s49, 3072
    s_nop 0
    buffer_load_dwordx4 v19, s[16:19], s51 offen lds
    s_add_u32 m0, s49, 4096
    s_nop 0
    buffer_load_dwordx4 v20, s[16:19], s51 offen lds
    s_add_u32 m0, s49, 5120
    s_nop 0
    buffer_load_dwordx4 v21, s[16:19], s51 offen lds
    s_add_u32 m0, s49, 6144
    s_nop 0
    buffer_load_dwordx4 v22, s[16:19], s51 offen lds
    s_add_u32 m0, s49, 7168
    s_nop 0
    buffer_load_dwordx4 v23, s[16:19], s51 offen lds
    s_add_u32 m0, s49, 8192
    s_nop 0
    buffer_load_dwordx4 v24, s[16:19], s51 offen lds
    s_add_u32 m0, s49, 9216
    s_nop 0
    buffer_load_dwordx4 v25, s[16:19], s51 offen lds
    v_lshrrev_b32 v10, 4, v0
    v_and_b32 v11, 15, v0
    v_lshlrev_b32 v2, 13, v10
    v_lshl_add_u32 v2, v11, 4, v2
    s_lshl_b32 s32, s29, 8
    v_add_u32 v2, s32, v2
    v_mul_u32_u24 v3, 288, v10
    v_lshl_add_u32 v3, v11, 4, v3
    v_add_u32 v3, 122880, v3
    v_lshrrev_b32 v10, 4, v1
    v_bfe_u32 v11, v1, 2, 2
    v_lshl_add_u32 v10, v10, 3, v11
    v_mul_u32_u24 v4, 288, v10
    v_and_b32 v10, 3, v1
    v_lshl_add_u32 v4, v10, 3, v4
    s_lshl_b32 s32, s5, 6
    s_add_u32 s32, s32, 122880
    v_add_u32 v4, s32, v4
    s_mov_b32 s50, 0
    buffer_load_dwordx4 v[128:131], v2, s[12:15], s50 offen
    s_mov_b32 s50, 131072
    buffer_load_dwordx4 v[132:135], v2, s[12:15], s50 offen
    s_mov_b32 s50, 262144
    buffer_load_dwordx4 v[136:139], v2, s[12:15], s50 offen
    s_mov_b32 s50, 393216
    buffer_load_dwordx4 v[140:143], v2, s[12:15], s50 offen
    s_mov_b32 s50, 524288
    buffer_load_dwordx4 v[144:147], v2, s[12:15], s50 offen
    s_mov_b32 s50, 655360
    buffer_load_dwordx4 v[148:151], v2, s[12:15], s50 offen
    s_mov_b32 s50, 786432
    buffer_load_dwordx4 v[152:155], v2, s[12:15], s50 offen
    s_mov_b32 s50, 917504
    buffer_load_dwordx4 v[156:159], v2, s[12:15], s50 offen
    s_mov_b32 s50, 1048576
    buffer_load_dwordx4 v[160:163], v2, s[12:15], s50 offen
    s_mov_b32 s50, 1179648
    buffer_load_dwordx4 v[164:167], v2, s[12:15], s50 offen
    s_mov_b32 s50, 1310720
    buffer_load_dwordx4 v[168:171], v2, s[12:15], s50 offen
    s_mov_b32 s50, 1441792
    buffer_load_dwordx4 v[172:175], v2, s[12:15], s50 offen
    s_mov_b32 s50, 1572864
    buffer_load_dwordx4 v[176:179], v2, s[12:15], s50 offen
    s_mov_b32 s50, 1703936
    buffer_load_dwordx4 v[180:183], v2, s[12:15], s50 offen
    s_mov_b32 s50, 1835008
    buffer_load_dwordx4 v[184:187], v2, s[12:15], s50 offen
    s_mov_b32 s50, 1966080
    buffer_load_dwordx4 v[188:191], v2, s[12:15], s50 offen
    s_mov_b32 s50, 2097152
    buffer_load_dwordx4 v[192:195], v2, s[12:15], s50 offen
    s_mov_b32 s50, 2228224
    buffer_load_dwordx4 v[196:199], v2, s[12:15], s50 offen
    s_mov_b32 s50, 2359296
    buffer_load_dwordx4 v[200:203], v2, s[12:15], s50 offen
    s_mov_b32 s50, 2490368
    buffer_load_dwordx4 v[204:207], v2, s[12:15], s50 offen
    s_mov_b32 s50, 2621440
    buffer_load_dwordx4 v[208:211], v2, s[12:15], s50 offen
    s_mov_b32 s50, 2752512
    buffer_load_dwordx4 v[212:215], v2, s[12:15], s50 offen
    s_mov_b32 s50, 2883584
    buffer_load_dwordx4 v[216:219], v2, s[12:15], s50 offen
    s_mov_b32 s50, 3014656
    buffer_load_dwordx4 v[220:223], v2, s[12:15], s50 offen
    s_mov_b32 s50, 3145728
    buffer_load_dwordx4 v[224:227], v2, s[12:15], s50 offen
    s_mov_b32 s50, 3276800
    buffer_load_dwordx4 v[228:231], v2, s[12:15], s50 offen
    s_mov_b32 s50, 3407872
    buffer_load_dwordx4 v[232:235], v2, s[12:15], s50 offen
    s_mov_b32 s50, 3538944
    buffer_load_dwordx4 v[236:239], v2, s[12:15], s50 offen
    s_mov_b32 s50, 3670016
    buffer_load_dwordx4 v[240:243], v2, s[12:15], s50 offen
    s_mov_b32 s50, 3801088
    buffer_load_dwordx4 v[244:247], v2, s[12:15], s50 offen
    s_mov_b32 s50, 3932160
    buffer_load_dwordx4 v[248:251], v2, s[12:15], s50 offen
    s_mov_b32 s50, 4063232
    buffer_load_dwordx4 v[252:255], v2, s[12:15], s50 offen
    s_getpc_b64 s[32:33]
    s_add_u32 s32, s32, L_proj_run-.
    s_addc_u32 s33, s33, 0
    s_lshl_b32 s34, s29, 8
    v_lshl_add_u32 v9, v0, 2, s34
    v_min_u32 v9, L_code_end-L_proj_run, v9
    global_load_dword v9, v9, s[32:33]
    s_or_b32 s32, s4, s5
    s_cbranch_scc1 Lreg_9
    s_lshl_b32 s32, 1, s29
    s_mov_b32 s33, 0x100
    s_lshl_b32 s34, s28, 5
    s_waitcnt vmcnt(53)
    s_atomic_add_x2 s[32:33], s[6:7], s34
    s_waitcnt lgkmcnt(0)
Lreg_9:
L_proj_run:
    s_waitcnt vmcnt(29)
    ds_write_b128 v3, v[128:131] offset:0
    ds_write_b128 v3, v[132:135] offset:4608
    ds_write_b128 v3, v[136:139] offset:9216
    ds_write_b128 v3, v[140:143] offset:13824
    s_waitcnt lgkmcnt(0)
    s_mov_b32 s50, 4194304
    buffer_load_dwordx4 v[128:131], v2, s[12:15], s50 offen
    s_mov_b32 s50, 4325376
    buffer_load_dwordx4 v[132:135], v2, s[12:15], s50 offen
    s_mov_b32 s50, 4456448
    buffer_load_dwordx4 v[136:139], v2, s[12:15], s50 offen
    s_mov_b32 s50, 4587520
    buffer_load_dwordx4 v[140:143], v2, s[12:15], s50 offen
    s_barrier
    ds_read_b64_tr_b16 a[0:1], v4 offset:0
    ds_read_b64_tr_b16 a[2:3], v4 offset:1152
    ds_read_b64_tr_b16 a[4:5], v4 offset:32
    ds_read_b64_tr_b16 a[6:7], v4 offset:1184
    ds_read_b64_tr_b16 a[8:9], v4 offset:9216
    ds_read_b64_tr_b16 a[10:11], v4 offset:10368
    ds_read_b64_tr_b16 a[12:13], v4 offset:9248
    ds_read_b64_tr_b16 a[14:15], v4 offset:10400
    s_waitcnt vmcnt(29)
    ds_write_b128 v3, v[144:147] offset:18432
    ds_write_b128 v3, v[148:151] offset:23040
    ds_write_b128 v3, v[152:155] offset:27648
    ds_write_b128 v3, v[156:159] offset:32256
    s_waitcnt lgkmcnt(0)
    s_mov_b32 s50, 4718592
    buffer_load_dwordx4 v[144:147], v2, s[12:15], s50 offen
    s_mov_b32 s50, 4849664
    buffer_load_dwordx4 v[148:151], v2, s[12:15], s50 offen
    s_mov_b32 s50, 4980736
    buffer_load_dwordx4 v[152:155], v2, s[12:15], s50 offen
    s_mov_b32 s50, 5111808
    buffer_load_dwordx4 v[156:159], v2, s[12:15], s50 offen
    s_barrier
    ds_read_b64_tr_b16 a[16:17], v4 offset:18432
    ds_read_b64_tr_b16 a[18:19], v4 offset:19584
    ds_read_b64_tr_b16 a[20:21], v4 offset:18464
    ds_read_b64_tr_b16 a[22:23], v4 offset:19616
    ds_read_b64_tr_b16 a[24:25], v4 offset:27648
    ds_read_b64_tr_b16 a[26:27], v4 offset:28800
    ds_read_b64_tr_b16 a[28:29], v4 offset:27680
    ds_read_b64_tr_b16 a[30:31], v4 offset:28832
    s_waitcnt vmcnt(29)
    ds_write_b128 v3, v[160:163] offset:0
    ds_write_b128 v3, v[164:167] offset:4608
    ds_write_b128 v3, v[168:171] offset:9216
    ds_write_b128 v3, v[172:175] offset:13824
    s_waitcnt lgkmcnt(0)
    s_barrier
    ds_read_b64_tr_b16 a[32:33], v4 offset:0
    ds_read_b64_tr_b16 a[34:35], v4 offset:1152
    ds_read_b64_tr_b16 a[36:37], v4 offset:32
    ds_read_b64_tr_b16 a[38:39], v4 offset:1184
    ds_read_b64_tr_b16 a[40:41], v4 offset:9216
    ds_read_b64_tr_b16 a[42:43], v4 offset:10368
    ds_read_b64_tr_b16 a[44:45], v4 offset:9248
    ds_read_b64_tr_b16 a[46:47], v4 offset:10400
    s_waitcnt vmcnt(25)
    ds_write_b128 v3, v[176:179] offset:18432
    ds_write_b128 v3, v[180:183] offset:23040
    ds_write_b128 v3, v[184:187] offset:27648
    ds_write_b128 v3, v[188:191] offset:32256
    s_waitcnt lgkmcnt(0)
    s_barrier
    ds_read_b64_tr_b16 a[48:49], v4 offset:18432
    ds_read_b64_tr_b16 a[50:51], v4 offset:19584
    ds_read_b64_tr_b16 a[52:53], v4 offset:18464
    ds_read_b64_tr_b16 a[54:55], v4 offset:19616
    ds_read_b64_tr_b16 a[56:57], v4 offset:27648
    ds_read_b64_tr_b16 a[58:59], v4 offset:28800
    ds_read_b64_tr_b16 a[60:61], v4 offset:27680
    ds_read_b64_tr_b16 a[62:63], v4 offset:28832
    s_waitcnt vmcnt(21)
    ds_write_b128 v3, v[192:195] offset:0
    ds_write_b128 v3, v[196:199] offset:4608
    ds_write_b128 v3, v[200:203] offset:9216
    ds_write_b128 v3, v[204:207] offset:13824
    s_waitcnt lgkmcnt(0)
    s_barrier
    ds_read_b64_tr_b16 a[64:65], v4 offset:0
    ds_read_b64_tr_b16 a[66:67], v4 offset:1152
    ds_read_b64_tr_b16 a[68:69], v4 offset:32
    ds_read_b64_tr_b16 a[70:71], v4 offset:1184
    ds_read_b64_tr_b16 a[72:73], v4 offset:9216
    ds_read_b64_tr_b16 a[74:75], v4 offset:10368
    ds_read_b64_tr_b16 a[76:77], v4 offset:9248
    ds_read_b64_tr_b16 a[78:79], v4 offset:10400
    s_waitcnt vmcnt(17)
    ds_write_b128 v3, v[208:211] offset:18432
    ds_write_b128 v3, v[212:215] offset:23040
    ds_write_b128 v3, v[216:219] offset:27648
    ds_write_b128 v3, v[220:223] offset:32256
    s_waitcnt lgkmcnt(0)
    s_barrier
    ds_read_b64_tr_b16 a[80:81], v4 offset:18432
    ds_read_b64_tr_b16 a[82:83], v4 offset:19584
    ds_read_b64_tr_b16 a[84:85], v4 offset:18464
    ds_read_b64_tr_b16 a[86:87], v4 offset:19616
    ds_read_b64_tr_b16 a[88:89], v4 offset:27648
    ds_read_b64_tr_b16 a[90:91], v4 offset:28800
    ds_read_b64_tr_b16 a[92:93], v4 offset:27680
    ds_read_b64_tr_b16 a[94:95], v4 offset:28832
    s_waitcnt vmcnt(13)
    ds_write_b128 v3, v[224:227] offset:0
    ds_write_b128 v3, v[228:231] offset:4608
    ds_write_b128 v3, v[232:235] offset:9216
    ds_write_b128 v3, v[236:239] offset:13824
    s_waitcnt lgkmcnt(0)
    s_barrier
    ds_read_b64_tr_b16 a[96:97], v4 offset:0
    ds_read_b64_tr_b16 a[98:99], v4 offset:1152
    ds_read_b64_tr_b16 a[100:101], v4 offset:32
    ds_read_b64_tr_b16 a[102:103], v4 offset:1184
    ds_read_b64_tr_b16 a[104:105], v4 offset:9216
    ds_read_b64_tr_b16 a[106:107], v4 offset:10368
    ds_read_b64_tr_b16 a[108:109], v4 offset:9248
    ds_read_b64_tr_b16 a[110:111], v4 offset:10400
    s_waitcnt vmcnt(9)
    ds_write_b128 v3, v[240:243] offset:18432
    ds_write_b128 v3, v[244:247] offset:23040
    ds_write_b128 v3, v[248:251] offset:27648
    ds_write_b128 v3, v[252:255] offset:32256
    s_waitcnt lgkmcnt(0)
    s_barrier
    ds_read_b64_tr_b16 a[112:113], v4 offset:18432
    ds_read_b64_tr_b16 a[114:115], v4 offset:19584
    ds_read_b64_tr_b16 a[116:117], v4 offset:18464
    ds_read_b64_tr_b16 a[118:119], v4 offset:19616
    ds_read_b64_tr_b16 a[120:121], v4 offset:27648
    ds_read_b64_tr_b16 a[122:123], v4 offset:28800
    ds_read_b64_tr_b16 a[124:125], v4 offset:27680
    ds_read_b64_tr_b16 a[126:127], v4 offset:28832
    s_waitcnt vmcnt(4)
    ds_write_b128 v3, v[128:131] offset:0
    ds_write_b128 v3, v[132:135] offset:4608
    ds_write_b128 v3, v[136:139] offset:9216
    ds_write_b128 v3, v[140:143] offset:13824
    s_waitcnt lgkmcnt(0)
    s_barrier
    ds_read_b64_tr_b16 a[128:129], v4 offset:0
    ds_read_b64_tr_b16 a[130:131], v4 offset:1152
    ds_read_b64_tr_b16 a[132:133], v4 offset:32
    ds_read_b64_tr_b16 a[134:135], v4 offset:1184
    ds_read_b64_tr_b16 a[136:137], v4 offset:9216
    ds_read_b64_tr_b16 a[138:139], v4 offset:10368
    ds_read_b64_tr_b16 a[140:141], v4 offset:9248
    ds_read_b64_tr_b16 a[142:143], v4 offset:10400
    s_waitcnt vmcnt(0)
    ds_write_b128 v3, v[144:147] offset:18432
    ds_write_b128 v3, v[148:151] offset:23040
    ds_write_b128 v3, v[152:155] offset:27648
    ds_write_b128 v3, v[156:159] offset:32256
    s_waitcnt lgkmcnt(0)
    s_barrier
    ds_read_b64_tr_b16 a[144:145], v4 offset:18432
    ds_read_b64_tr_b16 a[146:147], v4 offset:19584
    ds_read_b64_tr_b16 a[148:149], v4 offset:18464
    ds_read_b64_tr_b16 a[150:151], v4 offset:19616
    ds_read_b64_tr_b16 a[152:153], v4 offset:27648
    ds_read_b64_tr_b16 a[154:155], v4 offset:28800
    ds_read_b64_tr_b16 a[156:157], v4 offset:27680
    ds_read_b64_tr_b16 a[158:159], v4 offset:28832
    s_waitcnt lgkmcnt(0)
    s_barrier
    s_cmp_lg_u32 s4, 0
    s_cbranch_scc1 Lverd_10_ok
    v_and_b32 v12, 7, v1
    v_lshlrev_b32 v12, 5, v12
    s_mov_b32 s30, 131072
Lverd_10:
    global_load_dwordx2 v[10:11], v12, s[6:7] sc1
    s_sub_u32 s30, s30, 1
    s_cbranch_scc1 L_abort
    s_mov_b32 s32, 0x2000
    s_waitcnt vmcnt(0)
    v_cmp_ne_u32 vcc, -1, v10
    v_cmp_ne_u32 s[34:35], s32, v11
    s_nop 0
    s_or_b64 vcc, vcc, s[34:35]
    s_cbranch_scc0 Lverd_10_ok
    v_lshrrev_b32 v11, 8, v11
    s_mov_b32 s32, 0
    v_readlane_b32 s33, v11, 0
    s_nop 0
    s_add_u32 s32, s32, s33
    v_readlane_b32 s33, v11, 1
    s_nop 0
    s_add_u32 s32, s32, s33
    v_readlane_b32 s33, v11, 2
    s_nop 0
    s_add_u32 s32, s32, s33
    v_readlane_b32 s33, v11, 3
    s_nop 0
    s_add_u32 s32, s32, s33
    v_readlane_b32 s33, v11, 4
    s_nop 0
    s_add_u32 s32, s32, s33
    v_readlane_b32 s33, v11, 5
    s_nop 0
    s_add_u32 s32, s32, s33
    v_readlane_b32 s33, v11, 6
    s_nop 0
    s_add_u32 s32, s32, s33
    v_readlane_b32 s33, v11, 7
    s_nop 0
    s_add_u32 s32, s32, s33
    s_cmp_eq_u32 s32, 256
    s_cbranch_scc1 L_restart_safe
    s_sleep 8
    s_branch Lverd_10
Lverd_10_ok:
    s_mov_b32 s30, 131072
    v_mov_b32 v10, 16
Lpol_11:
    global_load_dword v11, v10, s[6:7] sc1
    s_sub_u32 s30, s30, 1
    s_cbranch_scc1 L_abort
    s_waitcnt vmcnt(0)
    v_readfirstlane_b32 s53, v11
    s_nop 0
    s_cmp_lg_u32 s53, 0
    s_cbranch_scc1 Lpol_11_ok
    s_sleep 4
    s_branch Lpol_11
Lpol_11_ok:
    s_and_b32 s53, s53, 2
    s_lshl_b32 s53, s53, 12
    s_sub_u32 s32, s28, 5
    s_cmp_eq_u32 s32, 1
    s_cselect_b32 s33, 33554432, 0
    s_add_u32 s33, s33, 4194304
    s_lshl_b32 s34, s32, 12
    s_and_b32 s34, s34, 8192
    s_xor_b32 s53, s53, s34
    s_add_u32 s53, s53, s33
    s_lshl_b32 s34, s29, 14
    s_add_u32 s53, s53, s34
    s_lshl_b32 s33, s29, 4
    s_add_u32 s32, s32, s33
    s_lshl_b32 s32, s32, 3
    s_add_u32 s32, s32, 94208
    v_mov_b32 v8, 2147418112
    v_mov_b32 v10, s32
    v_cmp_eq_u32 vcc, 0, v0
    s_nop 1
    v_cndmask_b32 v8, v8, v10, vcc
    s_mov_b32 s48, 0
    s_mov_b32 s52, 0
    s_mov_b32 s54, 81920
    s_mov_b32 s51, 81920
    s_cmp_eq_u32 s28, 6
    s_cbranch_scc1 L_proj_v
L_proj_kq:
    s_lshl_b32 s32, s5, 10
    v_lshl_add_u32 v7, v1, 4, s32
L_proj_kq_loop:
    s_sub_u32 s32, s48, 2
    s_max_i32 s32, s32, 3
    s_cmp_gt_u32 s48, 3
    s_cbranch_scc1 L_proj_kq_late
    s_mov_b32 s32, s48
    s_waitcnt vmcnt(0)
L_proj_kq_late:
    s_waitcnt vmcnt(15)
    s_barrier
    v_mov_b32 v10, s32
    buffer_store_dword v10, v8, s[8:11], 0 offen sc1
    v_add_u32 v92, s52, v88
    v_add_u32 v93, s52, v89
    v_add_u32 v94, s52, v90
    v_add_u32 v95, s52, v91
    s_mul_i32 s49, s5, 10240
    s_add_u32 s49, s49, s54
    ds_read_b128 v[32:35], v92 offset:0
    ds_read_b128 v[36:39], v92 offset:20480
    ds_read_b128 v[40:43], v93 offset:0
    ds_read_b128 v[44:47], v93 offset:20480
    ds_read_b128 v[48:51], v94 offset:0
    ds_read_b128 v[52:55], v94 offset:20480
    ds_read_b128 v[56:59], v95 offset:0
    ds_read_b128 v[60:63], v95 offset:20480
    s_waitcnt lgkmcnt(6)
    v_mfma_f32_16x16x32_bf16 v[64:67], a[0:3], v[32:35], 0
    v_mfma_f32_16x16x32_bf16 v[68:71], a[4:7], v[32:35], 0
    s_add_u32 m0, s49, 0
    s_nop 0
    buffer_load_dwordx4 v16, s[16:19], s51 offen lds
    v_mfma_f32_16x16x32_bf16 v[72:75], a[0:3], v[36:39], 0
    v_mfma_f32_16x16x32_bf16 v[76:79], a[4:7], v[36:39], 0
    ds_read_b128 v[32:35], v92 offset:256
    ds_read_b128 v[36:39], v92 offset:20736
    s_waitcnt lgkmcnt(6)
    v_mfma_f32_16x16x32_bf16 v[64:67], a[8:11], v[40:43], v[64:67]
    v_mfma_f32_16x16x32_bf16 v[68:71], a[12:15], v[40:43], v[68:71]
    v_mfma_f32_16x16x32_bf16 v[72:75], a[8:11], v[44:47], v[72:75]
    v_mfma_f32_16x16x32_bf16 v[76:79], a[12:15], v[44:47], v[76:79]
    ds_read_b128 v[40:43], v93 offset:256
    ds_read_b128 v[44:47], v93 offset:20736
    s_waitcnt lgkmcnt(6)
    v_mfma_f32_16x16x32_bf16 v[64:67], a[16:19], v[48:51], v[64:67]
    v_mfma_f32_16x16x32_bf16 v[68:71], a[20:23], v[48:51], v[68:71]
    s_add_u32 m0, s49, 1024
    s_nop 0
    buffer_load_dwordx4 v17, s[16:19], s51 offen lds
    v_mfma_f32_16x16x32_bf16 v[72:75], a[16:19], v[52:55], v[72:75]
    v_mfma_f32_16x16x32_bf16 v[76:79], a[20:23], v[52:55], v[76:79]
    ds_read_b128 v[48:51], v94 offset:256
    ds_read_b128 v[52:55], v94 offset:20736
    s_waitcnt lgkmcnt(6)
    v_mfma_f32_16x16x32_bf16 v[64:67], a[24:27], v[56:59], v[64:67]
    v_mfma_f32_16x16x32_bf16 v[68:71], a[28:31], v[56:59], v[68:71]
    v_mfma_f32_16x16x32_bf16 v[72:75], a[24:27], v[60:63], v[72:75]
    v_mfma_f32_16x16x32_bf16 v[76:79], a[28:31], v[60:63], v[76:79]
    ds_read_b128 v[56:59], v95 offset:256
    ds_read_b128 v[60:63], v95 offset:20736
    s_waitcnt lgkmcnt(6)
    v_mfma_f32_16x16x32_bf16 v[64:67], a[32:35], v[32:35], v[64:67]
    v_mfma_f32_16x16x32_bf16 v[68:71], a[36:39], v[32:35], v[68:71]
    s_add_u32 m0, s49, 2048
    s_nop 0
    buffer_load_dwordx4 v18, s[16:19], s51 offen lds
    v_mfma_f32_16x16x32_bf16 v[72:75], a[32:35], v[36:39], v[72:75]
    v_mfma_f32_16x16x32_bf16 v[76:79], a[36:39], v[36:39], v[76:79]
    ds_read_b128 v[32:35], v92 offset:512
    ds_read_b128 v[36:39], v92 offset:20992
    s_waitcnt lgkmcnt(6)
    v_mfma_f32_16x16x32_bf16 v[64:67], a[40:43], v[40:43], v[64:67]
    v_mfma_f32_16x16x32_bf16 v[68:71], a[44:47], v[40:43], v[68:71]
    v_mfma_f32_16x16x32_bf16 v[72:75], a[40:43], v[44:47], v[72:75]
    v_mfma_f32_16x16x32_bf16 v[76:79], a[44:47], v[44:47], v[76:79]
    ds_read_b128 v[40:43], v93 offset:512
    ds_read_b128 v[44:47], v93 offset:20992
    s_waitcnt lgkmcnt(6)
    v_mfma_f32_16x16x32_bf16 v[64:67], a[48:51], v[48:51], v[64:67]
    v_mfma_f32_16x16x32_bf16 v[68:71], a[52:55], v[48:51], v[68:71]
    s_add_u32 m0, s49, 3072
    s_nop 0
    buffer_load_dwordx4 v19, s[16:19], s51 offen lds
    v_mfma_f32_16x16x32_bf16 v[72:75], a[48:51], v[52:55], v[72:75]
    v_mfma_f32_16x16x32_bf16 v[76:79], a[52:55], v[52:55], v[76:79]
    ds_read_b128 v[48:51], v94 offset:512
    ds_read_b128 v[52:55], v94 offset:20992
    s_waitcnt lgkmcnt(6)
    v_mfma_f32_16x16x32_bf16 v[64:67], a[56:59], v[56:59], v[64:67]
    v_mfma_f32_16x16x32_bf16 v[68:71], a[60:63], v[56:59], v[68:71]
    v_mfma_f32_16x16x32_bf16 v[72:75], a[56:59], v[60:63], v[72:75]
    v_mfma_f32_16x16x32_bf16 v[76:79], a[60:63], v[60:63], v[76:79]
    ds_read_b128 v[56:59], v95 offset:512
    ds_read_b128 v[60:63], v95 offset:20992
    s_waitcnt lgkmcnt(6)
    v_mfma_f32_16x16x32_bf16 v[64:67], a[64:67], v[32:35], v[64:67]
    v_mfma_f32_16x16x32_bf16 v[68:71], a[68:71], v[32:35], v[68:71]
    s_add_u32 m0, s49, 4096
    s_nop 0
    buffer_load_dwordx4 v20, s[16:19], s51 offen lds
    v_mfma_f32_16x16x32_bf16 v[72:75], a[64:67], v[36:39], v[72:75]
    v_mfma_f32_16x16x32_bf16 v[76:79], a[68:71], v[36:39], v[76:79]
    ds_read_b128 v[32:35], v92 offset:768
    ds_read_b128 v[36:39], v92 offset:21248
    s_waitcnt lgkmcnt(6)
    v_mfma_f32_16x16x32_bf16 v[64:67], a[72:75], v[40:43], v[64:67]
    v_mfma_f32_16x16x32_bf16 v[68:71], a[76:79], v[40:43], v[68:71]
    v_mfma_f32_16x16x32_bf16 v[72:75], a[72:75], v[44:47], v[72:75]
    v_mfma_f32_16x16x32_bf16 v[76:79], a[76:79], v[44:47], v[76:79]
    ds_read_b128 v[40:43], v93 offset:768
    ds_read_b128 v[44:47], v93 offset:21248
    s_waitcnt lgkmcnt(6)
    v_mfma_f32_16x16x32_bf16 v[64:67], a[80:83], v[48:51], v[64:67]
    v_mfma_f32_16x16x32_bf16 v[68:71], a[84:87], v[48:51], v[68:71]
    s_add_u32 m0, s49, 5120
    s_nop 0
    buffer_load_dwordx4 v21, s[16:19], s51 offen lds
    v_mfma_f32_16x16x32_bf16 v[72:75], a[80:83], v[52:55], v[72:75]
    v_mfma_f32_16x16x32_bf16 v[76:79], a[84:87], v[52:55], v[76:79]
    ds_read_b128 v[48:51], v94 offset:768
    ds_read_b128 v[52:55], v94 offset:21248
    s_waitcnt lgkmcnt(6)
    v_mfma_f32_16x16x32_bf16 v[64:67], a[88:91], v[56:59], v[64:67]
    v_mfma_f32_16x16x32_bf16 v[68:71], a[92:95], v[56:59], v[68:71]
    v_mfma_f32_16x16x32_bf16 v[72:75], a[88:91], v[60:63], v[72:75]
    v_mfma_f32_16x16x32_bf16 v[76:79], a[92:95], v[60:63], v[76:79]
    ds_read_b128 v[56:59], v95 offset:768
    ds_read_b128 v[60:63], v95 offset:21248
    s_waitcnt lgkmcnt(6)
    v_mfma_f32_16x16x32_bf16 v[64:67], a[96:99], v[32:35], v[64:67]
    v_mfma_f32_16x16x32_bf16 v[68:71], a[100:103], v[32:35], v[68:71]
    s_add_u32 m0, s49, 6144
    s_nop 0
    buffer_load_dwordx4 v22, s[16:19], s51 offen lds
    v_mfma_f32_16x16x32_bf16 v[72:75], a[96:99], v[36:39], v[72:75]
    v_mfma_f32_16x16x32_bf16 v[76:79], a[100:103], v[36:39], v[76:79]
    ds_read_b128 v[32:35], v92 offset:1024
    ds_read_b128 v[36:39], v92 offset:21504
    s_waitcnt lgkmcnt(6)
    v_mfma_f32_16x16x32_bf16 v[64:67], a[104:107], v[40:43], v[64:67]
    v_mfma_f32_16x16x32_bf16 v[68:71], a[108:111], v[40:43], v[68:71]
    v_mfma_f32_16x16x32_bf16 v[72:75], a[104:107], v[44:47], v[72:75]
    v_mfma_f32_16x16x32_bf16 v[76:79], a[108:111], v[44:47], v[76:79]
    ds_read_b128 v[40:43], v93 offset:1024
    ds_read_b128 v[44:47], v93 offset:21504
    s_waitcnt lgkmcnt(6)
    v_mfma_f32_16x16x32_bf16 v[64:67], a[112:115], v[48:51], v[64:67]
    v_mfma_f32_16x16x32_bf16 v[68:71], a[116:119], v[48:51], v[68:71]
    s_add_u32 m0, s49, 7168
    s_nop 0
    buffer_load_dwordx4 v23, s[16:19], s51 offen lds
    v_mfma_f32_16x16x32_bf16 v[72:75], a[112:115], v[52:55], v[72:75]
    v_mfma_f32_16x16x32_bf16 v[76:79], a[116:119], v[52:55], v[76:79]
    ds_read_b128 v[48:51], v94 offset:1024
    ds_read_b128 v[52:55], v94 offset:21504
    s_waitcnt lgkmcnt(6)
    v_mfma_f32_16x16x32_bf16 v[64:67], a[120:123], v[56:59], v[64:67]
    v_mfma_f32_16x16x32_bf16 v[68:71], a[124:127], v[56:59], v[68:71]
    v_mfma_f32_16x16x32_bf16 v[72:75], a[120:123], v[60:63], v[72:75]
    v_mfma_f32_16x16x32_bf16 v[76:79], a[124:127], v[60:63], v[76:79]
    ds_read_b128 v[56:59], v95 offset:1024
    ds_read_b128 v[60:63], v95 offset:21504
    s_waitcnt lgkmcnt(6)
    v_mfma_f32_16x16x32_bf16 v[64:67], a[128:131], v[32:35], v[64:67]
    v_mfma_f32_16x16x32_bf16 v[68:71], a[132:135], v[32:35], v[68:71]
    s_add_u32 m0, s49, 8192
    s_nop 0
    buffer_load_dwordx4 v24, s[16:19], s51 offen lds
    v_mfma_f32_16x16x32_bf16 v[72:75], a[128:131], v[36:39], v[72:75]
    v_mfma_f32_16x16x32_bf16 v[76:79], a[132:135], v[36:39], v[76:79]
    s_waitcnt lgkmcnt(4)
    v_mfma_f32_16x16x32_bf16 v[64:67], a[136:139], v[40:43], v[64:67]
    v_mfma_f32_16x16x32_bf16 v[68:71], a[140:143], v[40:43], v[68:71]
    v_mfma_f32_16x16x32_bf16 v[72:75], a[136:139], v[44:47], v[72:75]
    v_mfma_f32_16x16x32_bf16 v[76:79], a[140:143], v[44:47], v[76:79]
    s_waitcnt lgkmcnt(2)
    v_mfma_f32_16x16x32_bf16 v[64:67], a[144:147], v[48:51], v[64:67]
    v_mfma_f32_16x16x32_bf16 v[68:71], a[148:151], v[48:51], v[68:71]
    s_add_u32 m0, s49, 9216
    s_nop 0
    buffer_load_dwordx4 v25, s[16:19], s51 offen lds
    v_mfma_f32_16x16x32_bf16 v[72:75], a[144:147], v[52:55], v[72:75]
    v_mfma_f32_16x16x32_bf16 v[76:79], a[148:151], v[52:55], v[76:79]
    s_waitcnt lgkmcnt(0)
    v_mfma_f32_16x16x32_bf16 v[64:67], a[152:155], v[56:59], v[64:67]
    v_mfma_f32_16x16x32_bf16 v[68:71], a[156:159], v[56:59], v[68:71]
    v_mfma_f32_16x16x32_bf16 v[72:75], a[152:155], v[60:63], v[72:75]
    v_mfma_f32_16x16x32_bf16 v[76:79], a[156:159], v[60:63], v[76:79]
    v_cvt_pk_bf16_f32 v80, v64, v68
    v_cvt_pk_bf16_f32 v81, v65, v69
    v_cvt_pk_bf16_f32 v82, v66, v70
    v_cvt_pk_bf16_f32 v83, v67, v71
    s_add_u32 s50, s53, 0
    buffer_store_dwordx4 v[80:83], v7, s[8:11], s50 offen sc1
    s_nop 1
    v_cvt_pk_bf16_f32 v84, v72, v76
    v_cvt_pk_bf16_f32 v85, v73, v77
    v_cvt_pk_bf16_f32 v86, v74, v78
    v_cvt_pk_bf16_f32 v87, v75, v79
    s_add_u32 s50, s53, 4096
    buffer_store_dwordx4 v[84:87], v7, s[8:11], s50 offen sc1
    s_add_u32 s53, s53, 524288
    s_and_b32 s32, s48, 3
    s_cmp_eq_u32 s32, 3
    s_cselect_b32 s32, 8192, 0
    s_xor_b32 s53, s53, s32
    s_add_u32 s51, s51, 40960
    s_mov_b32 s54, s52
    s_add_u32 s52, s52, 40960
    s_cmp_eq_u32 s52, 122880
    s_cselect_b32 s52, 0, s52
    s_add_u32 s48, s48, 1
    s_cmp_lt_u32 s48, 64
    s_cbranch_scc1 L_proj_kq_loop
    s_branch L_proj_done
L_proj_v:
    s_lshl_b32 s32, s5, 11
    v_lshl_add_u32 v7, v1, 4, s32
L_proj_v_loop:
    s_sub_u32 s32, s48, 2
    s_max_i32 s32, s32, 3
    s_cmp_gt_u32 s48, 3
    s_cbranch_scc1 L_proj_v_late
    s_mov_b32 s32, s48
    s_waitcnt vmcnt(0)
L_proj_v_late:
    s_waitcnt vmcnt(15)
    s_barrier
    v_mov_b32 v10, s32
    buffer_store_dword v10, v8, s[8:11], 0 offen sc1
    v_add_u32 v92, s52, v88
    v_add_u32 v93, s52, v89
    v_add_u32 v94, s52, v90
    v_add_u32 v95, s52, v91
    s_mul_i32 s49, s5, 10240
    s_add_u32 s49, s49, s54
    ds_read_b128 v[32:35], v92 offset:0
    ds_read_b128 v[36:39], v92 offset:20480
    ds_read_b128 v[40:43], v93 offset:0
    ds_read_b128 v[44:47], v93 offset:20480
    ds_read_b128 v[48:51], v94 offset:0
    ds_read_b128 v[52:55], v94 offset:20480
    ds_read_b128 v[56:59], v95 offset:0
    ds_read_b128 v[60:63], v95 offset:20480
    s_waitcnt lgkmcnt(6)
    v_mfma_f32_16x16x32_bf16 v[64:67], v[32:35], a[0:3], 0
    v_mfma_f32_16x16x32_bf16 v[68:71], v[32:35], a[4:7], 0
    s_add_u32 m0, s49, 0
    s_nop 0
    buffer_load_dwordx4 v16, s[16:19], s51 offen lds
    v_mfma_f32_16x16x32_bf16 v[72:75], v[36:39], a[0:3], 0
    v_mfma_f32_16x16x32_bf16 v[76:79], v[36:39], a[4:7], 0
    ds_read_b128 v[32:35], v92 offset:256
    ds_read_b128 v[36:39], v92 offset:20736
    s_waitcnt lgkmcnt(6)
    v_mfma_f32_16x16x32_bf16 v[64:67], v[40:43], a[8:11], v[64:67]
    v_mfma_f32_16x16x32_bf16 v[68:71], v[40:43], a[12:15], v[68:71]
    v_mfma_f32_16x16x32_bf16 v[72:75], v[44:47], a[8:11], v[72:75]
    v_mfma_f32_16x16x32_bf16 v[76:79], v[44:47], a[12:15], v[76:79]
    ds_read_b128 v[40:43], v93 offset:256
    ds_read_b128 v[44:47], v93 offset:20736
    s_waitcnt lgkmcnt(6)
    v_mfma_f32_16x16x32_bf16 v[64:67], v[48:51], a[16:19], v[64:67]
    v_mfma_f32_16x16x32_bf16 v[68:71], v[48:51], a[20:23], v[68:71]
    s_add_u32 m0, s49, 1024
    s_nop 0
    buffer_load_dwordx4 v17, s[16:19], s51 offen lds
    v_mfma_f32_16x16x32_bf16 v[72:75], v[52:55], a[16:19], v[72:75]
    v_mfma_f32_16x16x32_bf16 v[76:79], v[52:55], a[20:23], v[76:79]
    ds_read_b128 v[48:51], v94 offset:256
    ds_read_b128 v[52:55], v94 offset:20736
    s_waitcnt lgkmcnt(6)
    v_mfma_f32_16x16x32_bf16 v[64:67], v[56:59], a[24:27], v[64:67]
    v_mfma_f32_16x16x32_bf16 v[68:71], v[56:59], a[28:31], v[68:71]
    v_mfma_f32_16x16x32_bf16 v[72:75], v[60:63], a[24:27], v[72:75]
    v_mfma_f32_16x16x32_bf16 v[76:79], v[60:63], a[28:31], v[76:79]
    ds_read_b128 v[56:59], v95 offset:256
    ds_read_b128 v[60:63], v95 offset:20736
    s_waitcnt lgkmcnt(6)
    v_mfma_f32_16x16x32_bf16 v[64:67], v[32:35], a[32:35], v[64:67]
    v_mfma_f32_16x16x32_bf16 v[68:71], v[32:35], a[36:39], v[68:71]
    s_add_u32 m0, s49, 2048
    s_nop 0
    buffer_load_dwordx4 v18, s[16:19], s51 offen lds
    v_mfma_f32_16x16x32_bf16 v[72:75], v[36:39], a[32:35], v[72:75]
    v_mfma_f32_16x16x32_bf16 v[76:79], v[36:39], a[36:39], v[76:79]
    ds_read_b128 v[32:35], v92 offset:512
    ds_read_b128 v[36:39], v92 offset:20992
    s_waitcnt lgkmcnt(6)
    v_mfma_f32_16x16x32_bf16 v[64:67], v[40:43], a[40:43], v[64:67]
    v_mfma_f32_16x16x32_bf16 v[68:71], v[40:43], a[44:47], v[68:71]
    v_mfma_f32_16x16x32_bf16 v[72:75], v[44:47], a[40:43], v[72:75]
    v_mfma_f32_16x16x32_bf16 v[76:79], v[44:47], a[44:47], v[76:79]
    ds_read_b128 v[40:43], v93 offset:512
    ds_read_b128 v[44:47], v93 offset:20992
    s_waitcnt lgkmcnt(6)
    v_mfma_f32_16x16x32_bf16 v[64:67], v[48:51], a[48:51], v[64:67]
    v_mfma_f32_16x16x32_bf16 v[68:71], v[48:51], a[52:55], v[68:71]
    s_add_u32 m0, s49, 3072
    s_nop 0
    buffer_load_dwordx4 v19, s[16:19], s51 offen lds
    v_mfma_f32_16x16x32_bf16 v[72:75], v[52:55], a[48:51], v[72:75]
    v_mfma_f32_16x16x32_bf16 v[76:79], v[52:55], a[52:55], v[76:79]
    ds_read_b128 v[48:51], v94 offset:512
    ds_read_b128 v[52:55], v94 offset:20992
    s_waitcnt lgkmcnt(6)
    v_mfma_f32_16x16x32_bf16 v[64:67], v[56:59], a[56:59], v[64:67]
    v_mfma_f32_16x16x32_bf16 v[68:71], v[56:59], a[60:63], v[68:71]
    v_mfma_f32_16x16x32_bf16 v[72:75], v[60:63], a[56:59], v[72:75]
    v_mfma_f32_16x16x32_bf16 v[76:79], v[60:63], a[60:63], v[76:79]
    ds_read_b128 v[56:59], v95 offset:512
    ds_read_b128 v[60:63], v95 offset:20992
    s_waitcnt lgkmcnt(6)
    v_mfma_f32_16x16x32_bf16 v[64:67], v[32:35], a[64:67], v[64:67]
    v_mfma_f32_16x16x32_bf16 v[68:71], v[32:35], a[68:71], v[68:71]
    s_add_u32 m0, s49, 4096
    s_nop 0
    buffer_load_dwordx4 v20, s[16:19], s51 offen lds
    v_mfma_f32_16x16x32_bf16 v[72:75], v[36:39], a[64:67], v[72:75]
    v_mfma_f32_16x16x32_bf16 v[76:79], v[36:39], a[68:71], v[76:79]
    ds_read_b128 v[32:35], v92 offset:768
    ds_read_b128 v[36:39], v92 offset:21248
    s_waitcnt lgkmcnt(6)
    v_mfma_f32_16x16x32_bf16 v[64:67], v[40:43], a[72:75], v[64:67]
    v_mfma_f32_16x16x32_bf16 v[68:71], v[40:43], a[76:79], v[68:71]
    v_mfma_f32_16x16x32_bf16 v[72:75], v[44:47], a[72:75], v[72:75]
    v_mfma_f32_16x16x32_bf16 v[76:79], v[44:47], a[76:79], v[76:79]
    ds_read_b128 v[40:43], v93 offset:768
    ds_read_b128 v[44:47], v93 offset:21248
    s_waitcnt lgkmcnt(6)
    v_mfma_f32_16x16x32_bf16 v[64:67], v[48:51], a[80:83], v[64:67]
    v_mfma_f32_16x16x32_bf16 v[68:71], v[48:51], a[84:87], v[68:71]
    s_add_u32 m0, s49, 5120
    s_nop 0
    buffer_load_dwordx4 v21, s[16:19], s51 offen lds
    v_mfma_f32_16x16x32_bf16 v[72:75], v[52:55], a[80:83], v[72:75]
    v_mfma_f32_16x16x32_bf16 v[76:79], v[52:55], a[84:87], v[76:79]
    ds_read_b128 v[48:51], v94 offset:768
    ds_read_b128 v[52:55], v94 offset:21248
    s_waitcnt lgkmcnt(6)
    v_mfma_f32_16x16x32_bf16 v[64:67], v[56:59], a[88:91], v[64:67]
    v_mfma_f32_16x16x32_bf16 v[68:71], v[56:59], a[92:95], v[68:71]
    v_mfma_f32_16x16x32_bf16 v[72:75], v[60:63], a[88:91], v[72:75]
    v_mfma_f32_16x16x32_bf16 v[76:79], v[60:63], a[92:95], v[76:79]
    ds_read_b128 v[56:59], v95 offset:768
    ds_read_b128 v[60:63], v95 offset:21248
    s_waitcnt lgkmcnt(6)
    v_mfma_f32_16x16x32_bf16 v[64:67], v[32:35], a[96:99], v[64:67]
    v_mfma_f32_16x16x32_bf16 v[68:71], v[32:35], a[100:103], v[68:71]
    s_add_u32 m0, s49, 6144
    s_nop 0
    buffer_load_dwordx4 v22, s[16:19], s51 offen lds
    v_mfma_f32_16x16x32_bf16 v[72:75], v[36:39], a[96:99], v[72:75]
    v_mfma_f32_16x16x32_bf16 v[76:79], v[36:39], a[100:103], v[76:79]
    ds_read_b128 v[32:35], v92 offset:1024
    ds_read_b128 v[36:39], v92 offset:21504
    s_waitcnt lgkmcnt(6)
    v_mfma_f32_16x16x32_bf16 v[64:67], v[40:43], a[104:107], v[64:67]
    v_mfma_f32_16x16x32_bf16 v[68:71], v[40:43], a[108:111], v[68:71]
    v_mfma_f32_16x16x32_bf16 v[72:75], v[44:47], a[104:107], v[72:75]
    v_mfma_f32_16x16x32_bf16 v[76:79], v[44:47], a[108:111], v[76:79]
    ds_read_b128 v[40:43], v93 offset:1024
    ds_read_b128 v[44:47], v93 offset:21504
    s_waitcnt lgkmcnt(6)
    v_mfma_f32_16x16x32_bf16 v[64:67], v[48:51], a[112:115], v[64:67]
    v_mfma_f32_16x16x32_bf16 v[68:71], v[48:51], a[116:119], v[68:71]
    s_add_u32 m0, s49, 7168
    s_nop 0
    buffer_load_dwordx4 v23, s[16:19], s51 offen lds
    v_mfma_f32_16x16x32_bf16 v[72:75], v[52:55], a[112:115], v[72:75]
    v_mfma_f32_16x16x32_bf16 v[76:79], v[52:55], a[116:119], v[76:79]
    ds_read_b128 v[48:51], v94 offset:1024
    ds_read_b128 v[52:55], v94 offset:21504
    s_waitcnt lgkmcnt(6)
    v_mfma_f32_16x16x32_bf16 v[64:67], v[56:59], a[120:123], v[64:67]
    v_mfma_f32_16x16x32_bf16 v[68:71], v[56:59], a[124:127], v[68:71]
    v_mfma_f32_16x16x32_bf16 v[72:75], v[60:63], a[120:123], v[72:75]
    v_mfma_f32_16x16x32_bf16 v[76:79], v[60:63], a[124:127], v[76:79]
    ds_read_b128 v[56:59], v95 offset:1024
    ds_read_b128 v[60:63], v95 offset:21504
    s_waitcnt lgkmcnt(6)
    v_mfma_f32_16x16x32_bf16 v[64:67], v[32:35], a[128:131], v[64:67]
    v_mfma_f32_16x16x32_bf16 v[68:71], v[32:35], a[132:135], v[68:71]
    s_add_u32 m0, s49, 8192
    s_nop 0
    buffer_load_dwordx4 v24, s[16:19], s51 offen lds
    v_mfma_f32_16x16x32_bf16 v[72:75], v[36:39], a[128:131], v[72:75]
    v_mfma_f32_16x16x32_bf16 v[76:79], v[36:39], a[132:135], v[76:79]
    s_waitcnt lgkmcnt(4)
    v_mfma_f32_16x16x32_bf16 v[64:67], v[40:43], a[136:139], v[64:67]
    v_mfma_f32_16x16x32_bf16 v[68:71], v[40:43], a[140:143], v[68:71]
    v_mfma_f32_16x16x32_bf16 v[72:75], v[44:47], a[136:139], v[72:75]
    v_mfma_f32_16x16x32_bf16 v[76:79], v[44:47], a[140:143], v[76:79]
    s_waitcnt lgkmcnt(2)
    v_mfma_f32_16x16x32_bf16 v[64:67], v[48:51], a[144:147], v[64:67]
    v_mfma_f32_16x16x32_bf16 v[68:71], v[48:51], a[148:151], v[68:71]
    s_add_u32 m0, s49, 9216
    s_nop 0
    buffer_load_dwordx4 v25, s[16:19], s51 offen lds
    v_mfma_f32_16x16x32_bf16 v[72:75], v[52:55], a[144:147], v[72:75]
    v_mfma_f32_16x16x32_bf16 v[76:79], v[52:55], a[148:151], v[76:79]
    s_waitcnt lgkmcnt(0)
    v_mfma_f32_16x16x32_bf16 v[64:67], v[56:59], a[152:155], v[64:67]
    v_mfma_f32_16x16x32_bf16 v[68:71], v[56:59], a[156:159], v[68:71]
    v_mfma_f32_16x16x32_bf16 v[72:75], v[60:63], a[152:155], v[72:75]
    v_mfma_f32_16x16x32_bf16 v[76:79], v[60:63], a[156:159], v[76:79]
    v_cvt_pk_bf16_f32 v80, v64, v65
    v_cvt_pk_bf16_f32 v81, v66, v67
    s_nop 1
    v_cvt_pk_bf16_f32 v82, v72, v73
    v_cvt_pk_bf16_f32 v83, v74, v75
    buffer_store_dwordx4 v[80:83], v7, s[8:11], s53 offen offset:0 sc1
    v_cvt_pk_bf16_f32 v84, v68, v69
    v_cvt_pk_bf16_f32 v85, v70, v71
    v_cvt_pk_bf16_f32 v86, v76, v77
    v_cvt_pk_bf16_f32 v87, v78, v79
    buffer_store_dwordx4 v[84:87], v7, s[8:11], s53 offen offset:1024 sc1
    s_add_u32 s53, s53, 524288
    s_and_b32 s32, s48, 3
    s_cmp_eq_u32 s32, 3
    s_cselect_b32 s32, 8192, 0
    s_xor_b32 s53, s53, s32
    s_add_u32 s51, s51, 40960
    s_mov_b32 s54, s52
    s_add_u32 s52, s52, 40960
    s_cmp_eq_u32 s52, 122880
    s_cselect_b32 s52, 0, s52
    s_add_u32 s48, s48, 1
    s_cmp_lt_u32 s48, 64
    s_cbranch_scc1 L_proj_v_loop
    s_branch L_proj_done
L_proj_done:
    s_waitcnt vmcnt(0)
    s_barrier
    v_mov_b32 v10, 64
    buffer_store_dword v10, v8, s[8:11], 0 offen sc1
    s_branch L_exit2
L_exit2:
    s_endpgm
L_s4:
    s_load_dwordx2 s[12:13], s[0:1], 56
    s_mov_b32 s14, 2621440
    s_mov_b32 s15, 0x20000
    s_load_dwordx2 s[16:17], s[0:1], 128
    s_mov_b32 s18, 5242880
    s_mov_b32 s19, 0x20000
    s_load_dwordx16 s[56:71], s[0:1], 64
    s_sub_u32 s48, s28, 2
    s_lshl_b32 s48, s48, 5
    s_add_u32 s48, s48, s29
    s_sub_u32 s48, s48, 16
    s_mul_i32 s49, s5, 21792
    s_add_u32 s49, s49, 41600
    v_mul_u32_u24 v2, 10240, v0
    s_lshl_b32 s32, s48, 4
    v_add_u32 v2, s32, v2
    s_waitcnt lgkmcnt(0)
    s_mov_b32 s53, 0
    buffer_load_dwordx4 v[16:19], v2, s[12:15], s53 offen
    s_mov_b32 s53, 1280
    buffer_load_dwordx4 v[20:23], v2, s[12:15], s53 offen
    s_mov_b32 s53, 2560
    buffer_load_dwordx4 v[24:27], v2, s[12:15], s53 offen
    s_mov_b32 s53, 3840
    buffer_load_dwordx4 v[28:31], v2, s[12:15], s53 offen
    s_mov_b32 s53, 5120
    buffer_load_dwordx4 v[32:35], v2, s[12:15], s53 offen
    s_mov_b32 s53, 6400
    buffer_load_dwordx4 v[36:39], v2, s[12:15], s53 offen
    s_mov_b32 s53, 7680
    buffer_load_dwordx4 v[40:43], v2, s[12:15], s53 offen
    s_mov_b32 s53, 8960
    buffer_load_dwordx4 v[44:47], v2, s[12:15], s53 offen
    s_or_b32 s32, s4, s5
    s_cbranch_scc1 Lreg_12
    s_lshl_b32 s32, 1, s29
    s_mov_b32 s33, 0x100
    s_lshl_b32 s34, s28, 5
    s_waitcnt vmcnt(8)
    s_atomic_add_x2 s[32:33], s[6:7], s34
    s_waitcnt lgkmcnt(0)
Lreg_12:
    v_and_b32 v2, 15, v1
    v_lshrrev_b32 v3, 4, v1
    v_lshlrev_b32 v4, 3, v2
    v_cvt_f32_u32 v90, v4
    v_lshrrev_b32 v5, 3, v2
    v_and_b32 v6, 7, v2
    v_lshl_add_u32 v7, v5, 7, v6
    v_cvt_f32_u32 v91, v7
    v_lshrrev_b32 v7, 2, v6
    v_and_b32 v8, 3, v6
    v_lshlrev_b32 v8, 1, v8
    v_lshl_add_u32 v7, v7, 7, v8
    v_add_u32 v7, 256, v7
    v_lshrrev_b32 v8, 1, v6
    v_and_b32 v9, 1, v6
    v_lshlrev_b32 v9, 2, v9
    v_lshl_add_u32 v8, v8, 7, v9
    v_add_u32 v8, 512, v8
    v_cmp_eq_u32 vcc, 1, v5
    s_nop 1
    v_cndmask_b32 v7, v7, v8, vcc
    v_cvt_f32_u32 v92, v7
    v_lshlrev_b32 v7, 7, v2
    v_add_u32 v7, 1024, v7
    v_cvt_f32_u32 v93, v7
    s_add_u32 s32, s49, 18688
    v_lshrrev_b32 v5, 1, v3
    v_and_b32 v6, 1, v3
    v_lshl_add_u32 v7, v5, 7, v4
    v_lshl_add_u32 v7, v6, 2, v7
    v_lshl_add_u32 v84, v7, 2, s32
    v_cmp_eq_u32 vcc, 1, v5
    v_lshlrev_b32 v7, 6, v6
    v_lshl_add_u32 v8, v2, 2, v7
    v_add_u32 v8, 256, v8
    v_lshl_add_u32 v9, v2, 1, v7
    v_add_u32 v9, 384, v9
    v_cndmask_b32 v8, v8, v9, vcc
    v_lshl_add_u32 v85, v8, 2, s32
    v_lshl_add_u32 v8, v2, 2, v7
    v_add_u32 v8, 257, v8
    v_lshl_add_u32 v9, v2, 1, v7
    v_add_u32 v9, 385, v9
    v_cndmask_b32 v8, v8, v9, vcc
    v_lshl_add_u32 v86, v8, 2, s32
    v_lshl_add_u32 v8, v2, 2, v7
    v_add_u32 v8, 258, v8
    v_lshl_add_u32 v9, v2, 1, v7
    v_add_u32 v9, 416, v9
    v_cndmask_b32 v8, v8, v9, vcc
    v_lshl_add_u32 v87, v8, 2, s32
    v_lshl_add_u32 v8, v2, 2, v7
    v_add_u32 v8, 259, v8
    v_lshl_add_u32 v9, v2, 1, v7
    v_add_u32 v9, 417, v9
    v_cndmask_b32 v8, v8, v9, vcc
    v_lshl_add_u32 v88, v8, 2, s32
    v_lshl_add_u32 v8, v3, 6, v2
    v_add_u32 v8, 512, v8
    v_lshl_add_u32 v89, v8, 2, s32
    s_add_u32 s33, s49, 16640
    v_lshl_add_u32 v94, v3, 4, s33
    v_lshlrev_b32 v4, 5, v1
    v_sub_u32 v4, 2047, v4
    v_mov_b32 v10, 768
    v_cvt_f32_i32 v5, v4
    v_cvt_pk_bf16_f32 v5, v5, v5
    v_and_b32 v5, 0xffff, v5
    v_add_u32 v5, 4294950272, v5
    v_cmp_gt_i32 vcc, 0x100, v4
    s_nop 1
    v_cndmask_b32 v5, v5, v4, vcc
    v_lshl_add_u32 v48, v5, 2, s32
    v_add_u32 v4, -1, v4
    v_cvt_f32_i32 v5, v4
    v_cvt_pk_bf16_f32 v5, v5, v5
    v_and_b32 v5, 0xffff, v5
    v_add_u32 v5, 4294950272, v5
    v_cmp_gt_i32 vcc, 0x100, v4
    s_nop 1
    v_cndmask_b32 v5, v5, v4, vcc
    v_lshl_add_u32 v49, v5, 2, s32
    v_add_u32 v4, -1, v4
    v_cvt_f32_i32 v5, v4
    v_cvt_pk_bf16_f32 v5, v5, v5
    v_and_b32 v5, 0xffff, v5
    v_add_u32 v5, 4294950272, v5
    v_cmp_gt_i32 vcc, 0x100, v4
    s_nop 1
    v_cndmask_b32 v5, v5, v4, vcc
    v_lshl_add_u32 v50, v5, 2, s32
    v_add_u32 v4, -1, v4
    v_cvt_f32_i32 v5, v4
    v_cvt_pk_bf16_f32 v5, v5, v5
    v_and_b32 v5, 0xffff, v5
    v_add_u32 v5, 4294950272, v5
    v_cmp_gt_i32 vcc, 0x100, v4
    s_nop 1
    v_cndmask_b32 v5, v5, v4, vcc
    v_lshl_add_u32 v51, v5, 2, s32
    v_add_u32 v4, -1, v4
    v_cvt_f32_i32 v5, v4
    v_cvt_pk_bf16_f32 v5, v5, v5
    v_and_b32 v5, 0xffff, v5
    v_add_u32 v5, 4294950272, v5
    v_cmp_gt_i32 vcc, 0x100, v4
    s_nop 1
    v_cndmask_b32 v5, v5, v4, vcc
    v_lshl_add_u32 v52, v5, 2, s32
    v_add_u32 v4, -1, v4
    v_cvt_f32_i32 v5, v4
    v_cvt_pk_bf16_f32 v5, v5, v5
    v_and_b32 v5, 0xffff, v5
    v_add_u32 v5, 4294950272, v5
    v_cmp_gt_i32 vcc, 0x100, v4
    s_nop 1
    v_cndmask_b32 v5, v5, v4, vcc
    v_lshl_add_u32 v53, v5, 2, s32
    v_add_u32 v4, -1, v4
    v_cvt_f32_i32 v5, v4
    v_cvt_pk_bf16_f32 v5, v5, v5
    v_and_b32 v5, 0xffff, v5
    v_add_u32 v5, 4294950272, v5
    v_cmp_gt_i32 vcc, 0x100, v4
    s_nop 1
    v_cndmask_b32 v5, v5, v4, vcc
    v_lshl_add_u32 v54, v5, 2, s32
    v_add_u32 v4, -1, v4
    v_cvt_f32_i32 v5, v4
    v_cvt_pk_bf16_f32 v5, v5, v5
    v_and_b32 v5, 0xffff, v5
    v_add_u32 v5, 4294950272, v5
    v_cmp_gt_i32 vcc, 0x100, v4
    s_nop 1
    v_cndmask_b32 v5, v5, v4, vcc
    v_lshl_add_u32 v55, v5, 2, s32
    v_add_u32 v4, -1, v4
    v_cvt_f32_i32 v5, v4
    v_cvt_pk_bf16_f32 v5, v5, v5
    v_and_b32 v5, 0xffff, v5
    v_add_u32 v5, 4294950272, v5
    v_cmp_gt_i32 vcc, 0x100, v4
    s_nop 1
    v_cndmask_b32 v5, v5, v4, vcc
    v_lshl_add_u32 v56, v5, 2, s32
    v_add_u32 v4, -1, v4
    v_cvt_f32_i32 v5, v4
    v_cvt_pk_bf16_f32 v5, v5, v5
    v_and_b32 v5, 0xffff, v5
    v_add_u32 v5, 4294950272, v5
    v_cmp_gt_i32 vcc, 0x100, v4
    s_nop 1
    v_cndmask_b32 v5, v5, v4, vcc
    v_lshl_add_u32 v57, v5, 2, s32
    v_add_u32 v4, -1, v4
    v_cvt_f32_i32 v5, v4
    v_cvt_pk_bf16_f32 v5, v5, v5
    v_and_b32 v5, 0xffff, v5
    v_add_u32 v5, 4294950272, v5
    v_cmp_gt_i32 vcc, 0x100, v4
    s_nop 1
    v_cndmask_b32 v5, v5, v4, vcc
    v_lshl_add_u32 v58, v5, 2, s32
    v_add_u32 v4, -1, v4
    v_cvt_f32_i32 v5, v4
    v_cvt_pk_bf16_f32 v5, v5, v5
    v_and_b32 v5, 0xffff, v5
    v_add_u32 v5, 4294950272, v5
    v_cmp_gt_i32 vcc, 0x100, v4
    s_nop 1
    v_cndmask_b32 v5, v5, v4, vcc
    v_lshl_add_u32 v59, v5, 2, s32
    v_add_u32 v4, -1, v4
    v_cvt_f32_i32 v5, v4
    v_cvt_pk_bf16_f32 v5, v5, v5
    v_and_b32 v5, 0xffff, v5
    v_add_u32 v5, 4294950272, v5
    v_cmp_gt_i32 vcc, 0x100, v4
    s_nop 1
    v_cndmask_b32 v5, v5, v4, vcc
    v_lshl_add_u32 v60, v5, 2, s32
    v_add_u32 v4, -1, v4
    v_cvt_f32_i32 v5, v4
    v_cvt_pk_bf16_f32 v5, v5, v5
    v_and_b32 v5, 0xffff, v5
    v_add_u32 v5, 4294950272, v5
    v_cmp_gt_i32 vcc, 0x100, v4
    s_nop 1
    v_cndmask_b32 v5, v5, v4, vcc
    v_lshl_add_u32 v61, v5, 2, s32
    v_add_u32 v4, -1, v4
    v_cvt_f32_i32 v5, v4
    v_cvt_pk_bf16_f32 v5, v5, v5
    v_and_b32 v5, 0xffff, v5
    v_add_u32 v5, 4294950272, v5
    v_cmp_gt_i32 vcc, 0x100, v4
    s_nop 1
    v_cndmask_b32 v5, v5, v4, vcc
    v_lshl_add_u32 v62, v5, 2, s32
    v_add_u32 v4, -1, v4
    v_cvt_f32_i32 v5, v4
    v_cvt_pk_bf16_f32 v5, v5, v5
    v_and_b32 v5, 0xffff, v5
    v_add_u32 v5, 4294950272, v5
    v_cmp_gt_i32 vcc, 0x100, v4
    s_nop 1
    v_cndmask_b32 v5, v5, v4, vcc
    v_lshl_add_u32 v63, v5, 2, s32
    v_add_u32 v4, -1, v4
    v_cvt_f32_i32 v5, v4
    v_cvt_pk_bf16_f32 v5, v5, v5
    v_and_b32 v5, 0xffff, v5
    v_add_u32 v5, 4294950272, v5
    v_cmp_gt_i32 vcc, 0x100, v4
    s_nop 1
    v_cndmask_b32 v5, v5, v4, vcc
    v_lshl_add_u32 v64, v5, 2, s32
    v_add_u32 v4, -1, v4
    v_cvt_f32_i32 v5, v4
    v_cvt_pk_bf16_f32 v5, v5, v5
    v_and_b32 v5, 0xffff, v5
    v_add_u32 v5, 4294950272, v5
    v_cmp_gt_i32 vcc, 0x100, v4
    s_nop 1
    v_cndmask_b32 v5, v5, v4, vcc
    v_lshl_add_u32 v65, v5, 2, s32
    v_add_u32 v4, -1, v4
    v_cvt_f32_i32 v5, v4
    v_cvt_pk_bf16_f32 v5, v5, v5
    v_and_b32 v5, 0xffff, v5
    v_add_u32 v5, 4294950272, v5
    v_cmp_gt_i32 vcc, 0x100, v4
    s_nop 1
    v_cndmask_b32 v5, v5, v4, vcc
    v_lshl_add_u32 v66, v5, 2, s32
    v_add_u32 v4, -1, v4
    v_cvt_f32_i32 v5, v4
    v_cvt_pk_bf16_f32 v5, v5, v5
    v_and_b32 v5, 0xffff, v5
    v_add_u32 v5, 4294950272, v5
    v_cmp_gt_i32 vcc, 0x100, v4
    s_nop 1
    v_cndmask_b32 v5, v5, v4, vcc
    v_lshl_add_u32 v67, v5, 2, s32
    v_add_u32 v4, -1, v4
    v_cvt_f32_i32 v5, v4
    v_cvt_pk_bf16_f32 v5, v5, v5
    v_and_b32 v5, 0xffff, v5
    v_add_u32 v5, 4294950272, v5
    v_cmp_gt_i32 vcc, 0x100, v4
    s_nop 1
    v_cndmask_b32 v5, v5, v4, vcc
    v_lshl_add_u32 v68, v5, 2, s32
    v_add_u32 v4, -1, v4
    v_cvt_f32_i32 v5, v4
    v_cvt_pk_bf16_f32 v5, v5, v5
    v_and_b32 v5, 0xffff, v5
    v_add_u32 v5, 4294950272, v5
    v_cmp_gt_i32 vcc, 0x100, v4
    s_nop 1
    v_cndmask_b32 v5, v5, v4, vcc
    v_lshl_add_u32 v69, v5, 2, s32
    v_add_u32 v4, -1, v4
    v_cvt_f32_i32 v5, v4
    v_cvt_pk_bf16_f32 v5, v5, v5
    v_and_b32 v5, 0xffff, v5
    v_add_u32 v5, 4294950272, v5
    v_cmp_gt_i32 vcc, 0x100, v4
    s_nop 1
    v_cndmask_b32 v5, v5, v4, vcc
    v_lshl_add_u32 v70, v5, 2, s32
    v_add_u32 v4, -1, v4
    v_cvt_f32_i32 v5, v4
    v_cvt_pk_bf16_f32 v5, v5, v5
    v_and_b32 v5, 0xffff, v5
    v_add_u32 v5, 4294950272, v5
    v_cmp_gt_i32 vcc, 0x100, v4
    s_nop 1
    v_cndmask_b32 v5, v5, v4, vcc
    v_lshl_add_u32 v71, v5, 2, s32
    v_add_u32 v4, -1, v4
    v_cvt_f32_i32 v5, v4
    v_cvt_pk_bf16_f32 v5, v5, v5
    v_and_b32 v5, 0xffff, v5
    v_add_u32 v5, 4294950272, v5
    v_cmp_gt_i32 vcc, 0x100, v4
    s_nop 1
    v_cndmask_b32 v5, v5, v4, vcc
    v_lshl_add_u32 v72, v5, 2, s32
    v_add_u32 v4, -1, v4
    v_cvt_f32_i32 v5, v4
    v_cvt_pk_bf16_f32 v5, v5, v5
    v_and_b32 v5, 0xffff, v5
    v_add_u32 v5, 4294950272, v5
    v_cmp_gt_i32 vcc, 0x100, v4
    s_nop 1
    v_cndmask_b32 v5, v5, v4, vcc
    v_lshl_add_u32 v73, v5, 2, s32
    v_add_u32 v4, -1, v4
    v_cvt_f32_i32 v5, v4
    v_cvt_pk_bf16_f32 v5, v5, v5
    v_and_b32 v5, 0xffff, v5
    v_add_u32 v5, 4294950272, v5
    v_cmp_gt_i32 vcc, 0x100, v4
    s_nop 1
    v_cndmask_b32 v5, v5, v4, vcc
    v_lshl_add_u32 v74, v5, 2, s32
    v_add_u32 v4, -1, v4
    v_cvt_f32_i32 v5, v4
    v_cvt_pk_bf16_f32 v5, v5, v5
    v_and_b32 v5, 0xffff, v5
    v_add_u32 v5, 4294950272, v5
    v_cmp_gt_i32 vcc, 0x100, v4
    s_nop 1
    v_cndmask_b32 v5, v5, v4, vcc
    v_lshl_add_u32 v75, v5, 2, s32
    v_add_u32 v4, -1, v4
    v_cvt_f32_i32 v5, v4
    v_cvt_pk_bf16_f32 v5, v5, v5
    v_and_b32 v5, 0xffff, v5
    v_add_u32 v5, 4294950272, v5
    v_cmp_gt_i32 vcc, 0x100, v4
    s_nop 1
    v_cndmask_b32 v5, v5, v4, vcc
    v_lshl_add_u32 v76, v5, 2, s32
    v_add_u32 v4, -1, v4
    v_cvt_f32_i32 v5, v4
    v_cvt_pk_bf16_f32 v5, v5, v5
    v_and_b32 v5, 0xffff, v5
    v_add_u32 v5, 4294950272, v5
    v_cmp_gt_i32 vcc, 0x100, v4
    s_nop 1
    v_cndmask_b32 v5, v5, v4, vcc
    v_lshl_add_u32 v77, v5, 2, s32
    v_add_u32 v4, -1, v4
    v_cvt_f32_i32 v5, v4
    v_cvt_pk_bf16_f32 v5, v5, v5
    v_and_b32 v5, 0xffff, v5
    v_add_u32 v5, 4294950272, v5
    v_cmp_gt_i32 vcc, 0x100, v4
    s_nop 1
    v_cndmask_b32 v5, v5, v4, vcc
    v_lshl_add_u32 v78, v5, 2, s32
    v_add_u32 v4, -1, v4
    v_cvt_f32_i32 v5, v4
    v_cvt_pk_bf16_f32 v5, v5, v5
    v_and_b32 v5, 0xffff, v5
    v_add_u32 v5, 4294950272, v5
    v_cmp_gt_i32 vcc, 0x100, v4
    s_nop 1
    v_cndmask_b32 v5, v5, v4, vcc
    v_lshl_add_u32 v79, v5, 2, s32
    v_add_u32 v4, -1, v4
    v_cvt_f32_i32 v5, v4
    v_cvt_pk_bf16_f32 v5, v5, v5
    v_and_b32 v5, 0xffff, v5
    v_add_u32 v5, 4294950272, v5
    v_cmp_gt_i32 vcc, 0x100, v4
    s_nop 1
    v_cndmask_b32 v5, v5, v4, vcc
    v_cmp_gt_i32 vcc, 0, v4
    s_nop 1
    v_cndmask_b32 v5, v5, v10, vcc
    v_lshl_add_u32 v80, v5, 2, s32
    v_add_u32 v4, -1, v4
    v_cvt_f32_i32 v5, v4
    v_cvt_pk_bf16_f32 v5, v5, v5
    v_and_b32 v5, 0xffff, v5
    v_add_u32 v5, 4294950272, v5
    v_cmp_gt_i32 vcc, 0x100, v4
    s_nop 1
    v_cndmask_b32 v5, v5, v4, vcc
    v_cmp_gt_i32 vcc, 0, v4
    s_nop 1
    v_cndmask_b32 v5, v5, v10, vcc
    v_lshl_add_u32 v81, v5, 2, s32
    v_add_u32 v4, -1, v4
    v_cvt_f32_i32 v5, v4
    v_cvt_pk_bf16_f32 v5, v5, v5
    v_and_b32 v5, 0xffff, v5
    v_add_u32 v5, 4294950272, v5
    v_cmp_gt_i32 vcc, 0x100, v4
    s_nop 1
    v_cndmask_b32 v5, v5, v4, vcc
    v_cmp_gt_i32 vcc, 0, v4
    s_nop 1
    v_cndmask_b32 v5, v5, v10, vcc
    v_lshl_add_u32 v82, v5, 2, s32
    v_add_u32 v4, -1, v4
    v_and_b32 v2, 31, v1
    v_lshrrev_b32 v3, 5, v1
    v_lshlrev_b32 v4, 3, v3
    v_sub_u32 v4, v4, v2
    v_add_u32 v4, 31, v4
    v_and_b32 v5, 3, v4
    v_and_b32 v4, -4, v4
    v_mul_u32_u24 v5, 4160, v5
    v_lshl_add_u32 v5, v4, 1, v5
    v_add_u32 v95, s49, v5
    v_lshl_add_u32 v100, v1, 6, s49
    v_lshrrev_b32 v4, 2, v0
    v_mul_u32_u24 v4, 80, v4
    v_and_b32 v5, 3, v0
    v_lshl_add_u32 v101, v5, 4, v4
    v_add_u32 v101, 80, v101
    v_mov_b32 v6, 0
    v_lshrrev_b32 v4, 5, v0
    v_mul_u32_u24 v4, 5200, v4
    v_and_b32 v5, 15, v0
    v_lshl_add_u32 v4, v5, 2, v4
    ds_write_b32 v4, v6
    v_lshrrev_b32 v4, 4, v1
    v_mul_u32_u24 v4, 4160, v4
    v_lshl_add_u32 v4, v5, 2, v4
    v_add_u32 v4, s49, v4
    ds_write_b32 v4, v6 offset:4096
    v_mov_b32 v4, s32
    ds_write_b32 v4, v6 offset:3072
    s_mov_b32 s32, 0x05040100
    s_mov_b32 s33, 0x07060302
    s_waitcnt vmcnt(0)
    v_perm_b32 v176, v20, v16, s32
    v_perm_b32 v177, v28, v24, s32
    v_perm_b32 v178, v36, v32, s32
    v_perm_b32 v179, v44, v40, s32
    ds_write_b128 v101, v[176:179] offset:0
    v_perm_b32 v180, v20, v16, s33
    v_perm_b32 v181, v28, v24, s33
    v_perm_b32 v182, v36, v32, s33
    v_perm_b32 v183, v44, v40, s33
    ds_write_b128 v101, v[180:183] offset:5200
    v_perm_b32 v184, v21, v17, s32
    v_perm_b32 v185, v29, v25, s32
    v_perm_b32 v186, v37, v33, s32
    v_perm_b32 v187, v45, v41, s32
    ds_write_b128 v101, v[184:187] offset:10400
    v_perm_b32 v188, v21, v17, s33
    v_perm_b32 v189, v29, v25, s33
    v_perm_b32 v190, v37, v33, s33
    v_perm_b32 v191, v45, v41, s33
    ds_write_b128 v101, v[188:191] offset:15600
    v_perm_b32 v176, v22, v18, s32
    v_perm_b32 v177, v30, v26, s32
    v_perm_b32 v178, v38, v34, s32
    v_perm_b32 v179, v46, v42, s32
    ds_write_b128 v101, v[176:179] offset:20800
    v_perm_b32 v180, v22, v18, s33
    v_perm_b32 v181, v30, v26, s33
    v_perm_b32 v182, v38, v34, s33
    v_perm_b32 v183, v46, v42, s33
    ds_write_b128 v101, v[180:183] offset:26000
    v_perm_b32 v184, v23, v19, s32
    v_perm_b32 v185, v31, v27, s32
    v_perm_b32 v186, v39, v35, s32
    v_perm_b32 v187, v47, v43, s32
    ds_write_b128 v101, v[184:187] offset:31200
    v_perm_b32 v188, v23, v19, s33
    v_perm_b32 v189, v31, v27, s33
    v_perm_b32 v190, v39, v35, s33
    v_perm_b32 v191, v47, v43, s33
    ds_write_b128 v101, v[188:191] offset:36400
    s_waitcnt lgkmcnt(0)
    s_barrier
    s_mov_b32 s50, 0
L_s4_round:
    s_lshl_b32 s52, s50, 2
    s_add_u32 s52, s52, s5
    s_lshl_b32 s32, s48, 3
    s_add_u32 s32, s32, s52
    s_lshl_b32 s33, s32, 8
    v_lshl_add_u32 v2, v1, 2, s33
    s_lshl_b32 s33, s32, 1
    v_mov_b32 v3, s33
    global_load_dword v140, v2, s[56:57]
    global_load_dword v141, v2, s[58:59]
    global_load_dword v142, v2, s[60:61]
    global_load_dword v143, v2, s[62:63]
    global_load_dword v144, v2, s[64:65]
    global_load_dword v145, v2, s[66:67]
    global_load_ushort v146, v3, s[68:69]
    s_mul_i32 s34, s52, 5200
    v_and_b32 v4, 31, v1
    v_lshrrev_b32 v5, 5, v1
    v_lshl_add_u32 v98, v5, 4, s34
    v_mul_u32_u24 v4, 80, v4
    v_add_u32 v96, v4, v98
    v_add_u32 v96, 80, v96
    v_add_u32 v97, 80, v96
    v_lshl_add_u32 v99, v5, 3, v4
    v_add_u32 v99, s34, v99
    s_mov_b32 s35, 1069066811
    s_waitcnt vmcnt(0)
    v_lshlrev_b32 v2, 16, v146
    v_mul_f32 v3, s35, v2
    v_fma_f32 v4, v2, s35, -v3
    v_fmac_f32 v4, 849703008, v2
    v_exp_f32 v3, v3
    v_mul_f32 v4, 1060205080, v4
    v_fma_f32 v3, v3, v4, v3
    v_cvt_pk_bf16_f32 v3, v3, v3
    v_lshlrev_b32 v3, 16, v3
    s_add_u32 s34, s49, 16640
    v_lshl_add_u32 v2, v1, 5, s34
    v_lshlrev_b32 v148, 16, v140
    v_lshlrev_b32 v149, 16, v141
    v_lshlrev_b32 v150, 16, v142
    v_lshlrev_b32 v151, 16, v143
    v_lshlrev_b32 v152, 16, v144
    v_lshlrev_b32 v153, 16, v145
    v_mul_f32 v176, v3, v148
    v_mul_f32 v176, s35, v176
    v_max_f32 v176, 4048155338, v176
    v_mul_f32 v177, v3, v149
    v_mul_f32 v177, 0.15915494, v177
    v_mul_f32 v150, v3, v150
    v_mul_f32 v151, v3, v151
    v_mul_f32 v178, v152, v150
    v_fma_f32 v178, -v153, v151, v178
    v_mul_f32 v179, v152, v151
    v_fma_f32 v179, v153, v150, v179
    ds_write_b128 v2, v[176:179] offset:0
    v_and_b32 v148, 0xffff0000, v140
    v_and_b32 v149, 0xffff0000, v141
    v_and_b32 v150, 0xffff0000, v142
    v_and_b32 v151, 0xffff0000, v143
    v_and_b32 v152, 0xffff0000, v144
    v_and_b32 v153, 0xffff0000, v145
    v_mul_f32 v180, v3, v148
    v_mul_f32 v180, s35, v180
    v_max_f32 v180, 4048155338, v180
    v_mul_f32 v181, v3, v149
    v_mul_f32 v181, 0.15915494, v181
    v_mul_f32 v150, v3, v150
    v_mul_f32 v151, v3, v151
    v_mul_f32 v182, v152, v150
    v_fma_f32 v182, -v153, v151, v182
    v_mul_f32 v183, v152, v151
    v_fma_f32 v183, v153, v150, v183
    ds_write_b128 v2, v[180:183] offset:16
    v_mov_b64 v[104:105], 0
    v_mov_b64 v[106:107], 0
    v_mov_b64 v[108:109], 0
    v_mov_b64 v[110:111], 0
    v_mov_b64 v[112:113], 0
    v_mov_b64 v[114:115], 0
    v_mov_b32 v2, v94
    s_mov_b32 s51, 0
    s_waitcnt lgkmcnt(0)
    ds_read_b128 v[116:119], v2
L_s4_kgen:
    s_waitcnt lgkmcnt(0)
    ds_read_b128 v[120:123], v2 offset:64
    v_mul_f32 v132, v116, v90
    v_mul_f32 v133, v116, v91
    v_mul_f32 v134, v116, v92
    v_mul_f32 v135, v116, v93
    v_mul_f32 v124, v117, v90
    v_mul_f32 v126, v117, v91
    v_mul_f32 v128, v117, v92
    v_mul_f32 v130, v117, v93
    v_exp_f32 v132, v132
    v_exp_f32 v133, v133
    v_exp_f32 v134, v134
    v_exp_f32 v135, v135
    v_fract_f32 v124, v124
    v_fract_f32 v126, v126
    v_fract_f32 v128, v128
    v_fract_f32 v130, v130
    v_sin_f32 v125, v124
    v_sin_f32 v127, v126
    v_sin_f32 v129, v128
    v_sin_f32 v131, v130
    v_cos_f32 v124, v124
    v_cos_f32 v126, v126
    v_cos_f32 v128, v128
    v_cos_f32 v130, v130
    v_mul_f32 v125, v125, v132
    v_mul_f32 v127, v127, v133
    v_mul_f32 v129, v129, v134
    v_mul_f32 v131, v131, v135
    v_mul_f32 v124, v124, v132
    v_mul_f32 v126, v126, v133
    v_mul_f32 v128, v128, v134
    v_mul_f32 v130, v130, v135
    v_mul_f32 v132, v118, v124
    v_mul_f32 v133, v118, v125
    v_fma_f32 v132, -v119, v125, v132
    v_fma_f32 v133, -v119, v124, -v133
    s_nop 0
    v_mfma_f32_16x16x4_f32 v[104:107], v126, v132, v[104:107]
    v_mfma_f32_16x16x4_f32 v[108:111], v128, v132, v[108:111]
    v_mfma_f32_16x16x4_f32 v[112:115], v130, v132, v[112:115]
    v_mfma_f32_16x16x4_f32 v[104:107], v127, v133, v[104:107]
    v_mfma_f32_16x16x4_f32 v[108:111], v129, v133, v[108:111]
    v_mfma_f32_16x16x4_f32 v[112:115], v131, v133, v[112:115]
    s_waitcnt lgkmcnt(0)
    ds_read_b128 v[116:119], v2 offset:128
    v_mul_f32 v132, v120, v90
    v_mul_f32 v133, v120, v91
    v_mul_f32 v134, v120, v92
    v_mul_f32 v135, v120, v93
    v_mul_f32 v124, v121, v90
    v_mul_f32 v126, v121, v91
    v_mul_f32 v128, v121, v92
    v_mul_f32 v130, v121, v93
    v_exp_f32 v132, v132
    v_exp_f32 v133, v133
    v_exp_f32 v134, v134
    v_exp_f32 v135, v135
    v_fract_f32 v124, v124
    v_fract_f32 v126, v126
    v_fract_f32 v128, v128
    v_fract_f32 v130, v130
    v_sin_f32 v125, v124
    v_sin_f32 v127, v126
    v_sin_f32 v129, v128
    v_sin_f32 v131, v130
    v_cos_f32 v124, v124
    v_cos_f32 v126, v126
    v_cos_f32 v128, v128
    v_cos_f32 v130, v130
    v_mul_f32 v125, v125, v132
    v_mul_f32 v127, v127, v133
    v_mul_f32 v129, v129, v134
    v_mul_f32 v131, v131, v135
    v_mul_f32 v124, v124, v132
    v_mul_f32 v126, v126, v133
    v_mul_f32 v128, v128, v134
    v_mul_f32 v130, v130, v135
    v_mul_f32 v132, v122, v124
    v_mul_f32 v133, v122, v125
    v_fma_f32 v132, -v123, v125, v132
    v_fma_f32 v133, -v123, v124, -v133
    s_nop 0
    v_mfma_f32_16x16x4_f32 v[104:107], v126, v132, v[104:107]
    v_mfma_f32_16x16x4_f32 v[108:111], v128, v132, v[108:111]
    v_mfma_f32_16x16x4_f32 v[112:115], v130, v132, v[112:115]
    v_mfma_f32_16x16x4_f32 v[104:107], v127, v133, v[104:107]
    v_mfma_f32_16x16x4_f32 v[108:111], v129, v133, v[108:111]
    v_mfma_f32_16x16x4_f32 v[112:115], v131, v133, v[112:115]
    v_add_u32 v2, 128, v2
    s_add_u32 s51, s51, 1
    s_cmp_lt_u32 s51, 16
    s_cbranch_scc1 L_s4_kgen
    s_waitcnt lgkmcnt(0)
    ds_write_b128 v84, v[104:107]
    ds_write_b32 v85, v108
    ds_write_b32 v86, v109
    ds_write_b32 v87, v110
    ds_write_b32 v88, v111
    ds_write_b32 v89, v112 offset:0
    ds_write_b32 v89, v113 offset:64
    ds_write_b32 v89, v114 offset:128
    ds_write_b32 v89, v115 offset:192
    s_waitcnt lgkmcnt(0)
    ds_read_b32 v140, v48
    ds_read_b32 v141, v49
    ds_read_b32 v142, v50
    ds_read_b32 v143, v51
    ds_read_b32 v144, v52
    ds_read_b32 v145, v53
    ds_read_b32 v146, v54
    ds_read_b32 v147, v55
    ds_read_b32 v148, v56
    ds_read_b32 v149, v57
    ds_read_b32 v150, v58
    ds_read_b32 v151, v59
    s_waitcnt lgkmcnt(0)
    ds_read_b32 v152, v60
    ds_read_b32 v153, v61
    ds_read_b32 v154, v62
    ds_read_b32 v155, v63
    ds_read_b32 v156, v64
    ds_read_b32 v157, v65
    ds_read_b32 v158, v66
    ds_read_b32 v159, v67
    ds_read_b32 v160, v68
    ds_read_b32 v161, v69
    ds_read_b32 v162, v70
    ds_read_b32 v163, v71
    s_waitcnt lgkmcnt(0)
    ds_read_b32 v164, v72
    ds_read_b32 v165, v73
    ds_read_b32 v166, v74
    ds_read_b32 v167, v75
    ds_read_b32 v168, v76
    ds_read_b32 v169, v77
    ds_read_b32 v170, v78
    ds_read_b32 v171, v79
    ds_read_b32 v172, v80
    ds_read_b32 v173, v81
    ds_read_b32 v174, v82
    s_waitcnt lgkmcnt(0)
    v_cvt_pk_bf16_f32 v176, v140, v141
    v_cvt_pk_bf16_f32 v177, v142, v143
    v_cvt_pk_bf16_f32 v178, v144, v145
    v_cvt_pk_bf16_f32 v179, v146, v147
    v_cvt_pk_bf16_f32 v180, v148, v149
    v_cvt_pk_bf16_f32 v181, v150, v151
    v_cvt_pk_bf16_f32 v182, v152, v153
    v_cvt_pk_bf16_f32 v183, v154, v155
    v_cvt_pk_bf16_f32 v184, v156, v157
    v_cvt_pk_bf16_f32 v185, v158, v159
    v_cvt_pk_bf16_f32 v186, v160, v161
    v_cvt_pk_bf16_f32 v187, v162, v163
    v_cvt_pk_bf16_f32 v188, v164, v165
    v_cvt_pk_bf16_f32 v189, v166, v167
    v_cvt_pk_bf16_f32 v190, v168, v169
    v_cvt_pk_bf16_f32 v191, v170, v171
    ds_write_b128 v100, v[176:179] offset:0
    ds_write_b128 v100, v[180:183] offset:16
    ds_write_b128 v100, v[184:187] offset:32
    ds_write_b128 v100, v[188:191] offset:48
    s_waitcnt lgkmcnt(0)
    v_cvt_pk_bf16_f32 v176, v141, v142
    v_cvt_pk_bf16_f32 v177, v143, v144
    v_cvt_pk_bf16_f32 v178, v145, v146
    v_cvt_pk_bf16_f32 v179, v147, v148
    v_cvt_pk_bf16_f32 v180, v149, v150
    v_cvt_pk_bf16_f32 v181, v151, v152
    v_cvt_pk_bf16_f32 v182, v153, v154
    v_cvt_pk_bf16_f32 v183, v155, v156
    v_cvt_pk_bf16_f32 v184, v157, v158
    v_cvt_pk_bf16_f32 v185, v159, v160
    v_cvt_pk_bf16_f32 v186, v161, v162
    v_cvt_pk_bf16_f32 v187, v163, v164
    v_cvt_pk_bf16_f32 v188, v165, v166
    v_cvt_pk_bf16_f32 v189, v167, v168
    v_cvt_pk_bf16_f32 v190, v169, v170
    v_cvt_pk_bf16_f32 v191, v171, v172
    ds_write_b128 v100, v[176:179] offset:4160
    ds_write_b128 v100, v[180:183] offset:4176
    ds_write_b128 v100, v[184:187] offset:4192
    ds_write_b128 v100, v[188:191] offset:4208
    s_waitcnt lgkmcnt(0)
    v_cvt_pk_bf16_f32 v176, v142, v143
    v_cvt_pk_bf16_f32 v177, v144, v145
    v_cvt_pk_bf16_f32 v178, v146, v147
    v_cvt_pk_bf16_f32 v179, v148, v149
    v_cvt_pk_bf16_f32 v180, v150, v151
    v_cvt_pk_bf16_f32 v181, v152, v153
    v_cvt_pk_bf16_f32 v182, v154, v155
    v_cvt_pk_bf16_f32 v183, v156, v157
    v_cvt_pk_bf16_f32 v184, v158, v159
    v_cvt_pk_bf16_f32 v185, v160, v161
    v_cvt_pk_bf16_f32 v186, v162, v163
    v_cvt_pk_bf16_f32 v187, v164, v165
    v_cvt_pk_bf16_f32 v188, v166, v167
    v_cvt_pk_bf16_f32 v189, v168, v169
    v_cvt_pk_bf16_f32 v190, v170, v171
    v_cvt_pk_bf16_f32 v191, v172, v173
    ds_write_b128 v100, v[176:179] offset:8320
    ds_write_b128 v100, v[180:183] offset:8336
    ds_write_b128 v100, v[184:187] offset:8352
    ds_write_b128 v100, v[188:191] offset:8368
    s_waitcnt lgkmcnt(0)
    v_cvt_pk_bf16_f32 v176, v143, v144
    v_cvt_pk_bf16_f32 v177, v145, v146
    v_cvt_pk_bf16_f32 v178, v147, v148
    v_cvt_pk_bf16_f32 v179, v149, v150
    v_cvt_pk_bf16_f32 v180, v151, v152
    v_cvt_pk_bf16_f32 v181, v153, v154
    v_cvt_pk_bf16_f32 v182, v155, v156
    v_cvt_pk_bf16_f32 v183, v157, v158
    v_cvt_pk_bf16_f32 v184, v159, v160
    v_cvt_pk_bf16_f32 v185, v161, v162
    v_cvt_pk_bf16_f32 v186, v163, v164
    v_cvt_pk_bf16_f32 v187, v165, v166
    v_cvt_pk_bf16_f32 v188, v167, v168
    v_cvt_pk_bf16_f32 v189, v169, v170
    v_cvt_pk_bf16_f32 v190, v171, v172
    v_cvt_pk_bf16_f32 v191, v173, v174
    ds_write_b128 v100, v[176:179] offset:12480
    ds_write_b128 v100, v[180:183] offset:12496
    ds_write_b128 v100, v[184:187] offset:12512
    ds_write_b128 v100, v[188:191] offset:12528
    s_waitcnt lgkmcnt(0)
    v_add_u32 v2, 0, v96
    v_max_i32 v2, v2, v98
    ds_read_b64 v[104:105], v95 offset:4032
    ds_read_b64 v[106:107], v95 offset:4040
    ds_read_b128 v[112:115], v2 offset:0
    ds_read_b128 v[116:119], v97 offset:2480
    ds_read_b64 v[108:109], v95 offset:1984
    ds_read_b64 v[110:111], v95 offset:1992
    ds_read_b64 v[120:121], v95 offset:4064
    ds_read_b64 v[122:123], v95 offset:4072
    ds_read_b128 v[128:131], v2 offset:32
    ds_read_b128 v[132:135], v97 offset:2512
    ds_read_b64 v[124:125], v95 offset:2016
    ds_read_b64 v[126:127], v95 offset:2024
    s_waitcnt lgkmcnt(6)
    v_mfma_f32_32x32x16_bf16 v[192:207], v[104:107], v[112:115], 0
    v_add_u32 v3, 4294967216, v96
    v_max_i32 v3, v3, v98
    ds_read_b64 v[136:137], v95 offset:3968
    ds_read_b64 v[138:139], v95 offset:3976
    ds_read_b128 v[144:147], v3 offset:0
    ds_read_b128 v[148:151], v97 offset:2400
    ds_read_b64 v[140:141], v95 offset:1920
    ds_read_b64 v[142:143], v95 offset:1928
    v_mfma_f32_32x32x16_bf16 v[208:223], v[104:107], v[116:119], 0
    v_mfma_f32_32x32x16_bf16 v[208:223], v[108:111], v[112:115], v[208:223]
    s_waitcnt lgkmcnt(6)
    v_mfma_f32_32x32x16_bf16 v[192:207], v[120:123], v[128:131], v[192:207]
    ds_read_b64 v[104:105], v95 offset:4000
    ds_read_b64 v[106:107], v95 offset:4008
    ds_read_b128 v[112:115], v3 offset:32
    ds_read_b128 v[116:119], v97 offset:2432
    ds_read_b64 v[108:109], v95 offset:1952
    ds_read_b64 v[110:111], v95 offset:1960
    v_mfma_f32_32x32x16_bf16 v[208:223], v[120:123], v[132:135], v[208:223]
    v_mfma_f32_32x32x16_bf16 v[208:223], v[124:127], v[128:131], v[208:223]
    s_waitcnt lgkmcnt(6)
    v_mfma_f32_32x32x16_bf16 v[192:207], v[136:139], v[144:147], v[192:207]
    v_add_u32 v2, 4294967136, v96
    v_max_i32 v2, v2, v98
    ds_read_b64 v[120:121], v95 offset:3904
    ds_read_b64 v[122:123], v95 offset:3912
    ds_read_b128 v[128:131], v2 offset:0
    ds_read_b128 v[132:135], v97 offset:2320
    ds_read_b64 v[124:125], v95 offset:1856
    ds_read_b64 v[126:127], v95 offset:1864
    v_mfma_f32_32x32x16_bf16 v[208:223], v[136:139], v[148:151], v[208:223]
    v_mfma_f32_32x32x16_bf16 v[208:223], v[140:143], v[144:147], v[208:223]
    s_waitcnt lgkmcnt(6)
    v_mfma_f32_32x32x16_bf16 v[192:207], v[104:107], v[112:115], v[192:207]
    ds_read_b64 v[136:137], v95 offset:3936
    ds_read_b64 v[138:139], v95 offset:3944
    ds_read_b128 v[144:147], v2 offset:32
    ds_read_b128 v[148:151], v97 offset:2352
    ds_read_b64 v[140:141], v95 offset:1888
    ds_read_b64 v[142:143], v95 offset:1896
    v_mfma_f32_32x32x16_bf16 v[208:223], v[104:107], v[116:119], v[208:223]
    v_mfma_f32_32x32x16_bf16 v[208:223], v[108:111], v[112:115], v[208:223]
    s_waitcnt lgkmcnt(6)
    v_mfma_f32_32x32x16_bf16 v[192:207], v[120:123], v[128:131], v[192:207]
    v_add_u32 v3, 4294967056, v96
    v_max_i32 v3, v3, v98
    ds_read_b64 v[104:105], v95 offset:3840
    ds_read_b64 v[106:107], v95 offset:3848
    ds_read_b128 v[112:115], v3 offset:0
    ds_read_b128 v[116:119], v97 offset:2240
    ds_read_b64 v[108:109], v95 offset:1792
    ds_read_b64 v[110:111], v95 offset:1800
    v_mfma_f32_32x32x16_bf16 v[208:223], v[120:123], v[132:135], v[208:223]
    v_mfma_f32_32x32x16_bf16 v[208:223], v[124:127], v[128:131], v[208:223]
    s_waitcnt lgkmcnt(6)
    v_mfma_f32_32x32x16_bf16 v[192:207], v[136:139], v[144:147], v[192:207]
    ds_read_b64 v[120:121], v95 offset:3872
    ds_read_b64 v[122:123], v95 offset:3880
    ds_read_b128 v[128:131], v3 offset:32
    ds_read_b128 v[132:135], v97 offset:2272
    ds_read_b64 v[124:125], v95 offset:1824
    ds_read_b64 v[126:127], v95 offset:1832
    v_mfma_f32_32x32x16_bf16 v[208:223], v[136:139], v[148:151], v[208:223]
    v_mfma_f32_32x32x16_bf16 v[208:223], v[140:143], v[144:147], v[208:223]
    s_waitcnt lgkmcnt(6)
    v_mfma_f32_32x32x16_bf16 v[192:207], v[104:107], v[112:115], v[192:207]
    v_add_u32 v2, 4294966976, v96
    v_max_i32 v2, v2, v98
    ds_read_b64 v[136:137], v95 offset:3776
    ds_read_b64 v[138:139], v95 offset:3784
    ds_read_b128 v[144:147], v2 offset:0
    ds_read_b128 v[148:151], v97 offset:2160
    ds_read_b64 v[140:141], v95 offset:1728
    ds_read_b64 v[142:143], v95 offset:1736
    v_mfma_f32_32x32x16_bf16 v[208:223], v[104:107], v[116:119], v[208:223]
    v_mfma_f32_32x32x16_bf16 v[208:223], v[108:111], v[112:115], v[208:223]
    s_waitcnt lgkmcnt(6)
    v_mfma_f32_32x32x16_bf16 v[192:207], v[120:123], v[128:131], v[192:207]
    ds_read_b64 v[104:105], v95 offset:3808
    ds_read_b64 v[106:107], v95 offset:3816
    ds_read_b128 v[112:115], v2 offset:32
    ds_read_b128 v[116:119], v97 offset:2192
    ds_read_b64 v[108:109], v95 offset:1760
    ds_read_b64 v[110:111], v95 offset:1768
    v_mfma_f32_32x32x16_bf16 v[208:223], v[120:123], v[132:135], v[208:223]
    v_mfma_f32_32x32x16_bf16 v[208:223], v[124:127], v[128:131], v[208:223]
    s_waitcnt lgkmcnt(6)
    v_mfma_f32_32x32x16_bf16 v[192:207], v[136:139], v[144:147], v[192:207]
    v_add_u32 v3, 4294966896, v96
    v_max_i32 v3, v3, v98
    ds_read_b64 v[120:121], v95 offset:3712
    ds_read_b64 v[122:123], v95 offset:3720
    ds_read_b128 v[128:131], v3 offset:0
    ds_read_b128 v[132:135], v97 offset:2080
    ds_read_b64 v[124:125], v95 offset:1664
    ds_read_b64 v[126:127], v95 offset:1672
    v_mfma_f32_32x32x16_bf16 v[208:223], v[136:139], v[148:151], v[208:223]
    v_mfma_f32_32x32x16_bf16 v[208:223], v[140:143], v[144:147], v[208:223]
    s_waitcnt lgkmcnt(6)
    v_mfma_f32_32x32x16_bf16 v[192:207], v[104:107], v[112:115], v[192:207]
    ds_read_b64 v[136:137], v95 offset:3744
    ds_read_b64 v[138:139], v95 offset:3752
    ds_read_b128 v[144:147], v3 offset:32
    ds_read_b128 v[148:151], v97 offset:2112
    ds_read_b64 v[140:141], v95 offset:1696
    ds_read_b64 v[142:143], v95 offset:1704
    v_mfma_f32_32x32x16_bf16 v[208:223], v[104:107], v[116:119], v[208:223]
    v_mfma_f32_32x32x16_bf16 v[208:223], v[108:111], v[112:115], v[208:223]
    s_waitcnt lgkmcnt(6)
    v_mfma_f32_32x32x16_bf16 v[192:207], v[120:123], v[128:131], v[192:207]
    v_add_u32 v2, 4294966816, v96
    v_max_i32 v2, v2, v98
    ds_read_b64 v[104:105], v95 offset:3648
    ds_read_b64 v[106:107], v95 offset:3656
    ds_read_b128 v[112:115], v2 offset:0
    ds_read_b128 v[116:119], v97 offset:2000
    ds_read_b64 v[108:109], v95 offset:1600
    ds_read_b64 v[110:111], v95 offset:1608
    v_mfma_f32_32x32x16_bf16 v[208:223], v[120:123], v[132:135], v[208:223]
    v_mfma_f32_32x32x16_bf16 v[208:223], v[124:127], v[128:131], v[208:223]
    s_waitcnt lgkmcnt(6)
    v_mfma_f32_32x32x16_bf16 v[192:207], v[136:139], v[144:147], v[192:207]
    ds_read_b64 v[120:121], v95 offset:3680
    ds_read_b64 v[122:123], v95 offset:3688
    ds_read_b128 v[128:131], v2 offset:32
    ds_read_b128 v[132:135], v97 offset:2032
    ds_read_b64 v[124:125], v95 offset:1632
    ds_read_b64 v[126:127], v95 offset:1640
    v_mfma_f32_32x32x16_bf16 v[208:223], v[136:139], v[148:151], v[208:223]
    v_mfma_f32_32x32x16_bf16 v[208:223], v[140:143], v[144:147], v[208:223]
    s_waitcnt lgkmcnt(6)
    v_mfma_f32_32x32x16_bf16 v[192:207], v[104:107], v[112:115], v[192:207]
    v_add_u32 v3, 4294966736, v96
    v_max_i32 v3, v3, v98
    ds_read_b64 v[136:137], v95 offset:3584
    ds_read_b64 v[138:139], v95 offset:3592
    ds_read_b128 v[144:147], v3 offset:0
    ds_read_b128 v[148:151], v97 offset:1920
    ds_read_b64 v[140:141], v95 offset:1536
    ds_read_b64 v[142:143], v95 offset:1544
    v_mfma_f32_32x32x16_bf16 v[208:223], v[104:107], v[116:119], v[208:223]
    v_mfma_f32_32x32x16_bf16 v[208:223], v[108:111], v[112:115], v[208:223]
    s_waitcnt lgkmcnt(6)
    v_mfma_f32_32x32x16_bf16 v[192:207], v[120:123], v[128:131], v[192:207]
    ds_read_b64 v[104:105], v95 offset:3616
    ds_read_b64 v[106:107], v95 offset:3624
    ds_read_b128 v[112:115], v3 offset:32
    ds_read_b128 v[116:119], v97 offset:1952
    ds_read_b64 v[108:109], v95 offset:1568
    ds_read_b64 v[110:111], v95 offset:1576
    v_mfma_f32_32x32x16_bf16 v[208:223], v[120:123], v[132:135], v[208:223]
    v_mfma_f32_32x32x16_bf16 v[208:223], v[124:127], v[128:131], v[208:223]
    s_waitcnt lgkmcnt(6)
    v_mfma_f32_32x32x16_bf16 v[192:207], v[136:139], v[144:147], v[192:207]
    v_add_u32 v2, 4294966656, v96
    v_max_i32 v2, v2, v98
    ds_read_b64 v[120:121], v95 offset:3520
    ds_read_b64 v[122:123], v95 offset:3528
    ds_read_b128 v[128:131], v2 offset:0
    ds_read_b128 v[132:135], v97 offset:1840
    ds_read_b64 v[124:125], v95 offset:1472
    ds_read_b64 v[126:127], v95 offset:1480
    v_mfma_f32_32x32x16_bf16 v[208:223], v[136:139], v[148:151], v[208:223]
    v_mfma_f32_32x32x16_bf16 v[208:223], v[140:143], v[144:147], v[208:223]
    s_waitcnt lgkmcnt(6)
    v_mfma_f32_32x32x16_bf16 v[192:207], v[104:107], v[112:115], v[192:207]
    ds_read_b64 v[136:137], v95 offset:3552
    ds_read_b64 v[138:139], v95 offset:3560
    ds_read_b128 v[144:147], v2 offset:32
    ds_read_b128 v[148:151], v97 offset:1872
    ds_read_b64 v[140:141], v95 offset:1504
    ds_read_b64 v[142:143], v95 offset:1512
    v_mfma_f32_32x32x16_bf16 v[208:223], v[104:107], v[116:119], v[208:223]
    v_mfma_f32_32x32x16_bf16 v[208:223], v[108:111], v[112:115], v[208:223]
    s_waitcnt lgkmcnt(6)
    v_mfma_f32_32x32x16_bf16 v[192:207], v[120:123], v[128:131], v[192:207]
    v_add_u32 v3, 4294966576, v96
    v_max_i32 v3, v3, v98
    ds_read_b64 v[104:105], v95 offset:3456
    ds_read_b64 v[106:107], v95 offset:3464
    ds_read_b128 v[112:115], v3 offset:0
    ds_read_b128 v[116:119], v97 offset:1760
    ds_read_b64 v[108:109], v95 offset:1408
    ds_read_b64 v[110:111], v95 offset:1416
    v_mfma_f32_32x32x16_bf16 v[208:223], v[120:123], v[132:135], v[208:223]
    v_mfma_f32_32x32x16_bf16 v[208:223], v[124:127], v[128:131], v[208:223]
    s_waitcnt lgkmcnt(6)
    v_mfma_f32_32x32x16_bf16 v[192:207], v[136:139], v[144:147], v[192:207]
    ds_read_b64 v[120:121], v95 offset:3488
    ds_read_b64 v[122:123], v95 offset:3496
    ds_read_b128 v[128:131], v3 offset:32
    ds_read_b128 v[132:135], v97 offset:1792
    ds_read_b64 v[124:125], v95 offset:1440
    ds_read_b64 v[126:127], v95 offset:1448
    v_mfma_f32_32x32x16_bf16 v[208:223], v[136:139], v[148:151], v[208:223]
    v_mfma_f32_32x32x16_bf16 v[208:223], v[140:143], v[144:147], v[208:223]
    s_waitcnt lgkmcnt(6)
    v_mfma_f32_32x32x16_bf16 v[192:207], v[104:107], v[112:115], v[192:207]
    v_add_u32 v2, 4294966496, v96
    v_max_i32 v2, v2, v98
    ds_read_b64 v[136:137], v95 offset:3392
    ds_read_b64 v[138:139], v95 offset:3400
    ds_read_b128 v[144:147], v2 offset:0
    ds_read_b128 v[148:151], v97 offset:1680
    ds_read_b64 v[140:141], v95 offset:1344
    ds_read_b64 v[142:143], v95 offset:1352
    v_mfma_f32_32x32x16_bf16 v[208:223], v[104:107], v[116:119], v[208:223]
    v_mfma_f32_32x32x16_bf16 v[208:223], v[108:111], v[112:115], v[208:223]
    s_waitcnt lgkmcnt(6)
    v_mfma_f32_32x32x16_bf16 v[192:207], v[120:123], v[128:131], v[192:207]
    ds_read_b64 v[104:105], v95 offset:3424
    ds_read_b64 v[106:107], v95 offset:3432
    ds_read_b128 v[112:115], v2 offset:32
    ds_read_b128 v[116:119], v97 offset:1712
    ds_read_b64 v[108:109], v95 offset:1376
    ds_read_b64 v[110:111], v95 offset:1384
    v_mfma_f32_32x32x16_bf16 v[208:223], v[120:123], v[132:135], v[208:223]
    v_mfma_f32_32x32x16_bf16 v[208:223], v[124:127], v[128:131], v[208:223]
    s_waitcnt lgkmcnt(6)
    v_mfma_f32_32x32x16_bf16 v[192:207], v[136:139], v[144:147], v[192:207]
    v_add_u32 v3, 4294966416, v96
    v_max_i32 v3, v3, v98
    ds_read_b64 v[120:121], v95 offset:3328
    ds_read_b64 v[122:123], v95 offset:3336
    ds_read_b128 v[128:131], v3 offset:0
    ds_read_b128 v[132:135], v97 offset:1600
    ds_read_b64 v[124:125], v95 offset:1280
    ds_read_b64 v[126:127], v95 offset:1288
    v_mfma_f32_32x32x16_bf16 v[208:223], v[136:139], v[148:151], v[208:223]
    v_mfma_f32_32x32x16_bf16 v[208:223], v[140:143], v[144:147], v[208:223]
    s_waitcnt lgkmcnt(6)
    v_mfma_f32_32x32x16_bf16 v[192:207], v[104:107], v[112:115], v[192:207]
    ds_read_b64 v[136:137], v95 offset:3360
    ds_read_b64 v[138:139], v95 offset:3368
    ds_read_b128 v[144:147], v3 offset:32
    ds_read_b128 v[148:151], v97 offset:1632
    ds_read_b64 v[140:141], v95 offset:1312
    ds_read_b64 v[142:143], v95 offset:1320
    v_mfma_f32_32x32x16_bf16 v[208:223], v[104:107], v[116:119], v[208:223]
    v_mfma_f32_32x32x16_bf16 v[208:223], v[108:111], v[112:115], v[208:223]
    s_waitcnt lgkmcnt(6)
    v_mfma_f32_32x32x16_bf16 v[192:207], v[120:123], v[128:131], v[192:207]
    v_add_u32 v2, 4294966336, v96
    v_max_i32 v2, v2, v98
    ds_read_b64 v[104:105], v95 offset:3264
    ds_read_b64 v[106:107], v95 offset:3272
    ds_read_b128 v[112:115], v2 offset:0
    ds_read_b128 v[116:119], v97 offset:1520
    ds_read_b64 v[108:109], v95 offset:1216
    ds_read_b64 v[110:111], v95 offset:1224
    v_mfma_f32_32x32x16_bf16 v[208:223], v[120:123], v[132:135], v[208:223]
    v_mfma_f32_32x32x16_bf16 v[208:223], v[124:127], v[128:131], v[208:223]
    s_waitcnt lgkmcnt(6)
    v_mfma_f32_32x32x16_bf16 v[192:207], v[136:139], v[144:147], v[192:207]
    ds_read_b64 v[120:121], v95 offset:3296
    ds_read_b64 v[122:123], v95 offset:3304
    ds_read_b128 v[128:131], v2 offset:32
    ds_read_b128 v[132:135], v97 offset:1552
    ds_read_b64 v[124:125], v95 offset:1248
    ds_read_b64 v[126:127], v95 offset:1256
    v_mfma_f32_32x32x16_bf16 v[208:223], v[136:139], v[148:151], v[208:223]
    v_mfma_f32_32x32x16_bf16 v[208:223], v[140:143], v[144:147], v[208:223]
    s_waitcnt lgkmcnt(6)
    v_mfma_f32_32x32x16_bf16 v[192:207], v[104:107], v[112:115], v[192:207]
    v_add_u32 v3, 4294966256, v96
    v_max_i32 v3, v3, v98
    ds_read_b64 v[136:137], v95 offset:3200
    ds_read_b64 v[138:139], v95 offset:3208
    ds_read_b128 v[144:147], v3 offset:0
    ds_read_b128 v[148:151], v97 offset:1440
    ds_read_b64 v[140:141], v95 offset:1152
    ds_read_b64 v[142:143], v95 offset:1160
    v_mfma_f32_32x32x16_bf16 v[208:223], v[104:107], v[116:119], v[208:223]
    v_mfma_f32_32x32x16_bf16 v[208:223], v[108:111], v[112:115], v[208:223]
    s_waitcnt lgkmcnt(6)
    v_mfma_f32_32x32x16_bf16 v[192:207], v[120:123], v[128:131], v[192:207]
    ds_read_b64 v[104:105], v95 offset:3232
    ds_read_b64 v[106:107], v95 offset:3240
    ds_read_b128 v[112:115], v3 offset:32
    ds_read_b128 v[116:119], v97 offset:1472
    ds_read_b64 v[108:109], v95 offset:1184
    ds_read_b64 v[110:111], v95 offset:1192
    v_mfma_f32_32x32x16_bf16 v[208:223], v[120:123], v[132:135], v[208:223]
    v_mfma_f32_32x32x16_bf16 v[208:223], v[124:127], v[128:131], v[208:223]
    s_waitcnt lgkmcnt(6)
    v_mfma_f32_32x32x16_bf16 v[192:207], v[136:139], v[144:147], v[192:207]
    v_add_u32 v2, 4294966176, v96
    v_max_i32 v2, v2, v98
    ds_read_b64 v[120:121], v95 offset:3136
    ds_read_b64 v[122:123], v95 offset:3144
    ds_read_b128 v[128:131], v2 offset:0
    ds_read_b128 v[132:135], v97 offset:1360
    ds_read_b64 v[124:125], v95 offset:1088
    ds_read_b64 v[126:127], v95 offset:1096
    v_mfma_f32_32x32x16_bf16 v[208:223], v[136:139], v[148:151], v[208:223]
    v_mfma_f32_32x32x16_bf16 v[208:223], v[140:143], v[144:147], v[208:223]
    s_waitcnt lgkmcnt(6)
    v_mfma_f32_32x32x16_bf16 v[192:207], v[104:107], v[112:115], v[192:207]
    ds_read_b64 v[136:137], v95 offset:3168
    ds_read_b64 v[138:139], v95 offset:3176
    ds_read_b128 v[144:147], v2 offset:32
    ds_read_b128 v[148:151], v97 offset:1392
    ds_read_b64 v[140:141], v95 offset:1120
    ds_read_b64 v[142:143], v95 offset:1128
    v_mfma_f32_32x32x16_bf16 v[208:223], v[104:107], v[116:119], v[208:223]
    v_mfma_f32_32x32x16_bf16 v[208:223], v[108:111], v[112:115], v[208:223]
    s_waitcnt lgkmcnt(6)
    v_mfma_f32_32x32x16_bf16 v[192:207], v[120:123], v[128:131], v[192:207]
    v_add_u32 v3, 4294966096, v96
    v_max_i32 v3, v3, v98
    ds_read_b64 v[104:105], v95 offset:3072
    ds_read_b64 v[106:107], v95 offset:3080
    ds_read_b128 v[112:115], v3 offset:0
    ds_read_b128 v[116:119], v97 offset:1280
    ds_read_b64 v[108:109], v95 offset:1024
    ds_read_b64 v[110:111], v95 offset:1032
    v_mfma_f32_32x32x16_bf16 v[208:223], v[120:123], v[132:135], v[208:223]
    v_mfma_f32_32x32x16_bf16 v[208:223], v[124:127], v[128:131], v[208:223]
    s_waitcnt lgkmcnt(6)
    v_mfma_f32_32x32x16_bf16 v[192:207], v[136:139], v[144:147], v[192:207]
    ds_read_b64 v[120:121], v95 offset:3104
    ds_read_b64 v[122:123], v95 offset:3112
    ds_read_b128 v[128:131], v3 offset:32
    ds_read_b128 v[132:135], v97 offset:1312
    ds_read_b64 v[124:125], v95 offset:1056
    ds_read_b64 v[126:127], v95 offset:1064
    v_mfma_f32_32x32x16_bf16 v[208:223], v[136:139], v[148:151], v[208:223]
    v_mfma_f32_32x32x16_bf16 v[208:223], v[140:143], v[144:147], v[208:223]
    s_waitcnt lgkmcnt(6)
    v_mfma_f32_32x32x16_bf16 v[192:207], v[104:107], v[112:115], v[192:207]
    v_add_u32 v2, 4294966016, v96
    v_max_i32 v2, v2, v98
    ds_read_b64 v[136:137], v95 offset:3008
    ds_read_b64 v[138:139], v95 offset:3016
    ds_read_b128 v[144:147], v2 offset:0
    ds_read_b128 v[148:151], v97 offset:1200
    ds_read_b64 v[140:141], v95 offset:960
    ds_read_b64 v[142:143], v95 offset:968
    v_mfma_f32_32x32x16_bf16 v[208:223], v[104:107], v[116:119], v[208:223]
    v_mfma_f32_32x32x16_bf16 v[208:223], v[108:111], v[112:115], v[208:223]
    s_waitcnt lgkmcnt(6)
    v_mfma_f32_32x32x16_bf16 v[192:207], v[120:123], v[128:131], v[192:207]
    ds_read_b64 v[104:105], v95 offset:3040
    ds_read_b64 v[106:107], v95 offset:3048
    ds_read_b128 v[112:115], v2 offset:32
    ds_read_b128 v[116:119], v97 offset:1232
    ds_read_b64 v[108:109], v95 offset:992
    ds_read_b64 v[110:111], v95 offset:1000
    v_mfma_f32_32x32x16_bf16 v[208:223], v[120:123], v[132:135], v[208:223]
    v_mfma_f32_32x32x16_bf16 v[208:223], v[124:127], v[128:131], v[208:223]
    s_waitcnt lgkmcnt(6)
    v_mfma_f32_32x32x16_bf16 v[192:207], v[136:139], v[144:147], v[192:207]
    v_add_u32 v3, 4294965936, v96
    v_max_i32 v3, v3, v98
    ds_read_b64 v[120:121], v95 offset:2944
    ds_read_b64 v[122:123], v95 offset:2952
    ds_read_b128 v[128:131], v3 offset:0
    ds_read_b128 v[132:135], v97 offset:1120
    ds_read_b64 v[124:125], v95 offset:896
    ds_read_b64 v[126:127], v95 offset:904
    v_mfma_f32_32x32x16_bf16 v[208:223], v[136:139], v[148:151], v[208:223]
    v_mfma_f32_32x32x16_bf16 v[208:223], v[140:143], v[144:147], v[208:223]
    s_waitcnt lgkmcnt(6)
    v_mfma_f32_32x32x16_bf16 v[192:207], v[104:107], v[112:115], v[192:207]
    ds_read_b64 v[136:137], v95 offset:2976
    ds_read_b64 v[138:139], v95 offset:2984
    ds_read_b128 v[144:147], v3 offset:32
    ds_read_b128 v[148:151], v97 offset:1152
    ds_read_b64 v[140:141], v95 offset:928
    ds_read_b64 v[142:143], v95 offset:936
    v_mfma_f32_32x32x16_bf16 v[208:223], v[104:107], v[116:119], v[208:223]
    v_mfma_f32_32x32x16_bf16 v[208:223], v[108:111], v[112:115], v[208:223]
    s_waitcnt lgkmcnt(6)
    v_mfma_f32_32x32x16_bf16 v[192:207], v[120:123], v[128:131], v[192:207]
    v_add_u32 v2, 4294965856, v96
    v_max_i32 v2, v2, v98
    ds_read_b64 v[104:105], v95 offset:2880
    ds_read_b64 v[106:107], v95 offset:2888
    ds_read_b128 v[112:115], v2 offset:0
    ds_read_b128 v[116:119], v97 offset:1040
    ds_read_b64 v[108:109], v95 offset:832
    ds_read_b64 v[110:111], v95 offset:840
    v_mfma_f32_32x32x16_bf16 v[208:223], v[120:123], v[132:135], v[208:223]
    v_mfma_f32_32x32x16_bf16 v[208:223], v[124:127], v[128:131], v[208:223]
    s_waitcnt lgkmcnt(6)
    v_mfma_f32_32x32x16_bf16 v[192:207], v[136:139], v[144:147], v[192:207]
    ds_read_b64 v[120:121], v95 offset:2912
    ds_read_b64 v[122:123], v95 offset:2920
    ds_read_b128 v[128:131], v2 offset:32
    ds_read_b128 v[132:135], v97 offset:1072
    ds_read_b64 v[124:125], v95 offset:864
    ds_read_b64 v[126:127], v95 offset:872
    v_mfma_f32_32x32x16_bf16 v[208:223], v[136:139], v[148:151], v[208:223]
    v_mfma_f32_32x32x16_bf16 v[208:223], v[140:143], v[144:147], v[208:223]
    s_waitcnt lgkmcnt(6)
    v_mfma_f32_32x32x16_bf16 v[192:207], v[104:107], v[112:115], v[192:207]
    v_add_u32 v3, 4294965776, v96
    v_max_i32 v3, v3, v98
    ds_read_b64 v[136:137], v95 offset:2816
    ds_read_b64 v[138:139], v95 offset:2824
    ds_read_b128 v[144:147], v3 offset:0
    ds_read_b128 v[148:151], v97 offset:960
    ds_read_b64 v[140:141], v95 offset:768
    ds_read_b64 v[142:143], v95 offset:776
    v_mfma_f32_32x32x16_bf16 v[208:223], v[104:107], v[116:119], v[208:223]
    v_mfma_f32_32x32x16_bf16 v[208:223], v[108:111], v[112:115], v[208:223]
    s_waitcnt lgkmcnt(6)
    v_mfma_f32_32x32x16_bf16 v[192:207], v[120:123], v[128:131], v[192:207]
    ds_read_b64 v[104:105], v95 offset:2848
    ds_read_b64 v[106:107], v95 offset:2856
    ds_read_b128 v[112:115], v3 offset:32
    ds_read_b128 v[116:119], v97 offset:992
    ds_read_b64 v[108:109], v95 offset:800
    ds_read_b64 v[110:111], v95 offset:808
    v_mfma_f32_32x32x16_bf16 v[208:223], v[120:123], v[132:135], v[208:223]
    v_mfma_f32_32x32x16_bf16 v[208:223], v[124:127], v[128:131], v[208:223]
    s_waitcnt lgkmcnt(6)
    v_mfma_f32_32x32x16_bf16 v[192:207], v[136:139], v[144:147], v[192:207]
    v_add_u32 v2, 4294965696, v96
    v_max_i32 v2, v2, v98
    ds_read_b64 v[120:121], v95 offset:2752
    ds_read_b64 v[122:123], v95 offset:2760
    ds_read_b128 v[128:131], v2 offset:0
    ds_read_b128 v[132:135], v97 offset:880
    ds_read_b64 v[124:125], v95 offset:704
    ds_read_b64 v[126:127], v95 offset:712
    v_mfma_f32_32x32x16_bf16 v[208:223], v[136:139], v[148:151], v[208:223]
    v_mfma_f32_32x32x16_bf16 v[208:223], v[140:143], v[144:147], v[208:223]
    s_waitcnt lgkmcnt(6)
    v_mfma_f32_32x32x16_bf16 v[192:207], v[104:107], v[112:115], v[192:207]
    ds_read_b64 v[136:137], v95 offset:2784
    ds_read_b64 v[138:139], v95 offset:2792
    ds_read_b128 v[144:147], v2 offset:32
    ds_read_b128 v[148:151], v97 offset:912
    ds_read_b64 v[140:141], v95 offset:736
    ds_read_b64 v[142:143], v95 offset:744
    v_mfma_f32_32x32x16_bf16 v[208:223], v[104:107], v[116:119], v[208:223]
    v_mfma_f32_32x32x16_bf16 v[208:223], v[108:111], v[112:115], v[208:223]
    s_waitcnt lgkmcnt(6)
    v_mfma_f32_32x32x16_bf16 v[192:207], v[120:123], v[128:131], v[192:207]
    v_add_u32 v3, 4294965616, v96
    v_max_i32 v3, v3, v98
    ds_read_b64 v[104:105], v95 offset:2688
    ds_read_b64 v[106:107], v95 offset:2696
    ds_read_b128 v[112:115], v3 offset:0
    ds_read_b128 v[116:119], v97 offset:800
    ds_read_b64 v[108:109], v95 offset:640
    ds_read_b64 v[110:111], v95 offset:648
    v_mfma_f32_32x32x16_bf16 v[208:223], v[120:123], v[132:135], v[208:223]
    v_mfma_f32_32x32x16_bf16 v[208:223], v[124:127], v[128:131], v[208:223]
    s_waitcnt lgkmcnt(6)
    v_mfma_f32_32x32x16_bf16 v[192:207], v[136:139], v[144:147], v[192:207]
    ds_read_b64 v[120:121], v95 offset:2720
    ds_read_b64 v[122:123], v95 offset:2728
    ds_read_b128 v[128:131], v3 offset:32
    ds_read_b128 v[132:135], v97 offset:832
    ds_read_b64 v[124:125], v95 offset:672
    ds_read_b64 v[126:127], v95 offset:680
    v_mfma_f32_32x32x16_bf16 v[208:223], v[136:139], v[148:151], v[208:223]
    v_mfma_f32_32x32x16_bf16 v[208:223], v[140:143], v[144:147], v[208:223]
    s_waitcnt lgkmcnt(6)
    v_mfma_f32_32x32x16_bf16 v[192:207], v[104:107], v[112:115], v[192:207]
    v_add_u32 v2, 4294965536, v96
    v_max_i32 v2, v2, v98
    ds_read_b64 v[136:137], v95 offset:2624
    ds_read_b64 v[138:139], v95 offset:2632
    ds_read_b128 v[144:147], v2 offset:0
    ds_read_b128 v[148:151], v97 offset:720
    ds_read_b64 v[140:141], v95 offset:576
    ds_read_b64 v[142:143], v95 offset:584
    v_mfma_f32_32x32x16_bf16 v[208:223], v[104:107], v[116:119], v[208:223]
    v_mfma_f32_32x32x16_bf16 v[208:223], v[108:111], v[112:115], v[208:223]
    s_waitcnt lgkmcnt(6)
    v_mfma_f32_32x32x16_bf16 v[192:207], v[120:123], v[128:131], v[192:207]
    ds_read_b64 v[104:105], v95 offset:2656
    ds_read_b64 v[106:107], v95 offset:2664
    ds_read_b128 v[112:115], v2 offset:32
    ds_read_b128 v[116:119], v97 offset:752
    ds_read_b64 v[108:109], v95 offset:608
    ds_read_b64 v[110:111], v95 offset:616
    v_mfma_f32_32x32x16_bf16 v[208:223], v[120:123], v[132:135], v[208:223]
    v_mfma_f32_32x32x16_bf16 v[208:223], v[124:127], v[128:131], v[208:223]
    s_waitcnt lgkmcnt(6)
    v_mfma_f32_32x32x16_bf16 v[192:207], v[136:139], v[144:147], v[192:207]
    v_add_u32 v3, 4294965456, v96
    v_max_i32 v3, v3, v98
    ds_read_b64 v[120:121], v95 offset:2560
    ds_read_b64 v[122:123], v95 offset:2568
    ds_read_b128 v[128:131], v3 offset:0
    ds_read_b128 v[132:135], v97 offset:640
    ds_read_b64 v[124:125], v95 offset:512
    ds_read_b64 v[126:127], v95 offset:520
    v_mfma_f32_32x32x16_bf16 v[208:223], v[136:139], v[148:151], v[208:223]
    v_mfma_f32_32x32x16_bf16 v[208:223], v[140:143], v[144:147], v[208:223]
    s_waitcnt lgkmcnt(6)
    v_mfma_f32_32x32x16_bf16 v[192:207], v[104:107], v[112:115], v[192:207]
    ds_read_b64 v[136:137], v95 offset:2592
    ds_read_b64 v[138:139], v95 offset:2600
    ds_read_b128 v[144:147], v3 offset:32
    ds_read_b128 v[148:151], v97 offset:672
    ds_read_b64 v[140:141], v95 offset:544
    ds_read_b64 v[142:143], v95 offset:552
    v_mfma_f32_32x32x16_bf16 v[208:223], v[104:107], v[116:119], v[208:223]
    v_mfma_f32_32x32x16_bf16 v[208:223], v[108:111], v[112:115], v[208:223]
    s_waitcnt lgkmcnt(6)
    v_mfma_f32_32x32x16_bf16 v[192:207], v[120:123], v[128:131], v[192:207]
    v_add_u32 v2, 4294965376, v96
    v_max_i32 v2, v2, v98
    ds_read_b64 v[104:105], v95 offset:2496
    ds_read_b64 v[106:107], v95 offset:2504
    ds_read_b128 v[112:115], v2 offset:0
    ds_read_b128 v[116:119], v97 offset:560
    ds_read_b64 v[108:109], v95 offset:448
    ds_read_b64 v[110:111], v95 offset:456
    v_mfma_f32_32x32x16_bf16 v[208:223], v[120:123], v[132:135], v[208:223]
    v_mfma_f32_32x32x16_bf16 v[208:223], v[124:127], v[128:131], v[208:223]
    s_waitcnt lgkmcnt(6)
    v_mfma_f32_32x32x16_bf16 v[192:207], v[136:139], v[144:147], v[192:207]
    ds_read_b64 v[120:121], v95 offset:2528
    ds_read_b64 v[122:123], v95 offset:2536
    ds_read_b128 v[128:131], v2 offset:32
    ds_read_b128 v[132:135], v97 offset:592
    ds_read_b64 v[124:125], v95 offset:480
    ds_read_b64 v[126:127], v95 offset:488
    v_mfma_f32_32x32x16_bf16 v[208:223], v[136:139], v[148:151], v[208:223]
    v_mfma_f32_32x32x16_bf16 v[208:223], v[140:143], v[144:147], v[208:223]
    s_waitcnt lgkmcnt(6)
    v_mfma_f32_32x32x16_bf16 v[192:207], v[104:107], v[112:115], v[192:207]
    v_add_u32 v3, 4294965296, v96
    v_max_i32 v3, v3, v98
    ds_read_b64 v[136:137], v95 offset:2432
    ds_read_b64 v[138:139], v95 offset:2440
    ds_read_b128 v[144:147], v3 offset:0
    ds_read_b128 v[148:151], v97 offset:480
    ds_read_b64 v[140:141], v95 offset:384
    ds_read_b64 v[142:143], v95 offset:392
    v_mfma_f32_32x32x16_bf16 v[208:223], v[104:107], v[116:119], v[208:223]
    v_mfma_f32_32x32x16_bf16 v[208:223], v[108:111], v[112:115], v[208:223]
    s_waitcnt lgkmcnt(6)
    v_mfma_f32_32x32x16_bf16 v[192:207], v[120:123], v[128:131], v[192:207]
    ds_read_b64 v[104:105], v95 offset:2464
    ds_read_b64 v[106:107], v95 offset:2472
    ds_read_b128 v[112:115], v3 offset:32
    ds_read_b128 v[116:119], v97 offset:512
    ds_read_b64 v[108:109], v95 offset:416
    ds_read_b64 v[110:111], v95 offset:424
    v_mfma_f32_32x32x16_bf16 v[208:223], v[120:123], v[132:135], v[208:223]
    v_mfma_f32_32x32x16_bf16 v[208:223], v[124:127], v[128:131], v[208:223]
    s_waitcnt lgkmcnt(6)
    v_mfma_f32_32x32x16_bf16 v[192:207], v[136:139], v[144:147], v[192:207]
    v_add_u32 v2, 4294965216, v96
    v_max_i32 v2, v2, v98
    ds_read_b64 v[120:121], v95 offset:2368
    ds_read_b64 v[122:123], v95 offset:2376
    ds_read_b128 v[128:131], v2 offset:0
    ds_read_b128 v[132:135], v97 offset:400
    ds_read_b64 v[124:125], v95 offset:320
    ds_read_b64 v[126:127], v95 offset:328
    v_mfma_f32_32x32x16_bf16 v[208:223], v[136:139], v[148:151], v[208:223]
    v_mfma_f32_32x32x16_bf16 v[208:223], v[140:143], v[144:147], v[208:223]
    s_waitcnt lgkmcnt(6)
    v_mfma_f32_32x32x16_bf16 v[192:207], v[104:107], v[112:115], v[192:207]
    ds_read_b64 v[136:137], v95 offset:2400
    ds_read_b64 v[138:139], v95 offset:2408
    ds_read_b128 v[144:147], v2 offset:32
    ds_read_b128 v[148:151], v97 offset:432
    ds_read_b64 v[140:141], v95 offset:352
    ds_read_b64 v[142:143], v95 offset:360
    v_mfma_f32_32x32x16_bf16 v[208:223], v[104:107], v[116:119], v[208:223]
    v_mfma_f32_32x32x16_bf16 v[208:223], v[108:111], v[112:115], v[208:223]
    s_waitcnt lgkmcnt(6)
    v_mfma_f32_32x32x16_bf16 v[192:207], v[120:123], v[128:131], v[192:207]
    v_add_u32 v3, 4294965136, v96
    v_max_i32 v3, v3, v98
    ds_read_b64 v[104:105], v95 offset:2304
    ds_read_b64 v[106:107], v95 offset:2312
    ds_read_b128 v[112:115], v3 offset:0
    ds_read_b128 v[116:119], v97 offset:320
    ds_read_b64 v[108:109], v95 offset:256
    ds_read_b64 v[110:111], v95 offset:264
    v_mfma_f32_32x32x16_bf16 v[208:223], v[120:123], v[132:135], v[208:223]
    v_mfma_f32_32x32x16_bf16 v[208:223], v[124:127], v[128:131], v[208:223]
    s_waitcnt lgkmcnt(6)
    v_mfma_f32_32x32x16_bf16 v[192:207], v[136:139], v[144:147], v[192:207]
    ds_read_b64 v[120:121], v95 offset:2336
    ds_read_b64 v[122:123], v95 offset:2344
    ds_read_b128 v[128:131], v3 offset:32
    ds_read_b128 v[132:135], v97 offset:352
    ds_read_b64 v[124:125], v95 offset:288
    ds_read_b64 v[126:127], v95 offset:296
    v_mfma_f32_32x32x16_bf16 v[208:223], v[136:139], v[148:151], v[208:223]
    v_mfma_f32_32x32x16_bf16 v[208:223], v[140:143], v[144:147], v[208:223]
    s_waitcnt lgkmcnt(6)
    v_mfma_f32_32x32x16_bf16 v[192:207], v[104:107], v[112:115], v[192:207]
    v_add_u32 v2, 4294965056, v96
    v_max_i32 v2, v2, v98
    ds_read_b64 v[136:137], v95 offset:2240
    ds_read_b64 v[138:139], v95 offset:2248
    ds_read_b128 v[144:147], v2 offset:0
    ds_read_b128 v[148:151], v97 offset:240
    ds_read_b64 v[140:141], v95 offset:192
    ds_read_b64 v[142:143], v95 offset:200
    v_mfma_f32_32x32x16_bf16 v[208:223], v[104:107], v[116:119], v[208:223]
    v_mfma_f32_32x32x16_bf16 v[208:223], v[108:111], v[112:115], v[208:223]
    s_waitcnt lgkmcnt(6)
    v_mfma_f32_32x32x16_bf16 v[192:207], v[120:123], v[128:131], v[192:207]
    ds_read_b64 v[104:105], v95 offset:2272
    ds_read_b64 v[106:107], v95 offset:2280
    ds_read_b128 v[112:115], v2 offset:32
    ds_read_b128 v[116:119], v97 offset:272
    ds_read_b64 v[108:109], v95 offset:224
    ds_read_b64 v[110:111], v95 offset:232
    v_mfma_f32_32x32x16_bf16 v[208:223], v[120:123], v[132:135], v[208:223]
    v_mfma_f32_32x32x16_bf16 v[208:223], v[124:127], v[128:131], v[208:223]
    s_waitcnt lgkmcnt(6)
    v_mfma_f32_32x32x16_bf16 v[192:207], v[136:139], v[144:147], v[192:207]
    v_add_u32 v3, 4294964976, v96
    v_max_i32 v3, v3, v98
    ds_read_b64 v[120:121], v95 offset:2176
    ds_read_b64 v[122:123], v95 offset:2184
    ds_read_b128 v[128:131], v3 offset:0
    ds_read_b128 v[132:135], v97 offset:160
    ds_read_b64 v[124:125], v95 offset:128
    ds_read_b64 v[126:127], v95 offset:136
    v_mfma_f32_32x32x16_bf16 v[208:223], v[136:139], v[148:151], v[208:223]
    v_mfma_f32_32x32x16_bf16 v[208:223], v[140:143], v[144:147], v[208:223]
    s_waitcnt lgkmcnt(6)
    v_mfma_f32_32x32x16_bf16 v[192:207], v[104:107], v[112:115], v[192:207]
    ds_read_b64 v[136:137], v95 offset:2208
    ds_read_b64 v[138:139], v95 offset:2216
    ds_read_b128 v[144:147], v3 offset:32
    ds_read_b128 v[148:151], v97 offset:192
    ds_read_b64 v[140:141], v95 offset:160
    ds_read_b64 v[142:143], v95 offset:168
    v_mfma_f32_32x32x16_bf16 v[208:223], v[104:107], v[116:119], v[208:223]
    v_mfma_f32_32x32x16_bf16 v[208:223], v[108:111], v[112:115], v[208:223]
    s_waitcnt lgkmcnt(6)
    v_mfma_f32_32x32x16_bf16 v[192:207], v[120:123], v[128:131], v[192:207]
    v_add_u32 v2, 4294964896, v96
    v_max_i32 v2, v2, v98
    ds_read_b64 v[104:105], v95 offset:2112
    ds_read_b64 v[106:107], v95 offset:2120
    ds_read_b128 v[112:115], v2 offset:0
    ds_read_b128 v[116:119], v97 offset:80
    ds_read_b64 v[108:109], v95 offset:64
    ds_read_b64 v[110:111], v95 offset:72
    v_mfma_f32_32x32x16_bf16 v[208:223], v[120:123], v[132:135], v[208:223]
    v_mfma_f32_32x32x16_bf16 v[208:223], v[124:127], v[128:131], v[208:223]
    s_waitcnt lgkmcnt(6)
    v_mfma_f32_32x32x16_bf16 v[192:207], v[136:139], v[144:147], v[192:207]
    ds_read_b64 v[120:121], v95 offset:2144
    ds_read_b64 v[122:123], v95 offset:2152
    ds_read_b128 v[128:131], v2 offset:32
    ds_read_b128 v[132:135], v97 offset:112
    ds_read_b64 v[124:125], v95 offset:96
    ds_read_b64 v[126:127], v95 offset:104
    v_mfma_f32_32x32x16_bf16 v[208:223], v[136:139], v[148:151], v[208:223]
    v_mfma_f32_32x32x16_bf16 v[208:223], v[140:143], v[144:147], v[208:223]
    s_waitcnt lgkmcnt(6)
    v_mfma_f32_32x32x16_bf16 v[192:207], v[104:107], v[112:115], v[192:207]
    v_add_u32 v3, 4294964816, v96
    v_max_i32 v3, v3, v98
    ds_read_b64 v[136:137], v95 offset:2048
    ds_read_b64 v[138:139], v95 offset:2056
    ds_read_b128 v[144:147], v3 offset:0
    ds_read_b128 v[148:151], v97 offset:0
    ds_read_b64 v[140:141], v95 offset:0
    ds_read_b64 v[142:143], v95 offset:8
    v_mfma_f32_32x32x16_bf16 v[208:223], v[104:107], v[116:119], v[208:223]
    v_mfma_f32_32x32x16_bf16 v[208:223], v[108:111], v[112:115], v[208:223]
    s_waitcnt lgkmcnt(6)
    v_mfma_f32_32x32x16_bf16 v[192:207], v[120:123], v[128:131], v[192:207]
    ds_read_b64 v[104:105], v95 offset:2080
    ds_read_b64 v[106:107], v95 offset:2088
    ds_read_b128 v[112:115], v3 offset:32
    ds_read_b128 v[116:119], v97 offset:32
    ds_read_b64 v[108:109], v95 offset:32
    ds_read_b64 v[110:111], v95 offset:40
    v_mfma_f32_32x32x16_bf16 v[208:223], v[120:123], v[132:135], v[208:223]
    v_mfma_f32_32x32x16_bf16 v[208:223], v[124:127], v[128:131], v[208:223]
    s_waitcnt lgkmcnt(6)
    v_mfma_f32_32x32x16_bf16 v[192:207], v[136:139], v[144:147], v[192:207]
    v_mfma_f32_32x32x16_bf16 v[208:223], v[136:139], v[148:151], v[208:223]
    v_mfma_f32_32x32x16_bf16 v[208:223], v[140:143], v[144:147], v[208:223]
    s_waitcnt lgkmcnt(0)
    v_mfma_f32_32x32x16_bf16 v[192:207], v[104:107], v[112:115], v[192:207]
    v_mfma_f32_32x32x16_bf16 v[208:223], v[104:107], v[116:119], v[208:223]
    v_mfma_f32_32x32x16_bf16 v[208:223], v[108:111], v[112:115], v[208:223]
    v_cvt_pk_bf16_f32 v192, v192, v193
    v_cvt_pk_bf16_f32 v193, v194, v195
    ds_write_b64 v99, v[192:193] offset:80
    v_cvt_pk_bf16_f32 v196, v196, v197
    v_cvt_pk_bf16_f32 v197, v198, v199
    ds_write_b64 v99, v[196:197] offset:96
    v_cvt_pk_bf16_f32 v200, v200, v201
    v_cvt_pk_bf16_f32 v201, v202, v203
    ds_write_b64 v99, v[200:201] offset:112
    v_cvt_pk_bf16_f32 v204, v204, v205
    v_cvt_pk_bf16_f32 v205, v206, v207
    ds_write_b64 v99, v[204:205] offset:128
    v_cvt_pk_bf16_f32 v208, v208, v209
    v_cvt_pk_bf16_f32 v209, v210, v211
    ds_write_b64 v99, v[208:209] offset:2640
    v_cvt_pk_bf16_f32 v212, v212, v213
    v_cvt_pk_bf16_f32 v213, v214, v215
    ds_write_b64 v99, v[212:213] offset:2656
    v_cvt_pk_bf16_f32 v216, v216, v217
    v_cvt_pk_bf16_f32 v217, v218, v219
    ds_write_b64 v99, v[216:217] offset:2672
    v_cvt_pk_bf16_f32 v220, v220, v221
    v_cvt_pk_bf16_f32 v221, v222, v223
    ds_write_b64 v99, v[220:221] offset:2688
    s_add_u32 s50, s50, 1
    s_cmp_lt_u32 s50, 2
    s_cbranch_scc1 L_s4_round
    s_lshl_b32 s32, s48, 4
    v_mov_b32 v2, s32
    global_load_dwordx4 v[4:7], v2, s[70:71]
    s_waitcnt lgkmcnt(0)
    s_barrier
    ds_read_b128 v[140:143], v101 offset:0
    ds_read_b128 v[144:147], v101 offset:5200
    ds_read_b128 v[148:151], v101 offset:10400
    ds_read_b128 v[152:155], v101 offset:15600
    ds_read_b128 v[156:159], v101 offset:20800
    ds_read_b128 v[160:163], v101 offset:26000
    ds_read_b128 v[164:167], v101 offset:31200
    ds_read_b128 v[168:171], v101 offset:36400
    s_cmp_lg_u32 s4, 0
    s_cbranch_scc1 Lverd_13_ok
    v_and_b32 v12, 7, v1
    v_lshlrev_b32 v12, 5, v12
    s_mov_b32 s30, 131072
Lverd_13:
    global_load_dwordx2 v[10:11], v12, s[6:7] sc1
    s_sub_u32 s30, s30, 1
    s_cbranch_scc1 L_abort
    s_mov_b32 s32, 0x2000
    s_waitcnt vmcnt(0)
    v_cmp_ne_u32 vcc, -1, v10
    v_cmp_ne_u32 s[34:35], s32, v11
    s_nop 0
    s_or_b64 vcc, vcc, s[34:35]
    s_cbranch_scc0 Lverd_13_ok
    v_lshrrev_b32 v11, 8, v11
    s_mov_b32 s32, 0
    v_readlane_b32 s33, v11, 0
    s_nop 0
    s_add_u32 s32, s32, s33
    v_readlane_b32 s33, v11, 1
    s_nop 0
    s_add_u32 s32, s32, s33
    v_readlane_b32 s33, v11, 2
    s_nop 0
    s_add_u32 s32, s32, s33
    v_readlane_b32 s33, v11, 3
    s_nop 0
    s_add_u32 s32, s32, s33
    v_readlane_b32 s33, v11, 4
    s_nop 0
    s_add_u32 s32, s32, s33
    v_readlane_b32 s33, v11, 5
    s_nop 0
    s_add_u32 s32, s32, s33
    v_readlane_b32 s33, v11, 6
    s_nop 0
    s_add_u32 s32, s32, s33
    v_readlane_b32 s33, v11, 7
    s_nop 0
    s_add_u32 s32, s32, s33
    s_cmp_eq_u32 s32, 256
    s_cbranch_scc1 L_restart_safe
    s_sleep 8
    s_branch Lverd_13
Lverd_13_ok:
    s_waitcnt vmcnt(0) lgkmcnt(0)
    v_lshlrev_b32 v104, 16, v4
    v_and_b32 v105, 0xffff0000, v4
    v_lshlrev_b32 v106, 16, v5
    v_and_b32 v107, 0xffff0000, v5
    v_lshlrev_b32 v108, 16, v6
    v_and_b32 v109, 0xffff0000, v6
    v_lshlrev_b32 v110, 16, v7
    v_and_b32 v111, 0xffff0000, v7
    v_mul_u32_u24 v2, 20480, v0
    s_lshl_b32 s32, s48, 4
    s_add_u32 s32, s32, 1280
    v_add_u32 v2, s32, v2
    v_lshlrev_b32 v4, 16, v16
    v_and_b32 v5, 0xffff0000, v16
    v_mul_f32 v4, v4, v104
    v_mul_f32 v5, v5, v105
    v_cvt_pk_bf16_f32 v4, v4, v5
    v_and_b32 v5, 0xffff0000, v4
    v_lshlrev_b32 v4, 16, v4
    v_lshlrev_b32 v6, 16, v140
    v_lshlrev_b32 v7, 16, v144
    v_add_f32 v4, v4, v6
    v_add_f32 v5, v5, v7
    v_cvt_pk_bf16_f32 v176, v4, v5
    v_lshlrev_b32 v4, 16, v17
    v_and_b32 v5, 0xffff0000, v17
    v_mul_f32 v4, v4, v106
    v_mul_f32 v5, v5, v107
    v_cvt_pk_bf16_f32 v4, v4, v5
    v_and_b32 v5, 0xffff0000, v4
    v_lshlrev_b32 v4, 16, v4
    v_lshlrev_b32 v6, 16, v148
    v_lshlrev_b32 v7, 16, v152
    v_add_f32 v4, v4, v6
    v_add_f32 v5, v5, v7
    v_cvt_pk_bf16_f32 v177, v4, v5
    v_lshlrev_b32 v4, 16, v18
    v_and_b32 v5, 0xffff0000, v18
    v_mul_f32 v4, v4, v108
    v_mul_f32 v5, v5, v109
    v_cvt_pk_bf16_f32 v4, v4, v5
    v_and_b32 v5, 0xffff0000, v4
    v_lshlrev_b32 v4, 16, v4
    v_lshlrev_b32 v6, 16, v156
    v_lshlrev_b32 v7, 16, v160
    v_add_f32 v4, v4, v6
    v_add_f32 v5, v5, v7
    v_cvt_pk_bf16_f32 v178, v4, v5
    v_lshlrev_b32 v4, 16, v19
    v_and_b32 v5, 0xffff0000, v19
    v_mul_f32 v4, v4, v110
    v_mul_f32 v5, v5, v111
    v_cvt_pk_bf16_f32 v4, v4, v5
    v_and_b32 v5, 0xffff0000, v4
    v_lshlrev_b32 v4, 16, v4
    v_lshlrev_b32 v6, 16, v164
    v_lshlrev_b32 v7, 16, v168
    v_add_f32 v4, v4, v6
    v_add_f32 v5, v5, v7
    v_cvt_pk_bf16_f32 v179, v4, v5
    s_mov_b32 s53, 0
    buffer_store_dwordx4 v[176:179], v2, s[16:19], s53 offen
    v_lshlrev_b32 v4, 16, v20
    v_and_b32 v5, 0xffff0000, v20
    v_mul_f32 v4, v4, v104
    v_mul_f32 v5, v5, v105
    v_cvt_pk_bf16_f32 v4, v4, v5
    v_and_b32 v5, 0xffff0000, v4
    v_lshlrev_b32 v4, 16, v4
    v_and_b32 v6, 0xffff0000, v140
    v_and_b32 v7, 0xffff0000, v144
    v_add_f32 v4, v4, v6
    v_add_f32 v5, v5, v7
    v_cvt_pk_bf16_f32 v180, v4, v5
    v_lshlrev_b32 v4, 16, v21
    v_and_b32 v5, 0xffff0000, v21
    v_mul_f32 v4, v4, v106
    v_mul_f32 v5, v5, v107
    v_cvt_pk_bf16_f32 v4, v4, v5
    v_and_b32 v5, 0xffff0000, v4
    v_lshlrev_b32 v4, 16, v4
    v_and_b32 v6, 0xffff0000, v148
    v_and_b32 v7, 0xffff0000, v152
    v_add_f32 v4, v4, v6
    v_add_f32 v5, v5, v7
    v_cvt_pk_bf16_f32 v181, v4, v5
    v_lshlrev_b32 v4, 16, v22
    v_and_b32 v5, 0xffff0000, v22
    v_mul_f32 v4, v4, v108
    v_mul_f32 v5, v5, v109
    v_cvt_pk_bf16_f32 v4, v4, v5
    v_and_b32 v5, 0xffff0000, v4
    v_lshlrev_b32 v4, 16, v4
    v_and_b32 v6, 0xffff0000, v156
    v_and_b32 v7, 0xffff0000, v160
    v_add_f32 v4, v4, v6
    v_add_f32 v5, v5, v7
    v_cvt_pk_bf16_f32 v182, v4, v5
    v_lshlrev_b32 v4, 16, v23
    v_and_b32 v5, 0xffff0000, v23
    v_mul_f32 v4, v4, v110
    v_mul_f32 v5, v5, v111
    v_cvt_pk_bf16_f32 v4, v4, v5
    v_and_b32 v5, 0xffff0000, v4
    v_lshlrev_b32 v4, 16, v4
    v_and_b32 v6, 0xffff0000, v164
    v_and_b32 v7, 0xffff0000, v168
    v_add_f32 v4, v4, v6
    v_add_f32 v5, v5, v7
    v_cvt_pk_bf16_f32 v183, v4, v5
    s_mov_b32 s53, 2560
    buffer_store_dwordx4 v[180:183], v2, s[16:19], s53 offen
    v_lshlrev_b32 v4, 16, v24
    v_and_b32 v5, 0xffff0000, v24
    v_mul_f32 v4, v4, v104
    v_mul_f32 v5, v5, v105
    v_cvt_pk_bf16_f32 v4, v4, v5
    v_and_b32 v5, 0xffff0000, v4
    v_lshlrev_b32 v4, 16, v4
    v_lshlrev_b32 v6, 16, v141
    v_lshlrev_b32 v7, 16, v145
    v_add_f32 v4, v4, v6
    v_add_f32 v5, v5, v7
    v_cvt_pk_bf16_f32 v184, v4, v5
    v_lshlrev_b32 v4, 16, v25
    v_and_b32 v5, 0xffff0000, v25
    v_mul_f32 v4, v4, v106
    v_mul_f32 v5, v5, v107
    v_cvt_pk_bf16_f32 v4, v4, v5
    v_and_b32 v5, 0xffff0000, v4
    v_lshlrev_b32 v4, 16, v4
    v_lshlrev_b32 v6, 16, v149
    v_lshlrev_b32 v7, 16, v153
    v_add_f32 v4, v4, v6
    v_add_f32 v5, v5, v7
    v_cvt_pk_bf16_f32 v185, v4, v5
    v_lshlrev_b32 v4, 16, v26
    v_and_b32 v5, 0xffff0000, v26
    v_mul_f32 v4, v4, v108
    v_mul_f32 v5, v5, v109
    v_cvt_pk_bf16_f32 v4, v4, v5
    v_and_b32 v5, 0xffff0000, v4
    v_lshlrev_b32 v4, 16, v4
    v_lshlrev_b32 v6, 16, v157
    v_lshlrev_b32 v7, 16, v161
    v_add_f32 v4, v4, v6
    v_add_f32 v5, v5, v7
    v_cvt_pk_bf16_f32 v186, v4, v5
    v_lshlrev_b32 v4, 16, v27
    v_and_b32 v5, 0xffff0000, v27
    v_mul_f32 v4, v4, v110
    v_mul_f32 v5, v5, v111
    v_cvt_pk_bf16_f32 v4, v4, v5
    v_and_b32 v5, 0xffff0000, v4
    v_lshlrev_b32 v4, 16, v4
    v_lshlrev_b32 v6, 16, v165
    v_lshlrev_b32 v7, 16, v169
    v_add_f32 v4, v4, v6
    v_add_f32 v5, v5, v7
    v_cvt_pk_bf16_f32 v187, v4, v5
    s_mov_b32 s53, 5120
    buffer_store_dwordx4 v[184:187], v2, s[16:19], s53 offen
    v_lshlrev_b32 v4, 16, v28
    v_and_b32 v5, 0xffff0000, v28
    v_mul_f32 v4, v4, v104
    v_mul_f32 v5, v5, v105
    v_cvt_pk_bf16_f32 v4, v4, v5
    v_and_b32 v5, 0xffff0000, v4
    v_lshlrev_b32 v4, 16, v4
    v_and_b32 v6, 0xffff0000, v141
    v_and_b32 v7, 0xffff0000, v145
    v_add_f32 v4, v4, v6
    v_add_f32 v5, v5, v7
    v_cvt_pk_bf16_f32 v188, v4, v5
    v_lshlrev_b32 v4, 16, v29
    v_and_b32 v5, 0xffff0000, v29
    v_mul_f32 v4, v4, v106
    v_mul_f32 v5, v5, v107
    v_cvt_pk_bf16_f32 v4, v4, v5
    v_and_b32 v5, 0xffff0000, v4
    v_lshlrev_b32 v4, 16, v4
    v_and_b32 v6, 0xffff0000, v149
    v_and_b32 v7, 0xffff0000, v153
    v_add_f32 v4, v4, v6
    v_add_f32 v5, v5, v7
    v_cvt_pk_bf16_f32 v189, v4, v5
    v_lshlrev_b32 v4, 16, v30
    v_and_b32 v5, 0xffff0000, v30
    v_mul_f32 v4, v4, v108
    v_mul_f32 v5, v5, v109
    v_cvt_pk_bf16_f32 v4, v4, v5
    v_and_b32 v5, 0xffff0000, v4
    v_lshlrev_b32 v4, 16, v4
    v_and_b32 v6, 0xffff0000, v157
    v_and_b32 v7, 0xffff0000, v161
    v_add_f32 v4, v4, v6
    v_add_f32 v5, v5, v7
    v_cvt_pk_bf16_f32 v190, v4, v5
    v_lshlrev_b32 v4, 16, v31
    v_and_b32 v5, 0xffff0000, v31
    v_mul_f32 v4, v4, v110
    v_mul_f32 v5, v5, v111
    v_cvt_pk_bf16_f32 v4, v4, v5
    v_and_b32 v5, 0xffff0000, v4
    v_lshlrev_b32 v4, 16, v4
    v_and_b32 v6, 0xffff0000, v165
    v_and_b32 v7, 0xffff0000, v169
    v_add_f32 v4, v4, v6
    v_add_f32 v5, v5, v7
    v_cvt_pk_bf16_f32 v191, v4, v5
    s_mov_b32 s53, 7680
    buffer_store_dwordx4 v[188:191], v2, s[16:19], s53 offen
    v_lshlrev_b32 v4, 16, v32
    v_and_b32 v5, 0xffff0000, v32
    v_mul_f32 v4, v4, v104
    v_mul_f32 v5, v5, v105
    v_cvt_pk_bf16_f32 v4, v4, v5
    v_and_b32 v5, 0xffff0000, v4
    v_lshlrev_b32 v4, 16, v4
    v_lshlrev_b32 v6, 16, v142
    v_lshlrev_b32 v7, 16, v146
    v_add_f32 v4, v4, v6
    v_add_f32 v5, v5, v7
    v_cvt_pk_bf16_f32 v176, v4, v5
    v_lshlrev_b32 v4, 16, v33
    v_and_b32 v5, 0xffff0000, v33
    v_mul_f32 v4, v4, v106
    v_mul_f32 v5, v5, v107
    v_cvt_pk_bf16_f32 v4, v4, v5
    v_and_b32 v5, 0xffff0000, v4
    v_lshlrev_b32 v4, 16, v4
    v_lshlrev_b32 v6, 16, v150
    v_lshlrev_b32 v7, 16, v154
    v_add_f32 v4, v4, v6
    v_add_f32 v5, v5, v7
    v_cvt_pk_bf16_f32 v177, v4, v5
    v_lshlrev_b32 v4, 16, v34
    v_and_b32 v5, 0xffff0000, v34
    v_mul_f32 v4, v4, v108
    v_mul_f32 v5, v5, v109
    v_cvt_pk_bf16_f32 v4, v4, v5
    v_and_b32 v5, 0xffff0000, v4
    v_lshlrev_b32 v4, 16, v4
    v_lshlrev_b32 v6, 16, v158
    v_lshlrev_b32 v7, 16, v162
    v_add_f32 v4, v4, v6
    v_add_f32 v5, v5, v7
    v_cvt_pk_bf16_f32 v178, v4, v5
    v_lshlrev_b32 v4, 16, v35
    v_and_b32 v5, 0xffff0000, v35
    v_mul_f32 v4, v4, v110
    v_mul_f32 v5, v5, v111
    v_cvt_pk_bf16_f32 v4, v4, v5
    v_and_b32 v5, 0xffff0000, v4
    v_lshlrev_b32 v4, 16, v4
    v_lshlrev_b32 v6, 16, v166
    v_lshlrev_b32 v7, 16, v170
    v_add_f32 v4, v4, v6
    v_add_f32 v5, v5, v7
    v_cvt_pk_bf16_f32 v179, v4, v5
    s_mov_b32 s53, 10240
    buffer_store_dwordx4 v[176:179], v2, s[16:19], s53 offen
    v_lshlrev_b32 v4, 16, v36
    v_and_b32 v5, 0xffff0000, v36
    v_mul_f32 v4, v4, v104
    v_mul_f32 v5, v5, v105
    v_cvt_pk_bf16_f32 v4, v4, v5
    v_and_b32 v5, 0xffff0000, v4
    v_lshlrev_b32 v4, 16, v4
    v_and_b32 v6, 0xffff0000, v142
    v_and_b32 v7, 0xffff0000, v146
    v_add_f32 v4, v4, v6
    v_add_f32 v5, v5, v7
    v_cvt_pk_bf16_f32 v180, v4, v5
    v_lshlrev_b32 v4, 16, v37
    v_and_b32 v5, 0xffff0000, v37
    v_mul_f32 v4, v4, v106
    v_mul_f32 v5, v5, v107
    v_cvt_pk_bf16_f32 v4, v4, v5
    v_and_b32 v5, 0xffff0000, v4
    v_lshlrev_b32 v4, 16, v4
    v_and_b32 v6, 0xffff0000, v150
    v_and_b32 v7, 0xffff0000, v154
    v_add_f32 v4, v4, v6
    v_add_f32 v5, v5, v7
    v_cvt_pk_bf16_f32 v181, v4, v5
    v_lshlrev_b32 v4, 16, v38
    v_and_b32 v5, 0xffff0000, v38
    v_mul_f32 v4, v4, v108
    v_mul_f32 v5, v5, v109
    v_cvt_pk_bf16_f32 v4, v4, v5
    v_and_b32 v5, 0xffff0000, v4
    v_lshlrev_b32 v4, 16, v4
    v_and_b32 v6, 0xffff0000, v158
    v_and_b32 v7, 0xffff0000, v162
    v_add_f32 v4, v4, v6
    v_add_f32 v5, v5, v7
    v_cvt_pk_bf16_f32 v182, v4, v5
    v_lshlrev_b32 v4, 16, v39
    v_and_b32 v5, 0xffff0000, v39
    v_mul_f32 v4, v4, v110
    v_mul_f32 v5, v5, v111
    v_cvt_pk_bf16_f32 v4, v4, v5
    v_and_b32 v5, 0xffff0000, v4
    v_lshlrev_b32 v4, 16, v4
    v_and_b32 v6, 0xffff0000, v166
    v_and_b32 v7, 0xffff0000, v170
    v_add_f32 v4, v4, v6
    v_add_f32 v5, v5, v7
    v_cvt_pk_bf16_f32 v183, v4, v5
    s_mov_b32 s53, 12800
    buffer_store_dwordx4 v[180:183], v2, s[16:19], s53 offen
    v_lshlrev_b32 v4, 16, v40
    v_and_b32 v5, 0xffff0000, v40
    v_mul_f32 v4, v4, v104
    v_mul_f32 v5, v5, v105
    v_cvt_pk_bf16_f32 v4, v4, v5
    v_and_b32 v5, 0xffff0000, v4
    v_lshlrev_b32 v4, 16, v4
    v_lshlrev_b32 v6, 16, v143
    v_lshlrev_b32 v7, 16, v147
    v_add_f32 v4, v4, v6
    v_add_f32 v5, v5, v7
    v_cvt_pk_bf16_f32 v184, v4, v5
    v_lshlrev_b32 v4, 16, v41
    v_and_b32 v5, 0xffff0000, v41
    v_mul_f32 v4, v4, v106
    v_mul_f32 v5, v5, v107
    v_cvt_pk_bf16_f32 v4, v4, v5
    v_and_b32 v5, 0xffff0000, v4
    v_lshlrev_b32 v4, 16, v4
    v_lshlrev_b32 v6, 16, v151
    v_lshlrev_b32 v7, 16, v155
    v_add_f32 v4, v4, v6
    v_add_f32 v5, v5, v7
    v_cvt_pk_bf16_f32 v185, v4, v5
    v_lshlrev_b32 v4, 16, v42
    v_and_b32 v5, 0xffff0000, v42
    v_mul_f32 v4, v4, v108
    v_mul_f32 v5, v5, v109
    v_cvt_pk_bf16_f32 v4, v4, v5
    v_and_b32 v5, 0xffff0000, v4
    v_lshlrev_b32 v4, 16, v4
    v_lshlrev_b32 v6, 16, v159
    v_lshlrev_b32 v7, 16, v163
    v_add_f32 v4, v4, v6
    v_add_f32 v5, v5, v7
    v_cvt_pk_bf16_f32 v186, v4, v5
    v_lshlrev_b32 v4, 16, v43
    v_and_b32 v5, 0xffff0000, v43
    v_mul_f32 v4, v4, v110
    v_mul_f32 v5, v5, v111
    v_cvt_pk_bf16_f32 v4, v4, v5
    v_and_b32 v5, 0xffff0000, v4
    v_lshlrev_b32 v4, 16, v4
    v_lshlrev_b32 v6, 16, v167
    v_lshlrev_b32 v7, 16, v171
    v_add_f32 v4, v4, v6
    v_add_f32 v5, v5, v7
    v_cvt_pk_bf16_f32 v187, v4, v5
    s_mov_b32 s53, 15360
    buffer_store_dwordx4 v[184:187], v2, s[16:19], s53 offen
    v_lshlrev_b32 v4, 16, v44
    v_and_b32 v5, 0xffff0000, v44
    v_mul_f32 v4, v4, v104
    v_mul_f32 v5, v5, v105
    v_cvt_pk_bf16_f32 v4, v4, v5
    v_and_b32 v5, 0xffff0000, v4
    v_lshlrev_b32 v4, 16, v4
    v_and_b32 v6, 0xffff0000, v143
    v_and_b32 v7, 0xffff0000, v147
    v_add_f32 v4, v4, v6
    v_add_f32 v5, v5, v7
    v_cvt_pk_bf16_f32 v188, v4, v5
    v_lshlrev_b32 v4, 16, v45
    v_and_b32 v5, 0xffff0000, v45
    v_mul_f32 v4, v4, v106
    v_mul_f32 v5, v5, v107
    v_cvt_pk_bf16_f32 v4, v4, v5
    v_and_b32 v5, 0xffff0000, v4
    v_lshlrev_b32 v4, 16, v4
    v_and_b32 v6, 0xffff0000, v151
    v_and_b32 v7, 0xffff0000, v155
    v_add_f32 v4, v4, v6
    v_add_f32 v5, v5, v7
    v_cvt_pk_bf16_f32 v189, v4, v5
    v_lshlrev_b32 v4, 16, v46
    v_and_b32 v5, 0xffff0000, v46
    v_mul_f32 v4, v4, v108
    v_mul_f32 v5, v5, v109
    v_cvt_pk_bf16_f32 v4, v4, v5
    v_and_b32 v5, 0xffff0000, v4
    v_lshlrev_b32 v4, 16, v4
    v_and_b32 v6, 0xffff0000, v159
    v_and_b32 v7, 0xffff0000, v163
    v_add_f32 v4, v4, v6
    v_add_f32 v5, v5, v7
    v_cvt_pk_bf16_f32 v190, v4, v5
    v_lshlrev_b32 v4, 16, v47
    v_and_b32 v5, 0xffff0000, v47
    v_mul_f32 v4, v4, v110
    v_mul_f32 v5, v5, v111
    v_cvt_pk_bf16_f32 v4, v4, v5
    v_and_b32 v5, 0xffff0000, v4
    v_lshlrev_b32 v4, 16, v4
    v_and_b32 v6, 0xffff0000, v167
    v_and_b32 v7, 0xffff0000, v171
    v_add_f32 v4, v4, v6
    v_add_f32 v5, v5, v7
    v_cvt_pk_bf16_f32 v191, v4, v5
    s_mov_b32 s53, 17920
    buffer_store_dwordx4 v[188:191], v2, s[16:19], s53 offen
    s_waitcnt vmcnt(0)
    s_branch L_oproj
L_attn:
    s_or_b32 s32, s4, s5
    s_cbranch_scc1 Lreg_14
    s_lshl_b32 s32, 1, s29
    s_mov_b32 s33, 0x100
    s_lshl_b32 s34, s28, 5
    s_waitcnt vmcnt(0)
    s_atomic_add_x2 s[32:33], s[6:7], s34
    s_waitcnt lgkmcnt(0)
Lreg_14:
    s_cmp_ge_u32 s29, 2
    s_cbranch_scc1 Lrace_15_out
    s_cmp_lg_u32 s5, 1
    s_cbranch_scc1 Lrace_15
    s_lshl_b32 s32, s29, 13
    s_add_u32 s32, s32, 65536
    v_mov_b32 v12, 0
    s_mov_b64 exec, 1
    s_mov_b32 s34, 0
Lrace_15_t:
    buffer_store_dword v12, v12, s[8:11], s32 offen offset:0 sc1
    s_waitcnt vmcnt(0)
    buffer_load_dword v10, v12, s[8:11], s32 offen offset:0 sc1
    s_xor_b32 s32, s32, 4096
    s_waitcnt vmcnt(0)
    buffer_store_dword v12, v12, s[8:11], s32 offen offset:2048 sc1
    s_waitcnt vmcnt(0)
    buffer_load_dword v10, v12, s[8:11], s32 offen offset:2048 sc1
    s_xor_b32 s32, s32, 4096
    s_waitcnt vmcnt(0)
    s_add_u32 s34, s34, 1
    s_cmp_lg_u32 s34, 1
    s_cbranch_scc1 Lrace_15_n
    s_atomic_add s34, s[6:7], 144
    s_mov_b32 s30, 12
Lrace_15_h:
    s_load_dword s33, s[6:7], 144 glc
    s_sub_u32 s30, s30, 1
    s_waitcnt lgkmcnt(0)
    s_cbranch_scc1 Lrace_15_t
    s_cmp_lt_u32 s33, 2
    s_cbranch_scc1 Lrace_15_h
Lrace_15_n:
    s_cmp_le_u32 s34, 2
    s_cbranch_scc1 Lrace_15_t
    s_add_u32 s32, s29, 1
    v_mov_b32 v10, s32
    v_mov_b32 v11, 0
    v_mov_b32 v12, 16
    global_atomic_cmpswap v12, v[10:11], s[6:7]
    s_mov_b64 exec, -1
Lrace_15:
    s_barrier
Lrace_15_out:
    s_mov_b64 s[12:13], s[88:89]
    s_mov_b32 s14, 5242880
    s_mov_b32 s15, 0x20000
    s_mov_b64 s[16:17], s[78:79]
    s_mov_b32 s18, 2621440
    s_mov_b32 s19, 0x20000
    s_cmp_lt_u32 s29, 3
    s_cbranch_scc1 L_warm_done
    s_sub_u32 s32, s29, 3
    s_lshl_b32 s32, s32, 15
    v_lshl_add_u32 v10, v0, 7, s32
    s_waitcnt lgkmcnt(0)
    s_mov_b32 s32, 0
    buffer_load_dword v11, v10, s[12:15], s32 offen
    s_mov_b32 s32, 425984
    buffer_load_dword v11, v10, s[12:15], s32 offen
    s_mov_b32 s32, 851968
    buffer_load_dword v11, v10, s[12:15], s32 offen
    s_mov_b32 s32, 1277952
    buffer_load_dword v11, v10, s[12:15], s32 offen
    s_mov_b32 s32, 1703936
    buffer_load_dword v11, v10, s[12:15], s32 offen
    s_mov_b32 s32, 2129920
    buffer_load_dword v11, v10, s[12:15], s32 offen
    s_mov_b32 s32, 2555904
    buffer_load_dword v11, v10, s[12:15], s32 offen
    s_mov_b32 s32, 2981888
    buffer_load_dword v11, v10, s[12:15], s32 offen
    s_mov_b32 s32, 3407872
    buffer_load_dword v11, v10, s[12:15], s32 offen
    s_mov_b32 s32, 3833856
    buffer_load_dword v11, v10, s[12:15], s32 offen
    s_mov_b32 s32, 4259840
    buffer_load_dword v11, v10, s[12:15], s32 offen
    s_mov_b32 s32, 4685824
    buffer_load_dword v11, v10, s[12:15], s32 offen
    s_mov_b32 s32, 5111808
    buffer_load_dword v11, v10, s[12:15], s32 offen
    s_mov_b32 s32, 0
    buffer_load_dword v11, v10, s[16:19], s32 offen
    s_mov_b32 s32, 425984
    buffer_load_dword v11, v10, s[16:19], s32 offen
    s_mov_b32 s32, 851968
    buffer_load_dword v11, v10, s[16:19], s32 offen
    s_mov_b32 s32, 1277952
    buffer_load_dword v11, v10, s[16:19], s32 offen
    s_mov_b32 s32, 1703936
    buffer_load_dword v11, v10, s[16:19], s32 offen
    s_mov_b32 s32, 2129920
    buffer_load_dword v11, v10, s[16:19], s32 offen
    s_mov_b32 s32, 2555904
    buffer_load_dword v11, v10, s[16:19], s32 offen
L_warm_done:
    s_waitcnt lgkmcnt(0)
    s_cmp_lg_u32 s4, 0
    s_cbranch_scc1 Lverd_16_ok
    v_and_b32 v12, 7, v1
    v_lshlrev_b32 v12, 5, v12
    s_mov_b32 s30, 131072
Lverd_16:
    global_load_dwordx2 v[10:11], v12, s[6:7] sc1
    s_sub_u32 s30, s30, 1
    s_cbranch_scc1 L_abort
    s_mov_b32 s32, 0x2000
    s_waitcnt vmcnt(0)
    v_cmp_ne_u32 vcc, -1, v10
    v_cmp_ne_u32 s[34:35], s32, v11
    s_nop 0
    s_or_b64 vcc, vcc, s[34:35]
    s_cbranch_scc0 Lverd_16_ok
    v_lshrrev_b32 v11, 8, v11
    s_mov_b32 s32, 0
    v_readlane_b32 s33, v11, 0
    s_nop 0
    s_add_u32 s32, s32, s33
    v_readlane_b32 s33, v11, 1
    s_nop 0
    s_add_u32 s32, s32, s33
    v_readlane_b32 s33, v11, 2
    s_nop 0
    s_add_u32 s32, s32, s33
    v_readlane_b32 s33, v11, 3
    s_nop 0
    s_add_u32 s32, s32, s33
    v_readlane_b32 s33, v11, 4
    s_nop 0
    s_add_u32 s32, s32, s33
    v_readlane_b32 s33, v11, 5
    s_nop 0
    s_add_u32 s32, s32, s33
    v_readlane_b32 s33, v11, 6
    s_nop 0
    s_add_u32 s32, s32, s33
    v_readlane_b32 s33, v11, 7
    s_nop 0
    s_add_u32 s32, s32, s33
    s_cmp_eq_u32 s32, 256
    s_cbranch_scc1 L_restart_safe
    s_sleep 8
    s_branch Lverd_16
Lverd_16_ok:
    s_mov_b64 s[12:13], s[80:81]
    s_mov_b32 s14, 10240
    s_mov_b32 s15, 0x20000
    s_lshl_b32 s37, s29, 2
    s_add_u32 s37, s37, s5
    s_cmp_ge_u32 s37, 10
    s_cbranch_scc1 L_pm0_done
    s_cmp_ge_u32 s37, 5
    s_cselect_b32 s34, 1, 0
    s_mul_i32 s35, s34, 5
    s_sub_u32 s35, s37, s35
    v_bfe_u32 v12, v1, 2, 2
    v_and_b32 v13, 1, v1
    v_lshl_add_u32 v12, v12, 1, v13
    v_mul_u32_u24 v12, 1280, v12
    v_lshrrev_b32 v13, 4, v1
    v_bfe_u32 v14, v1, 1, 1
    v_lshl_add_u32 v13, v13, 1, v14
    s_lshl_b32 s36, s37, 7
    s_waitcnt lgkmcnt(0)
    s_cmp_eq_u32 s35, 4
    s_cbranch_scc1 L_pm0_4
    v_lshl_add_u32 v12, v13, 2, v12
    buffer_load_ushort v20, v12, s[12:15], s36 offen offset:0
    buffer_load_ushort v21, v12, s[12:15], s36 offen offset:32
    buffer_load_ushort v22, v12, s[12:15], s36 offen offset:64
    buffer_load_ushort v23, v12, s[12:15], s36 offen offset:96
    buffer_load_ushort v24, v12, s[12:15], s36 offen offset:2
    buffer_load_ushort v25, v12, s[12:15], s36 offen offset:34
    buffer_load_ushort v26, v12, s[12:15], s36 offen offset:66
    buffer_load_ushort v27, v12, s[12:15], s36 offen offset:98
    s_waitcnt vmcnt(0)
    v_lshl_or_b32 v16, v21, 16, v20
    v_lshl_or_b32 v17, v23, 16, v22
    v_lshl_or_b32 v18, v25, 16, v24
    v_lshl_or_b32 v19, v27, 16, v26
    s_branch L_pm0_st
L_pm0_4:
    v_lshl_add_u32 v12, v13, 4, v12
    buffer_load_dwordx4 v[16:19], v12, s[12:15], s36 offen
L_pm0_st:
    s_mov_b32 s30, 131072
    v_mov_b32 v12, 16
Lpol_17:
    global_load_dword v13, v12, s[6:7] sc1
    s_sub_u32 s30, s30, 1
    s_cbranch_scc1 L_abort
    s_waitcnt vmcnt(0)
    v_readfirstlane_b32 s32, v13
    s_nop 0
    s_cmp_lg_u32 s32, 0
    s_cbranch_scc1 Lpol_17_ok
    s_sleep 4
    s_branch Lpol_17
Lpol_17_ok:
    s_and_b32 s32, s32, 2
    s_lshl_b32 s32, s32, 12
    v_or_b32 v16, 1, v16
    v_lshlrev_b32 v12, 4, v1
    s_lshl_b32 s36, s37, 10
    s_add_u32 s36, s36, 81920
    buffer_store_dwordx4 v[16:19], v12, s[8:11], s36 offen sc1
    s_lshl_b32 s34, s34, 14
    s_lshl_b32 s35, s35, 10
    s_add_u32 s34, s34, s35
    s_xor_b32 s32, s32, 0
    s_add_u32 s34, s34, s32
    s_add_u32 s34, s34, 0
    buffer_store_dwordx4 v[16:19], v12, s[8:11], s34 offen sc1
L_pm0_done:
    s_waitcnt lgkmcnt(0)
    s_mov_b32 s30, 131072
    v_mov_b32 v12, 16
Lpol_18:
    global_load_dword v13, v12, s[6:7] sc1
    s_sub_u32 s30, s30, 1
    s_cbranch_scc1 L_abort
    s_waitcnt vmcnt(0)
    v_readfirstlane_b32 s58, v13
    s_nop 0
    s_cmp_lg_u32 s58, 0
    s_cbranch_scc1 Lpol_18_ok
    s_sleep 4
    s_branch Lpol_18
Lpol_18_ok:
    s_and_b32 s58, s58, 2
    s_lshl_b32 s58, s58, 12
    s_lshr_b32 s32, s5, 1
    s_lshl_b32 s48, s29, 1
    s_add_u32 s48, s48, s32
    s_and_b32 s49, s5, 1
    v_lshlrev_b32 v2, 4, v1
    v_and_b32 v8, 15, v1
    v_lshrrev_b32 v9, 4, v1
    s_lshl_b32 s32, s48, 7
    s_add_u32 s68, s32, 94208
    s_add_u32 s69, s32, 98304
    v_and_b32 v10, 1, v1
    s_lshl_b32 s33, s49, 12
    s_add_u32 s32, s32, s33
    s_add_u32 s70, s32, 114688
    s_add_u32 s70, s70, s58
    s_add_u32 s69, s69, s58
    s_mov_b32 s71, 1
    v_lshrrev_b32 v11, 3, v8
    v_lshlrev_b32 v5, 17, v11
    v_lshrrev_b32 v11, 1, v9
    v_lshl_add_u32 v5, v11, 8, v5
    v_bfe_u32 v11, v8, 1, 2
    v_lshl_add_u32 v5, v11, 6, v5
    v_and_b32 v11, 1, v9
    v_lshl_add_u32 v5, v11, 5, v5
    v_lshl_add_u32 v5, v10, 4, v5
    v_mov_b32 v7, 0x4444
    v_mov_b32 v11, 0xeeee
    v_and_b32 v12, 2, v1
    v_cmp_eq_u32 vcc, 2, v12
    s_nop 1
    v_cndmask_b32 v7, v7, v11, vcc
    v_lshlrev_b32 v11, 2, v9
    v_cmp_gt_u32 s[60:61], v11, v8
    v_add_u32 v11, 1, v11
    v_mov_b32 v16, 0x3f803f80
    v_cmp_gt_u32 s[62:63], v11, v8
    v_add_u32 v11, 1, v11
    v_mov_b32 v17, 0x3f803f80
    v_cmp_gt_u32 s[64:65], v11, v8
    v_add_u32 v11, 1, v11
    v_mov_b32 v18, 0x3f803f80
    v_cmp_gt_u32 s[66:67], v11, v8
    v_add_u32 v11, 1, v11
    v_mov_b32 v19, 0x3f803f80
    v_mov_b32 v20, 3492320863
    v_mov_b32 v24, 0x3f003f00
    v_mov_b32 v25, 0x3f003f00
    s_mov_b32 s50, 0
    s_mov_b32 s51, 0
    s_mov_b32 s54, 1040356334
    s_lshl_b32 s53, s49, 5
    s_add_u32 s53, s53, s48
    s_lshl_b32 s53, s53, 14
    s_lshl_b32 s32, s49, 11
    s_xor_b32 s32, s32, s58
    s_and_b32 s32, s32, 8192
    s_add_u32 s53, s53, s32
    s_xor_b32 s56, s53, 8192
    s_add_u32 s80, s49, 1
    s_cmp_ge_u32 s50, s80
    s_cbranch_scc1 Lsf_19_ok
    s_mov_b32 s30, 131072
Lsf_19:
    s_load_dwordx8 s[72:79], s[8:9], s68 glc
    s_sub_u32 s30, s30, 1
    s_cbranch_scc1 L_abort
    s_waitcnt lgkmcnt(0)
    s_min_u32 s50, s72, s74
    s_min_u32 s50, s50, s76
    s_cmp_ge_u32 s50, s80
    s_cbranch_scc1 Lsf_19_ok
    s_sleep 4
    s_branch Lsf_19
Lsf_19_ok:
    s_add_u32 s55, s56, 4194304
    buffer_load_dwordx4 v[32:35], v2, s[8:11], s55 offen offset:0 sc1
    buffer_load_dwordx4 v[36:39], v2, s[8:11], s55 offen offset:1024 sc1
    buffer_load_dwordx4 v[40:43], v2, s[8:11], s55 offen offset:2048 sc1
    buffer_load_dwordx4 v[44:47], v2, s[8:11], s55 offen offset:3072 sc1
    s_add_u32 s55, s56, 4198400
    buffer_load_dwordx4 v[48:51], v2, s[8:11], s55 offen offset:0 sc1
    buffer_load_dwordx4 v[52:55], v2, s[8:11], s55 offen offset:1024 sc1
    buffer_load_dwordx4 v[56:59], v2, s[8:11], s55 offen offset:2048 sc1
    buffer_load_dwordx4 v[60:63], v2, s[8:11], s55 offen offset:3072 sc1
    s_add_u32 s55, s53, 4194304
    buffer_load_dwordx4 v[64:67], v2, s[8:11], s55 offen offset:0 sc1
    buffer_load_dwordx4 v[68:71], v2, s[8:11], s55 offen offset:1024 sc1
    buffer_load_dwordx4 v[72:75], v2, s[8:11], s55 offen offset:2048 sc1
    buffer_load_dwordx4 v[76:79], v2, s[8:11], s55 offen offset:3072 sc1
    s_add_u32 s55, s53, 4198400
    buffer_load_dwordx4 v[80:83], v2, s[8:11], s55 offen offset:0 sc1
    buffer_load_dwordx4 v[84:87], v2, s[8:11], s55 offen offset:1024 sc1
    buffer_load_dwordx4 v[88:91], v2, s[8:11], s55 offen offset:2048 sc1
    buffer_load_dwordx4 v[92:95], v2, s[8:11], s55 offen offset:3072 sc1
    s_add_u32 s55, s53, 37748736
    buffer_load_dwordx4 v[96:99], v2, s[8:11], s55 offen offset:0 sc1
    buffer_load_dwordx4 v[100:103], v2, s[8:11], s55 offen offset:1024 sc1
    buffer_load_dwordx4 v[104:107], v2, s[8:11], s55 offen offset:2048 sc1
    buffer_load_dwordx4 v[108:111], v2, s[8:11], s55 offen offset:3072 sc1
    s_add_u32 s55, s53, 37752832
    buffer_load_dwordx4 v[112:115], v2, s[8:11], s55 offen offset:0 sc1
    buffer_load_dwordx4 v[116:119], v2, s[8:11], s55 offen offset:1024 sc1
    buffer_load_dwordx4 v[120:123], v2, s[8:11], s55 offen offset:2048 sc1
    buffer_load_dwordx4 v[124:127], v2, s[8:11], s55 offen offset:3072 sc1
L_attn_v:
    s_add_u32 s52, s49, 1
    s_lshl_b32 s57, s49, 5
    s_lshr_b32 s32, s48, 2
    s_add_u32 s57, s57, s32
    s_lshl_b32 s57, s57, 3
    s_and_b32 s32, s48, 3
    s_add_u32 s57, s57, s32
    s_lshl_b32 s57, s57, 11
    s_lshl_b32 s32, s49, 11
    s_xor_b32 s32, s32, s58
    s_and_b32 s32, s32, 8192
    s_add_u32 s57, s57, s32
    s_add_u32 s57, s57, 104857600
    s_waitcnt vmcnt(0)
    s_add_u32 s59, s49, 2
    s_cmp_ge_u32 s59, 64
    s_cbranch_scc1 L_attn_nf_v
    s_lshl_b32 s53, s59, 5
    s_add_u32 s53, s53, s48
    s_lshl_b32 s53, s53, 14
    s_lshl_b32 s32, s59, 11
    s_xor_b32 s32, s32, s58
    s_and_b32 s32, s32, 8192
    s_add_u32 s53, s53, s32
    s_xor_b32 s56, s53, 8192
    s_add_u32 s80, s59, 1
    s_cmp_ge_u32 s50, s80
    s_cbranch_scc1 Lsf_20_ok
    s_mov_b32 s30, 131072
Lsf_20:
    s_load_dwordx8 s[72:79], s[8:9], s68 glc
    s_sub_u32 s30, s30, 1
    s_cbranch_scc1 L_abort
    s_waitcnt lgkmcnt(0)
    s_min_u32 s50, s72, s74
    s_min_u32 s50, s50, s76
    s_cmp_ge_u32 s50, s80
    s_cbranch_scc1 Lsf_20_ok
    s_sleep 4
    s_branch Lsf_20
Lsf_20_ok:
    s_add_u32 s55, s56, 4194304
    buffer_load_dwordx4 a[32:35], v2, s[8:11], s55 offen offset:0 sc1
    buffer_load_dwordx4 a[36:39], v2, s[8:11], s55 offen offset:1024 sc1
    buffer_load_dwordx4 a[40:43], v2, s[8:11], s55 offen offset:2048 sc1
    buffer_load_dwordx4 a[44:47], v2, s[8:11], s55 offen offset:3072 sc1
    s_add_u32 s55, s56, 4198400
    buffer_load_dwordx4 a[48:51], v2, s[8:11], s55 offen offset:0 sc1
    buffer_load_dwordx4 a[52:55], v2, s[8:11], s55 offen offset:1024 sc1
    buffer_load_dwordx4 a[56:59], v2, s[8:11], s55 offen offset:2048 sc1
    buffer_load_dwordx4 a[60:63], v2, s[8:11], s55 offen offset:3072 sc1
    s_add_u32 s55, s53, 4194304
    buffer_load_dwordx4 a[64:67], v2, s[8:11], s55 offen offset:0 sc1
    buffer_load_dwordx4 a[68:71], v2, s[8:11], s55 offen offset:1024 sc1
    buffer_load_dwordx4 a[72:75], v2, s[8:11], s55 offen offset:2048 sc1
    buffer_load_dwordx4 a[76:79], v2, s[8:11], s55 offen offset:3072 sc1
    s_add_u32 s55, s53, 4198400
    buffer_load_dwordx4 a[80:83], v2, s[8:11], s55 offen offset:0 sc1
    buffer_load_dwordx4 a[84:87], v2, s[8:11], s55 offen offset:1024 sc1
    buffer_load_dwordx4 a[88:91], v2, s[8:11], s55 offen offset:2048 sc1
    buffer_load_dwordx4 a[92:95], v2, s[8:11], s55 offen offset:3072 sc1
    s_add_u32 s55, s53, 37748736
    buffer_load_dwordx4 a[96:99], v2, s[8:11], s55 offen offset:0 sc1
    buffer_load_dwordx4 a[100:103], v2, s[8:11], s55 offen offset:1024 sc1
    buffer_load_dwordx4 a[104:107], v2, s[8:11], s55 offen offset:2048 sc1
    buffer_load_dwordx4 a[108:111], v2, s[8:11], s55 offen offset:3072 sc1
    s_add_u32 s55, s53, 37752832
    buffer_load_dwordx4 a[112:115], v2, s[8:11], s55 offen offset:0 sc1
    buffer_load_dwordx4 a[116:119], v2, s[8:11], s55 offen offset:1024 sc1
    buffer_load_dwordx4 a[120:123], v2, s[8:11], s55 offen offset:2048 sc1
    buffer_load_dwordx4 a[124:127], v2, s[8:11], s55 offen offset:3072 sc1
L_attn_nf_v:
    s_lshl_b32 s53, s49, 5
    s_add_u32 s53, s53, s48
    s_lshl_b32 s53, s53, 14
    s_lshl_b32 s32, s49, 11
    s_xor_b32 s32, s32, s58
    s_and_b32 s32, s32, 8192
    s_add_u32 s53, s53, s32
    s_xor_b32 s56, s53, 8192
    v_mfma_f32_16x16x32_bf16 v[144:147], v[64:67], v[32:35], 0
    v_mfma_f32_16x16x32_bf16 v[156:159], v[64:67], v[48:51], 0
    v_mfma_f32_16x16x32_bf16 v[160:163], v[80:83], v[48:51], 0
    v_mfma_f32_16x16x32_bf16 v[144:147], v[68:71], v[36:39], v[144:147]
    v_mfma_f32_16x16x32_bf16 v[156:159], v[68:71], v[52:55], v[156:159]
    v_mfma_f32_16x16x32_bf16 v[160:163], v[84:87], v[52:55], v[160:163]
    v_mfma_f32_16x16x32_bf16 v[144:147], v[72:75], v[40:43], v[144:147]
    v_mfma_f32_16x16x32_bf16 v[156:159], v[72:75], v[56:59], v[156:159]
    v_mfma_f32_16x16x32_bf16 v[160:163], v[88:91], v[56:59], v[160:163]
    v_mfma_f32_16x16x32_bf16 v[144:147], v[76:79], v[44:47], v[144:147]
    v_mfma_f32_16x16x32_bf16 v[156:159], v[76:79], v[60:63], v[156:159]
    v_mfma_f32_16x16x32_bf16 v[160:163], v[92:95], v[60:63], v[160:163]
    v_mov_b64 v[152:153], 0
    v_mov_b64 v[154:155], 0
    v_mov_b64 v[164:165], 0
    v_mov_b64 v[166:167], 0
    v_cndmask_b32 v144, v144, v20, s[60:61]
    v_cndmask_b32 v145, v145, v20, s[62:63]
    v_cndmask_b32 v146, v146, v20, s[64:65]
    v_cndmask_b32 v147, v147, v20, s[66:67]
    v_cndmask_b32 v160, v160, v20, s[60:61]
    v_cndmask_b32 v161, v161, v20, s[62:63]
    v_cndmask_b32 v162, v162, v20, s[64:65]
    v_cndmask_b32 v163, v163, v20, s[66:67]
    v_max3_f32 v10, v144, v145, v146
    v_max_f32 v10, v10, v147
    v_max3_f32 v11, v156, v157, v158
    v_max_f32 v11, v11, v159
    v_max3_f32 v11, v11, v160, v161
    v_max3_f32 v11, v11, v162, v163
    s_cmp_ge_u32 s51, s52
    s_cbranch_scc1 Lsf_21_ok
    s_mov_b32 s30, 131072
Lsf_21:
    s_load_dwordx2 s[72:73], s[8:9], s69 glc
    s_sub_u32 s30, s30, 1
    s_cbranch_scc1 L_abort
    s_waitcnt lgkmcnt(0)
    s_min_u32 s51, s72, s73
    s_cmp_ge_u32 s51, s52
    s_cbranch_scc1 Lsf_21_ok
    s_branch Lsf_21
Lsf_21_ok:
    s_add_u32 s55, s53, 71303168
    buffer_load_dwordx4 v[208:211], v2, s[8:11], s55 offen offset:0 sc1
    buffer_load_dwordx4 v[216:219], v2, s[8:11], s55 offen offset:1024 sc1
    buffer_load_dwordx4 v[224:227], v2, s[8:11], s55 offen offset:2048 sc1
    buffer_load_dwordx4 v[232:235], v2, s[8:11], s55 offen offset:3072 sc1
    s_add_u32 s55, s53, 71307264
    buffer_load_dwordx4 v[212:215], v2, s[8:11], s55 offen offset:0 sc1
    buffer_load_dwordx4 v[220:223], v2, s[8:11], s55 offen offset:1024 sc1
    buffer_load_dwordx4 v[228:231], v2, s[8:11], s55 offen offset:2048 sc1
    buffer_load_dwordx4 v[236:239], v2, s[8:11], s55 offen offset:3072 sc1
    s_waitcnt vmcnt(4)
    v_mov_b32 v128, v210
    v_mov_b32 v129, v218
    v_mov_b32 v130, v226
    v_mov_b32 v131, v234
    s_nop 1
    v_smfmac_f32_16x16x64_bf16 v[152:155], v[128:131], v[32:39], v7
    v_smfmac_f32_16x16x64_bf16 v[164:167], v[128:131], v[48:55], v7
    s_waitcnt vmcnt(0)
    v_mov_b32 v132, v214
    v_mov_b32 v133, v222
    v_mov_b32 v134, v230
    v_mov_b32 v135, v238
    s_nop 1
    v_smfmac_f32_16x16x64_bf16 v[152:155], v[132:135], v[40:47], v7
    v_smfmac_f32_16x16x64_bf16 v[164:167], v[132:135], v[56:63], v7
    v_swap_b32 v209, v212
    v_swap_b32 v217, v220
    v_swap_b32 v225, v228
    v_swap_b32 v233, v236
    v_add_f32 v152, v152, v154
    v_add_f32 v153, v153, v155
    v_max3_f32 v154, v10, v152, v153
    v_max3_f32 v155, v10, v152, v153
    v_add_f32 v164, v164, v166
    v_add_f32 v165, v165, v167
    v_max3_f32 v166, v11, v164, v165
    v_max3_f32 v167, v11, v164, v165
    v_permlane32_swap_b32 v154, v155
    v_max_f32 v8, v154, v155
    v_max_f32 v154, v154, v155
    v_permlane32_swap_b32 v166, v167
    v_max_f32 v9, v166, v167
    v_max_f32 v166, v166, v167
    v_permlane16_swap_b32 v8, v154
    v_max_f32 v8, v8, v154
    v_mul_f32 v8, s54, v8
    v_permlane16_swap_b32 v9, v166
    v_max_f32 v9, v9, v166
    v_mul_f32 v9, s54, v9
    v_fma_f32 v144, v144, s54, -v8
    v_fma_f32 v145, v145, s54, -v8
    v_fma_f32 v146, v146, s54, -v8
    v_fma_f32 v147, v147, s54, -v8
    v_fma_f32 v152, v152, s54, -v8
    v_fma_f32 v153, v153, s54, -v8
    v_exp_f32 v144, v144
    v_exp_f32 v145, v145
    v_exp_f32 v146, v146
    v_exp_f32 v147, v147
    v_exp_f32 v152, v152
    v_exp_f32 v153, v153
    v_cvt_pk_bf16_f32 v144, v144, v145
    v_cvt_pk_bf16_f32 v145, v146, v147
    v_mov_b64 v[146:147], 0
    v_cvt_pk_bf16_f32 v154, v152, v153
    v_cvt_pk_bf16_f32 v155, v152, v153
    v_mfma_f32_16x16x32_bf16 v[168:171], v[16:19], v[144:147], 0
    v_fma_f32 v156, v156, s54, -v9
    v_fma_f32 v157, v157, s54, -v9
    v_mfma_f32_16x16x32_bf16 v[176:179], v[96:99], v[144:147], 0
    v_fma_f32 v158, v158, s54, -v9
    v_fma_f32 v159, v159, s54, -v9
    v_mfma_f32_16x16x32_bf16 v[180:183], v[100:103], v[144:147], 0
    v_fma_f32 v160, v160, s54, -v9
    v_fma_f32 v161, v161, s54, -v9
    v_mfma_f32_16x16x32_bf16 v[184:187], v[104:107], v[144:147], 0
    v_fma_f32 v162, v162, s54, -v9
    v_fma_f32 v163, v163, s54, -v9
    v_mfma_f32_16x16x32_bf16 v[188:191], v[108:111], v[144:147], 0
    v_fma_f32 v164, v164, s54, -v9
    v_fma_f32 v165, v165, s54, -v9
    v_mfma_f32_16x16x32_bf16 v[192:195], v[112:115], v[144:147], 0
    v_exp_f32 v156, v156
    v_mfma_f32_16x16x32_bf16 v[196:199], v[116:119], v[144:147], 0
    v_exp_f32 v157, v157
    v_mfma_f32_16x16x32_bf16 v[200:203], v[120:123], v[144:147], 0
    v_exp_f32 v158, v158
    v_mfma_f32_16x16x32_bf16 v[204:207], v[124:127], v[144:147], 0
    v_exp_f32 v159, v159
    v_mfma_f32_16x16x16_bf16 v[168:171], v[24:25], v[154:155], v[168:171]
    v_exp_f32 v160, v160
    v_mfma_f32_16x16x16_bf16 v[176:179], v[208:209], v[154:155], v[176:179]
    v_exp_f32 v161, v161
    v_mfma_f32_16x16x16_bf16 v[180:183], v[212:213], v[154:155], v[180:183]
    v_exp_f32 v162, v162
    v_mfma_f32_16x16x16_bf16 v[184:187], v[216:217], v[154:155], v[184:187]
    v_exp_f32 v163, v163
    v_mfma_f32_16x16x16_bf16 v[188:191], v[220:221], v[154:155], v[188:191]
    v_exp_f32 v164, v164
    v_mfma_f32_16x16x16_bf16 v[192:195], v[224:225], v[154:155], v[192:195]
    v_exp_f32 v165, v165
    v_mfma_f32_16x16x16_bf16 v[196:199], v[228:229], v[154:155], v[196:199]
    v_cvt_pk_bf16_f32 v156, v156, v157
    v_cvt_pk_bf16_f32 v157, v158, v159
    v_mfma_f32_16x16x16_bf16 v[200:203], v[232:233], v[154:155], v[200:203]
    v_cvt_pk_bf16_f32 v158, v160, v161
    v_cvt_pk_bf16_f32 v159, v162, v163
    v_mfma_f32_16x16x16_bf16 v[204:207], v[236:237], v[154:155], v[204:207]
    v_cvt_pk_bf16_f32 v166, v164, v165
    v_cvt_pk_bf16_f32 v167, v164, v165
    v_rcp_f32 v168, v168
    s_nop 0
    v_pk_mul_f32 v[176:177], v[176:177], v[168:169] op_sel_hi:[1,0]
    v_pk_mul_f32 v[178:179], v[178:179], v[168:169] op_sel_hi:[1,0]
    v_pk_mul_f32 v[180:181], v[180:181], v[168:169] op_sel_hi:[1,0]
    v_pk_mul_f32 v[182:183], v[182:183], v[168:169] op_sel_hi:[1,0]
    v_cvt_pk_bf16_f32 v240, v176, v177
    v_cvt_pk_bf16_f32 v241, v178, v179
    v_cvt_pk_bf16_f32 v242, v180, v181
    v_cvt_pk_bf16_f32 v243, v182, v183
    buffer_store_dwordx4 v[240:243], v5, s[8:11], s57 offen offset:0 sc1
    v_pk_mul_f32 v[184:185], v[184:185], v[168:169] op_sel_hi:[1,0]
    v_pk_mul_f32 v[186:187], v[186:187], v[168:169] op_sel_hi:[1,0]
    v_pk_mul_f32 v[188:189], v[188:189], v[168:169] op_sel_hi:[1,0]
    v_pk_mul_f32 v[190:191], v[190:191], v[168:169] op_sel_hi:[1,0]
    v_cvt_pk_bf16_f32 v244, v184, v185
    v_cvt_pk_bf16_f32 v245, v186, v187
    v_cvt_pk_bf16_f32 v246, v188, v189
    v_cvt_pk_bf16_f32 v247, v190, v191
    buffer_store_dwordx4 v[244:247], v5, s[8:11], s57 offen offset:512 sc1
    v_pk_mul_f32 v[192:193], v[192:193], v[168:169] op_sel_hi:[1,0]
    v_pk_mul_f32 v[194:195], v[194:195], v[168:169] op_sel_hi:[1,0]
    v_pk_mul_f32 v[196:197], v[196:197], v[168:169] op_sel_hi:[1,0]
    v_pk_mul_f32 v[198:199], v[198:199], v[168:169] op_sel_hi:[1,0]
    v_cvt_pk_bf16_f32 v248, v192, v193
    v_cvt_pk_bf16_f32 v249, v194, v195
    v_cvt_pk_bf16_f32 v250, v196, v197
    v_cvt_pk_bf16_f32 v251, v198, v199
    buffer_store_dwordx4 v[248:251], v5, s[8:11], s57 offen offset:1024 sc1
    v_pk_mul_f32 v[200:201], v[200:201], v[168:169] op_sel_hi:[1,0]
    v_pk_mul_f32 v[202:203], v[202:203], v[168:169] op_sel_hi:[1,0]
    v_pk_mul_f32 v[204:205], v[204:205], v[168:169] op_sel_hi:[1,0]
    v_pk_mul_f32 v[206:207], v[206:207], v[168:169] op_sel_hi:[1,0]
    v_cvt_pk_bf16_f32 v252, v200, v201
    v_cvt_pk_bf16_f32 v253, v202, v203
    v_cvt_pk_bf16_f32 v254, v204, v205
    v_cvt_pk_bf16_f32 v255, v206, v207
    buffer_store_dwordx4 v[252:255], v5, s[8:11], s57 offen offset:1536 sc1
    v_mfma_f32_16x16x32_bf16 v[172:175], v[16:19], v[156:159], 0
    v_mfma_f32_16x16x32_bf16 v[176:179], v[96:99], v[156:159], 0
    v_mfma_f32_16x16x32_bf16 v[180:183], v[100:103], v[156:159], 0
    v_mfma_f32_16x16x32_bf16 v[184:187], v[104:107], v[156:159], 0
    v_mfma_f32_16x16x32_bf16 v[188:191], v[108:111], v[156:159], 0
    v_mfma_f32_16x16x32_bf16 v[192:195], v[112:115], v[156:159], 0
    v_mfma_f32_16x16x32_bf16 v[196:199], v[116:119], v[156:159], 0
    v_mfma_f32_16x16x32_bf16 v[200:203], v[120:123], v[156:159], 0
    v_mfma_f32_16x16x32_bf16 v[204:207], v[124:127], v[156:159], 0
    v_mfma_f32_16x16x16_bf16 v[172:175], v[24:25], v[166:167], v[172:175]
    v_mfma_f32_16x16x16_bf16 v[176:179], v[208:209], v[166:167], v[176:179]
    v_mfma_f32_16x16x16_bf16 v[180:183], v[212:213], v[166:167], v[180:183]
    v_mfma_f32_16x16x16_bf16 v[184:187], v[216:217], v[166:167], v[184:187]
    v_mfma_f32_16x16x16_bf16 v[188:191], v[220:221], v[166:167], v[188:191]
    v_mfma_f32_16x16x16_bf16 v[192:195], v[224:225], v[166:167], v[192:195]
    v_mfma_f32_16x16x16_bf16 v[196:199], v[228:229], v[166:167], v[196:199]
    v_mfma_f32_16x16x16_bf16 v[200:203], v[232:233], v[166:167], v[200:203]
    v_mfma_f32_16x16x16_bf16 v[204:207], v[236:237], v[166:167], v[204:207]
    s_add_u32 s57, s57, 262144
    v_rcp_f32 v172, v172
    s_nop 0
    v_pk_mul_f32 v[176:177], v[176:177], v[172:173] op_sel_hi:[1,0]
    v_pk_mul_f32 v[178:179], v[178:179], v[172:173] op_sel_hi:[1,0]
    v_pk_mul_f32 v[180:181], v[180:181], v[172:173] op_sel_hi:[1,0]
    v_pk_mul_f32 v[182:183], v[182:183], v[172:173] op_sel_hi:[1,0]
    v_cvt_pk_bf16_f32 v240, v176, v177
    v_cvt_pk_bf16_f32 v241, v178, v179
    v_cvt_pk_bf16_f32 v242, v180, v181
    v_cvt_pk_bf16_f32 v243, v182, v183
    buffer_store_dwordx4 v[240:243], v5, s[8:11], s57 offen offset:0 sc1
    v_pk_mul_f32 v[184:185], v[184:185], v[172:173] op_sel_hi:[1,0]
    v_pk_mul_f32 v[186:187], v[186:187], v[172:173] op_sel_hi:[1,0]
    v_pk_mul_f32 v[188:189], v[188:189], v[172:173] op_sel_hi:[1,0]
    v_pk_mul_f32 v[190:191], v[190:191], v[172:173] op_sel_hi:[1,0]
    v_cvt_pk_bf16_f32 v244, v184, v185
    v_cvt_pk_bf16_f32 v245, v186, v187
    v_cvt_pk_bf16_f32 v246, v188, v189
    v_cvt_pk_bf16_f32 v247, v190, v191
    buffer_store_dwordx4 v[244:247], v5, s[8:11], s57 offen offset:512 sc1
    v_pk_mul_f32 v[192:193], v[192:193], v[172:173] op_sel_hi:[1,0]
    v_pk_mul_f32 v[194:195], v[194:195], v[172:173] op_sel_hi:[1,0]
    v_pk_mul_f32 v[196:197], v[196:197], v[172:173] op_sel_hi:[1,0]
    v_pk_mul_f32 v[198:199], v[198:199], v[172:173] op_sel_hi:[1,0]
    v_cvt_pk_bf16_f32 v248, v192, v193
    v_cvt_pk_bf16_f32 v249, v194, v195
    v_cvt_pk_bf16_f32 v250, v196, v197
    v_cvt_pk_bf16_f32 v251, v198, v199
    buffer_store_dwordx4 v[248:251], v5, s[8:11], s57 offen offset:1024 sc1
    v_pk_mul_f32 v[200:201], v[200:201], v[172:173] op_sel_hi:[1,0]
    v_pk_mul_f32 v[202:203], v[202:203], v[172:173] op_sel_hi:[1,0]
    v_pk_mul_f32 v[204:205], v[204:205], v[172:173] op_sel_hi:[1,0]
    v_pk_mul_f32 v[206:207], v[206:207], v[172:173] op_sel_hi:[1,0]
    v_cvt_pk_bf16_f32 v252, v200, v201
    v_cvt_pk_bf16_f32 v253, v202, v203
    v_cvt_pk_bf16_f32 v254, v204, v205
    v_cvt_pk_bf16_f32 v255, v206, v207
    buffer_store_dwordx4 v[252:255], v5, s[8:11], s57 offen offset:1536 sc1
    s_waitcnt vmcnt(0)
    s_atomic_add s71, s[8:9], s70
    s_mov_b32 s49, s59
L_attn_a:
    s_add_u32 s52, s49, 1
    s_lshl_b32 s57, s49, 5
    s_lshr_b32 s32, s48, 2
    s_add_u32 s57, s57, s32
    s_lshl_b32 s57, s57, 3
    s_and_b32 s32, s48, 3
    s_add_u32 s57, s57, s32
    s_lshl_b32 s57, s57, 11
    s_lshl_b32 s32, s49, 11
    s_xor_b32 s32, s32, s58
    s_and_b32 s32, s32, 8192
    s_add_u32 s57, s57, s32
    s_add_u32 s57, s57, 104857600
    s_waitcnt vmcnt(0)
    s_add_u32 s59, s49, 2
    s_cmp_ge_u32 s59, 64
    s_cbranch_scc1 L_attn_nf_a
    s_lshl_b32 s53, s59, 5
    s_add_u32 s53, s53, s48
    s_lshl_b32 s53, s53, 14
    s_lshl_b32 s32, s59, 11
    s_xor_b32 s32, s32, s58
    s_and_b32 s32, s32, 8192
    s_add_u32 s53, s53, s32
    s_xor_b32 s56, s53, 8192
    s_add_u32 s80, s59, 1
    s_cmp_ge_u32 s50, s80
    s_cbranch_scc1 Lsf_22_ok
    s_mov_b32 s30, 131072
Lsf_22:
    s_load_dwordx8 s[72:79], s[8:9], s68 glc
    s_sub_u32 s30, s30, 1
    s_cbranch_scc1 L_abort
    s_waitcnt lgkmcnt(0)
    s_min_u32 s50, s72, s74
    s_min_u32 s50, s50, s76
    s_cmp_ge_u32 s50, s80
    s_cbranch_scc1 Lsf_22_ok
    s_sleep 4
    s_branch Lsf_22
Lsf_22_ok:
    s_add_u32 s55, s56, 4194304
    buffer_load_dwordx4 v[32:35], v2, s[8:11], s55 offen offset:0 sc1
    buffer_load_dwordx4 v[36:39], v2, s[8:11], s55 offen offset:1024 sc1
    buffer_load_dwordx4 v[40:43], v2, s[8:11], s55 offen offset:2048 sc1
    buffer_load_dwordx4 v[44:47], v2, s[8:11], s55 offen offset:3072 sc1
    s_add_u32 s55, s56, 4198400
    buffer_load_dwordx4 v[48:51], v2, s[8:11], s55 offen offset:0 sc1
    buffer_load_dwordx4 v[52:55], v2, s[8:11], s55 offen offset:1024 sc1
    buffer_load_dwordx4 v[56:59], v2, s[8:11], s55 offen offset:2048 sc1
    buffer_load_dwordx4 v[60:63], v2, s[8:11], s55 offen offset:3072 sc1
    s_add_u32 s55, s53, 4194304
    buffer_load_dwordx4 v[64:67], v2, s[8:11], s55 offen offset:0 sc1
    buffer_load_dwordx4 v[68:71], v2, s[8:11], s55 offen offset:1024 sc1
    buffer_load_dwordx4 v[72:75], v2, s[8:11], s55 offen offset:2048 sc1
    buffer_load_dwordx4 v[76:79], v2, s[8:11], s55 offen offset:3072 sc1
    s_add_u32 s55, s53, 4198400
    buffer_load_dwordx4 v[80:83], v2, s[8:11], s55 offen offset:0 sc1
    buffer_load_dwordx4 v[84:87], v2, s[8:11], s55 offen offset:1024 sc1
    buffer_load_dwordx4 v[88:91], v2, s[8:11], s55 offen offset:2048 sc1
    buffer_load_dwordx4 v[92:95], v2, s[8:11], s55 offen offset:3072 sc1
    s_add_u32 s55, s53, 37748736
    buffer_load_dwordx4 v[96:99], v2, s[8:11], s55 offen offset:0 sc1
    buffer_load_dwordx4 v[100:103], v2, s[8:11], s55 offen offset:1024 sc1
    buffer_load_dwordx4 v[104:107], v2, s[8:11], s55 offen offset:2048 sc1
    buffer_load_dwordx4 v[108:111], v2, s[8:11], s55 offen offset:3072 sc1
    s_add_u32 s55, s53, 37752832
    buffer_load_dwordx4 v[112:115], v2, s[8:11], s55 offen offset:0 sc1
    buffer_load_dwordx4 v[116:119], v2, s[8:11], s55 offen offset:1024 sc1
    buffer_load_dwordx4 v[120:123], v2, s[8:11], s55 offen offset:2048 sc1
    buffer_load_dwordx4 v[124:127], v2, s[8:11], s55 offen offset:3072 sc1
L_attn_nf_a:
    s_lshl_b32 s53, s49, 5
    s_add_u32 s53, s53, s48
    s_lshl_b32 s53, s53, 14
    s_lshl_b32 s32, s49, 11
    s_xor_b32 s32, s32, s58
    s_and_b32 s32, s32, 8192
    s_add_u32 s53, s53, s32
    s_xor_b32 s56, s53, 8192
    v_mfma_f32_16x16x32_bf16 v[144:147], a[64:67], a[32:35], 0
    v_mfma_f32_16x16x32_bf16 v[156:159], a[64:67], a[48:51], 0
    v_mfma_f32_16x16x32_bf16 v[160:163], a[80:83], a[48:51], 0
    v_mfma_f32_16x16x32_bf16 v[144:147], a[68:71], a[36:39], v[144:147]
    v_mfma_f32_16x16x32_bf16 v[156:159], a[68:71], a[52:55], v[156:159]
    v_mfma_f32_16x16x32_bf16 v[160:163], a[84:87], a[52:55], v[160:163]
    v_mfma_f32_16x16x32_bf16 v[144:147], a[72:75], a[40:43], v[144:147]
    v_mfma_f32_16x16x32_bf16 v[156:159], a[72:75], a[56:59], v[156:159]
    v_mfma_f32_16x16x32_bf16 v[160:163], a[88:91], a[56:59], v[160:163]
    v_mfma_f32_16x16x32_bf16 v[144:147], a[76:79], a[44:47], v[144:147]
    v_mfma_f32_16x16x32_bf16 v[156:159], a[76:79], a[60:63], v[156:159]
    v_mfma_f32_16x16x32_bf16 v[160:163], a[92:95], a[60:63], v[160:163]
    v_mov_b64 v[152:153], 0
    v_mov_b64 v[154:155], 0
    v_mov_b64 v[164:165], 0
    v_mov_b64 v[166:167], 0
    v_cndmask_b32 v144, v144, v20, s[60:61]
    v_cndmask_b32 v145, v145, v20, s[62:63]
    v_cndmask_b32 v146, v146, v20, s[64:65]
    v_cndmask_b32 v147, v147, v20, s[66:67]
    v_cndmask_b32 v160, v160, v20, s[60:61]
    v_cndmask_b32 v161, v161, v20, s[62:63]
    v_cndmask_b32 v162, v162, v20, s[64:65]
    v_cndmask_b32 v163, v163, v20, s[66:67]
    v_max3_f32 v10, v144, v145, v146
    v_max_f32 v10, v10, v147
    v_max3_f32 v11, v156, v157, v158
    v_max_f32 v11, v11, v159
    v_max3_f32 v11, v11, v160, v161
    v_max3_f32 v11, v11, v162, v163
    s_cmp_ge_u32 s51, s52
    s_cbranch_scc1 Lsf_23_ok
    s_mov_b32 s30, 131072
Lsf_23:
    s_load_dwordx2 s[72:73], s[8:9], s69 glc
    s_sub_u32 s30, s30, 1
    s_cbranch_scc1 L_abort
    s_waitcnt lgkmcnt(0)
    s_min_u32 s51, s72, s73
    s_cmp_ge_u32 s51, s52
    s_cbranch_scc1 Lsf_23_ok
    s_branch Lsf_23
Lsf_23_ok:
    s_add_u32 s55, s53, 71303168
    buffer_load_dwordx4 v[208:211], v2, s[8:11], s55 offen offset:0 sc1
    buffer_load_dwordx4 v[216:219], v2, s[8:11], s55 offen offset:1024 sc1
    buffer_load_dwordx4 v[224:227], v2, s[8:11], s55 offen offset:2048 sc1
    buffer_load_dwordx4 v[232:235], v2, s[8:11], s55 offen offset:3072 sc1
    s_add_u32 s55, s53, 71307264
    buffer_load_dwordx4 v[212:215], v2, s[8:11], s55 offen offset:0 sc1
    buffer_load_dwordx4 v[220:223], v2, s[8:11], s55 offen offset:1024 sc1
    buffer_load_dwordx4 v[228:231], v2, s[8:11], s55 offen offset:2048 sc1
    buffer_load_dwordx4 v[236:239], v2, s[8:11], s55 offen offset:3072 sc1
    s_waitcnt vmcnt(4)
    v_mov_b32 v128, v210
    v_mov_b32 v129, v218
    v_mov_b32 v130, v226
    v_mov_b32 v131, v234
    s_nop 1
    v_smfmac_f32_16x16x64_bf16 v[152:155], v[128:131], a[32:39], v7
    v_smfmac_f32_16x16x64_bf16 v[164:167], v[128:131], a[48:55], v7
    s_waitcnt vmcnt(0)
    v_mov_b32 v132, v214
    v_mov_b32 v133, v222
    v_mov_b32 v134, v230
    v_mov_b32 v135, v238
    s_nop 1
    v_smfmac_f32_16x16x64_bf16 v[152:155], v[132:135], a[40:47], v7
    v_smfmac_f32_16x16x64_bf16 v[164:167], v[132:135], a[56:63], v7
    v_swap_b32 v209, v212
    v_swap_b32 v217, v220
    v_swap_b32 v225, v228
    v_swap_b32 v233, v236
    v_add_f32 v152, v152, v154
    v_add_f32 v153, v153, v155
    v_max3_f32 v154, v10, v152, v153
    v_max3_f32 v155, v10, v152, v153
    v_add_f32 v164, v164, v166
    v_add_f32 v165, v165, v167
    v_max3_f32 v166, v11, v164, v165
    v_max3_f32 v167, v11, v164, v165
    v_permlane32_swap_b32 v154, v155
    v_max_f32 v8, v154, v155
    v_max_f32 v154, v154, v155
    v_permlane32_swap_b32 v166, v167
    v_max_f32 v9, v166, v167
    v_max_f32 v166, v166, v167
    v_permlane16_swap_b32 v8, v154
    v_max_f32 v8, v8, v154
    v_mul_f32 v8, s54, v8
    v_permlane16_swap_b32 v9, v166
    v_max_f32 v9, v9, v166
    v_mul_f32 v9, s54, v9
    v_fma_f32 v144, v144, s54, -v8
    v_fma_f32 v145, v145, s54, -v8
    v_fma_f32 v146, v146, s54, -v8
    v_fma_f32 v147, v147, s54, -v8
    v_fma_f32 v152, v152, s54, -v8
    v_fma_f32 v153, v153, s54, -v8
    v_exp_f32 v144, v144
    v_exp_f32 v145, v145
    v_exp_f32 v146, v146
    v_exp_f32 v147, v147
    v_exp_f32 v152, v152
    v_exp_f32 v153, v153
    v_cvt_pk_bf16_f32 v144, v144, v145
    v_cvt_pk_bf16_f32 v145, v146, v147
    v_mov_b64 v[146:147], 0
    v_cvt_pk_bf16_f32 v154, v152, v153
    v_cvt_pk_bf16_f32 v155, v152, v153
    v_mfma_f32_16x16x32_bf16 v[168:171], v[16:19], v[144:147], 0
    v_fma_f32 v156, v156, s54, -v9
    v_fma_f32 v157, v157, s54, -v9
    v_mfma_f32_16x16x32_bf16 v[176:179], a[96:99], v[144:147], 0
    v_fma_f32 v158, v158, s54, -v9
    v_fma_f32 v159, v159, s54, -v9
    v_mfma_f32_16x16x32_bf16 v[180:183], a[100:103], v[144:147], 0
    v_fma_f32 v160, v160, s54, -v9
    v_fma_f32 v161, v161, s54, -v9
    v_mfma_f32_16x16x32_bf16 v[184:187], a[104:107], v[144:147], 0
    v_fma_f32 v162, v162, s54, -v9
    v_fma_f32 v163, v163, s54, -v9
    v_mfma_f32_16x16x32_bf16 v[188:191], a[108:111], v[144:147], 0
    v_fma_f32 v164, v164, s54, -v9
    v_fma_f32 v165, v165, s54, -v9
    v_mfma_f32_16x16x32_bf16 v[192:195], a[112:115], v[144:147], 0
    v_exp_f32 v156, v156
    v_mfma_f32_16x16x32_bf16 v[196:199], a[116:119], v[144:147], 0
    v_exp_f32 v157, v157
    v_mfma_f32_16x16x32_bf16 v[200:203], a[120:123], v[144:147], 0
    v_exp_f32 v158, v158
    v_mfma_f32_16x16x32_bf16 v[204:207], a[124:127], v[144:147], 0
    v_exp_f32 v159, v159
    v_mfma_f32_16x16x16_bf16 v[168:171], v[24:25], v[154:155], v[168:171]
    v_exp_f32 v160, v160
    v_mfma_f32_16x16x16_bf16 v[176:179], v[208:209], v[154:155], v[176:179]
    v_exp_f32 v161, v161
    v_mfma_f32_16x16x16_bf16 v[180:183], v[212:213], v[154:155], v[180:183]
    v_exp_f32 v162, v162
    v_mfma_f32_16x16x16_bf16 v[184:187], v[216:217], v[154:155], v[184:187]
    v_exp_f32 v163, v163
    v_mfma_f32_16x16x16_bf16 v[188:191], v[220:221], v[154:155], v[188:191]
    v_exp_f32 v164, v164
    v_mfma_f32_16x16x16_bf16 v[192:195], v[224:225], v[154:155], v[192:195]
    v_exp_f32 v165, v165
    v_mfma_f32_16x16x16_bf16 v[196:199], v[228:229], v[154:155], v[196:199]
    v_cvt_pk_bf16_f32 v156, v156, v157
    v_cvt_pk_bf16_f32 v157, v158, v159
    v_mfma_f32_16x16x16_bf16 v[200:203], v[232:233], v[154:155], v[200:203]
    v_cvt_pk_bf16_f32 v158, v160, v161
    v_cvt_pk_bf16_f32 v159, v162, v163
    v_mfma_f32_16x16x16_bf16 v[204:207], v[236:237], v[154:155], v[204:207]
    v_cvt_pk_bf16_f32 v166, v164, v165
    v_cvt_pk_bf16_f32 v167, v164, v165
    v_rcp_f32 v168, v168
    s_nop 0
    v_pk_mul_f32 v[176:177], v[176:177], v[168:169] op_sel_hi:[1,0]
    v_pk_mul_f32 v[178:179], v[178:179], v[168:169] op_sel_hi:[1,0]
    v_pk_mul_f32 v[180:181], v[180:181], v[168:169] op_sel_hi:[1,0]
    v_pk_mul_f32 v[182:183], v[182:183], v[168:169] op_sel_hi:[1,0]
    v_cvt_pk_bf16_f32 v240, v176, v177
    v_cvt_pk_bf16_f32 v241, v178, v179
    v_cvt_pk_bf16_f32 v242, v180, v181
    v_cvt_pk_bf16_f32 v243, v182, v183
    buffer_store_dwordx4 v[240:243], v5, s[8:11], s57 offen offset:0 sc1
    v_pk_mul_f32 v[184:185], v[184:185], v[168:169] op_sel_hi:[1,0]
    v_pk_mul_f32 v[186:187], v[186:187], v[168:169] op_sel_hi:[1,0]
    v_pk_mul_f32 v[188:189], v[188:189], v[168:169] op_sel_hi:[1,0]
    v_pk_mul_f32 v[190:191], v[190:191], v[168:169] op_sel_hi:[1,0]
    v_cvt_pk_bf16_f32 v244, v184, v185
    v_cvt_pk_bf16_f32 v245, v186, v187
    v_cvt_pk_bf16_f32 v246, v188, v189
    v_cvt_pk_bf16_f32 v247, v190, v191
    buffer_store_dwordx4 v[244:247], v5, s[8:11], s57 offen offset:512 sc1
    v_pk_mul_f32 v[192:193], v[192:193], v[168:169] op_sel_hi:[1,0]
    v_pk_mul_f32 v[194:195], v[194:195], v[168:169] op_sel_hi:[1,0]
    v_pk_mul_f32 v[196:197], v[196:197], v[168:169] op_sel_hi:[1,0]
    v_pk_mul_f32 v[198:199], v[198:199], v[168:169] op_sel_hi:[1,0]
    v_cvt_pk_bf16_f32 v248, v192, v193
    v_cvt_pk_bf16_f32 v249, v194, v195
    v_cvt_pk_bf16_f32 v250, v196, v197
    v_cvt_pk_bf16_f32 v251, v198, v199
    buffer_store_dwordx4 v[248:251], v5, s[8:11], s57 offen offset:1024 sc1
    v_pk_mul_f32 v[200:201], v[200:201], v[168:169] op_sel_hi:[1,0]
    v_pk_mul_f32 v[202:203], v[202:203], v[168:169] op_sel_hi:[1,0]
    v_pk_mul_f32 v[204:205], v[204:205], v[168:169] op_sel_hi:[1,0]
    v_pk_mul_f32 v[206:207], v[206:207], v[168:169] op_sel_hi:[1,0]
    v_cvt_pk_bf16_f32 v252, v200, v201
    v_cvt_pk_bf16_f32 v253, v202, v203
    v_cvt_pk_bf16_f32 v254, v204, v205
    v_cvt_pk_bf16_f32 v255, v206, v207
    buffer_store_dwordx4 v[252:255], v5, s[8:11], s57 offen offset:1536 sc1
    v_mfma_f32_16x16x32_bf16 v[172:175], v[16:19], v[156:159], 0
    v_mfma_f32_16x16x32_bf16 v[176:179], a[96:99], v[156:159], 0
    v_mfma_f32_16x16x32_bf16 v[180:183], a[100:103], v[156:159], 0
    v_mfma_f32_16x16x32_bf16 v[184:187], a[104:107], v[156:159], 0
    v_mfma_f32_16x16x32_bf16 v[188:191], a[108:111], v[156:159], 0
    v_mfma_f32_16x16x32_bf16 v[192:195], a[112:115], v[156:159], 0
    v_mfma_f32_16x16x32_bf16 v[196:199], a[116:119], v[156:159], 0
    v_mfma_f32_16x16x32_bf16 v[200:203], a[120:123], v[156:159], 0
    v_mfma_f32_16x16x32_bf16 v[204:207], a[124:127], v[156:159], 0
    v_mfma_f32_16x16x16_bf16 v[172:175], v[24:25], v[166:167], v[172:175]
    v_mfma_f32_16x16x16_bf16 v[176:179], v[208:209], v[166:167], v[176:179]
    v_mfma_f32_16x16x16_bf16 v[180:183], v[212:213], v[166:167], v[180:183]
    v_mfma_f32_16x16x16_bf16 v[184:187], v[216:217], v[166:167], v[184:187]
    v_mfma_f32_16x16x16_bf16 v[188:191], v[220:221], v[166:167], v[188:191]
    v_mfma_f32_16x16x16_bf16 v[192:195], v[224:225], v[166:167], v[192:195]
    v_mfma_f32_16x16x16_bf16 v[196:199], v[228:229], v[166:167], v[196:199]
    v_mfma_f32_16x16x16_bf16 v[200:203], v[232:233], v[166:167], v[200:203]
    v_mfma_f32_16x16x16_bf16 v[204:207], v[236:237], v[166:167], v[204:207]
    s_add_u32 s57, s57, 262144
    v_rcp_f32 v172, v172
    s_nop 0
    v_pk_mul_f32 v[176:177], v[176:177], v[172:173] op_sel_hi:[1,0]
    v_pk_mul_f32 v[178:179], v[178:179], v[172:173] op_sel_hi:[1,0]
    v_pk_mul_f32 v[180:181], v[180:181], v[172:173] op_sel_hi:[1,0]
    v_pk_mul_f32 v[182:183], v[182:183], v[172:173] op_sel_hi:[1,0]
    v_cvt_pk_bf16_f32 v240, v176, v177
    v_cvt_pk_bf16_f32 v241, v178, v179
    v_cvt_pk_bf16_f32 v242, v180, v181
    v_cvt_pk_bf16_f32 v243, v182, v183
    buffer_store_dwordx4 v[240:243], v5, s[8:11], s57 offen offset:0 sc1
    v_pk_mul_f32 v[184:185], v[184:185], v[172:173] op_sel_hi:[1,0]
    v_pk_mul_f32 v[186:187], v[186:187], v[172:173] op_sel_hi:[1,0]
    v_pk_mul_f32 v[188:189], v[188:189], v[172:173] op_sel_hi:[1,0]
    v_pk_mul_f32 v[190:191], v[190:191], v[172:173] op_sel_hi:[1,0]
    v_cvt_pk_bf16_f32 v244, v184, v185
    v_cvt_pk_bf16_f32 v245, v186, v187
    v_cvt_pk_bf16_f32 v246, v188, v189
    v_cvt_pk_bf16_f32 v247, v190, v191
    buffer_store_dwordx4 v[244:247], v5, s[8:11], s57 offen offset:512 sc1
    v_pk_mul_f32 v[192:193], v[192:193], v[172:173] op_sel_hi:[1,0]
    v_pk_mul_f32 v[194:195], v[194:195], v[172:173] op_sel_hi:[1,0]
    v_pk_mul_f32 v[196:197], v[196:197], v[172:173] op_sel_hi:[1,0]
    v_pk_mul_f32 v[198:199], v[198:199], v[172:173] op_sel_hi:[1,0]
    v_cvt_pk_bf16_f32 v248, v192, v193
    v_cvt_pk_bf16_f32 v249, v194, v195
    v_cvt_pk_bf16_f32 v250, v196, v197
    v_cvt_pk_bf16_f32 v251, v198, v199
    buffer_store_dwordx4 v[248:251], v5, s[8:11], s57 offen offset:1024 sc1
    v_pk_mul_f32 v[200:201], v[200:201], v[172:173] op_sel_hi:[1,0]
    v_pk_mul_f32 v[202:203], v[202:203], v[172:173] op_sel_hi:[1,0]
    v_pk_mul_f32 v[204:205], v[204:205], v[172:173] op_sel_hi:[1,0]
    v_pk_mul_f32 v[206:207], v[206:207], v[172:173] op_sel_hi:[1,0]
    v_cvt_pk_bf16_f32 v252, v200, v201
    v_cvt_pk_bf16_f32 v253, v202, v203
    v_cvt_pk_bf16_f32 v254, v204, v205
    v_cvt_pk_bf16_f32 v255, v206, v207
    buffer_store_dwordx4 v[252:255], v5, s[8:11], s57 offen offset:1536 sc1
    s_waitcnt vmcnt(0)
    s_atomic_add s71, s[8:9], s70
    s_mov_b32 s49, s59
    s_cmp_lt_u32 s49, 64
    s_cbranch_scc1 L_attn_v
    s_waitcnt lgkmcnt(0)
    s_endpgm
L_oproj:
    s_mov_b64 s[12:13], s[88:89]
    s_mov_b32 s14, 5242880
    s_mov_b32 s15, 0x20000
    s_load_dwordx2 s[16:17], s[0:1], 128
    s_mov_b32 s18, 5242880
    s_mov_b32 s19, 0x20000
    s_sub_u32 s48, s28, 2
    s_lshl_b32 s48, s48, 5
    s_add_u32 s48, s48, s29
    s_sub_u32 s48, s48, 16
    s_mul_i32 s49, s48, 3277
    s_lshr_b32 s49, s49, 16
    s_mul_i32 s32, s49, 20
    s_sub_u32 s50, s48, s32
    v_lshlrev_b32 v2, 4, v1
    v_lshrrev_b32 v12, 4, v0
    v_and_b32 v13, 15, v0
    v_lshrrev_b32 v14, 2, v13
    v_lshl_add_u32 v14, v14, 10, v12
    v_mul_u32_u24 v3, 1280, v14
    v_and_b32 v14, 3, v13
    v_lshl_add_u32 v3, v14, 4, v3
    s_lshl_b32 s32, s50, 6
    v_add_u32 v3, s32, v3
    v_mul_u32_u24 v4, 288, v12
    v_lshl_add_u32 v4, v13, 4, v4
    v_bfe_u32 v12, v1, 4, 1
    v_bfe_u32 v13, v1, 5, 1
    v_bfe_u32 v14, v1, 2, 1
    v_bfe_u32 v15, v1, 3, 1
    v_lshl_add_u32 v14, v12, 4, v14
    v_lshl_add_u32 v14, v13, 3, v14
    v_lshl_add_u32 v14, v15, 2, v14
    v_mul_u32_u24 v5, 288, v14
    v_and_b32 v14, 3, v1
    v_lshl_add_u32 v5, v14, 3, v5
    s_lshl_b32 s32, s5, 6
    v_add_u32 v5, s32, v5
    s_waitcnt lgkmcnt(0)
    s_barrier
    s_mov_b32 s56, 0
    buffer_load_dwordx4 v[128:131], v3, s[12:15], s56 offen
    s_mov_b32 s56, 20480
    buffer_load_dwordx4 v[132:135], v3, s[12:15], s56 offen
    s_mov_b32 s56, 40960
    buffer_load_dwordx4 v[136:139], v3, s[12:15], s56 offen
    s_mov_b32 s56, 61440
    buffer_load_dwordx4 v[140:143], v3, s[12:15], s56 offen
    s_mov_b32 s56, 81920
    buffer_load_dwordx4 v[144:147], v3, s[12:15], s56 offen
    s_mov_b32 s56, 102400
    buffer_load_dwordx4 v[148:151], v3, s[12:15], s56 offen
    s_mov_b32 s56, 122880
    buffer_load_dwordx4 v[152:155], v3, s[12:15], s56 offen
    s_mov_b32 s56, 143360
    buffer_load_dwordx4 v[156:159], v3, s[12:15], s56 offen
    s_mov_b32 s56, 163840
    buffer_load_dwordx4 v[160:163], v3, s[12:15], s56 offen
    s_mov_b32 s56, 184320
    buffer_load_dwordx4 v[164:167], v3, s[12:15], s56 offen
    s_mov_b32 s56, 204800
    buffer_load_dwordx4 v[168:171], v3, s[12:15], s56 offen
    s_mov_b32 s56, 225280
    buffer_load_dwordx4 v[172:175], v3, s[12:15], s56 offen
    s_mov_b32 s56, 245760
    buffer_load_dwordx4 v[176:179], v3, s[12:15], s56 offen
    s_mov_b32 s56, 266240
    buffer_load_dwordx4 v[180:183], v3, s[12:15], s56 offen
    s_mov_b32 s56, 286720
    buffer_load_dwordx4 v[184:187], v3, s[12:15], s56 offen
    s_mov_b32 s56, 307200
    buffer_load_dwordx4 v[188:191], v3, s[12:15], s56 offen
    s_mov_b32 s56, 327680
    buffer_load_dwordx4 v[192:195], v3, s[12:15], s56 offen
    s_mov_b32 s56, 348160
    buffer_load_dwordx4 v[196:199], v3, s[12:15], s56 offen
    s_mov_b32 s56, 368640
    buffer_load_dwordx4 v[200:203], v3, s[12:15], s56 offen
    s_mov_b32 s56, 389120
    buffer_load_dwordx4 v[204:207], v3, s[12:15], s56 offen
    s_mov_b32 s56, 409600
    buffer_load_dwordx4 v[208:211], v3, s[12:15], s56 offen
    s_mov_b32 s56, 430080
    buffer_load_dwordx4 v[212:215], v3, s[12:15], s56 offen
    s_mov_b32 s56, 450560
    buffer_load_dwordx4 v[216:219], v3, s[12:15], s56 offen
    s_mov_b32 s56, 471040
    buffer_load_dwordx4 v[220:223], v3, s[12:15], s56 offen
    s_mov_b32 s56, 491520
    buffer_load_dwordx4 v[224:227], v3, s[12:15], s56 offen
    s_mov_b32 s56, 512000
    buffer_load_dwordx4 v[228:231], v3, s[12:15], s56 offen
    s_mov_b32 s56, 532480
    buffer_load_dwordx4 v[232:235], v3, s[12:15], s56 offen
    s_mov_b32 s56, 552960
    buffer_load_dwordx4 v[236:239], v3, s[12:15], s56 offen
    s_mov_b32 s56, 573440
    buffer_load_dwordx4 v[240:243], v3, s[12:15], s56 offen
    s_mov_b32 s56, 593920
    buffer_load_dwordx4 v[244:247], v3, s[12:15], s56 offen
    s_mov_b32 s56, 614400
    buffer_load_dwordx4 v[248:251], v3, s[12:15], s56 offen
    s_mov_b32 s56, 634880
    buffer_load_dwordx4 v[252:255], v3, s[12:15], s56 offen
    s_waitcnt vmcnt(28)
    ds_write_b128 v4, v[128:131] offset:0
    ds_write_b128 v4, v[132:135] offset:4608
    ds_write_b128 v4, v[136:139] offset:9216
    ds_write_b128 v4, v[140:143] offset:13824
    s_waitcnt lgkmcnt(0)
    s_mov_b32 s56, 655360
    buffer_load_dwordx4 v[128:131], v3, s[12:15], s56 offen
    s_mov_b32 s56, 675840
    buffer_load_dwordx4 v[132:135], v3, s[12:15], s56 offen
    s_mov_b32 s56, 696320
    buffer_load_dwordx4 v[136:139], v3, s[12:15], s56 offen
    s_mov_b32 s56, 716800
    buffer_load_dwordx4 v[140:143], v3, s[12:15], s56 offen
    s_barrier
    ds_read_b64_tr_b16 a[0:1], v5 offset:0
    ds_read_b64_tr_b16 a[2:3], v5 offset:576
    ds_read_b64_tr_b16 a[4:5], v5 offset:9216
    ds_read_b64_tr_b16 a[6:7], v5 offset:9792
    ds_read_b64_tr_b16 a[8:9], v5 offset:32
    ds_read_b64_tr_b16 a[10:11], v5 offset:608
    ds_read_b64_tr_b16 a[12:13], v5 offset:9248
    ds_read_b64_tr_b16 a[14:15], v5 offset:9824
    s_waitcnt vmcnt(28)
    ds_write_b128 v4, v[144:147] offset:18432
    ds_write_b128 v4, v[148:151] offset:23040
    ds_write_b128 v4, v[152:155] offset:27648
    ds_write_b128 v4, v[156:159] offset:32256
    s_waitcnt lgkmcnt(0)
    s_mov_b32 s56, 737280
    buffer_load_dwordx4 v[144:147], v3, s[12:15], s56 offen
    s_mov_b32 s56, 757760
    buffer_load_dwordx4 v[148:151], v3, s[12:15], s56 offen
    s_mov_b32 s56, 778240
    buffer_load_dwordx4 v[152:155], v3, s[12:15], s56 offen
    s_mov_b32 s56, 798720
    buffer_load_dwordx4 v[156:159], v3, s[12:15], s56 offen
    s_barrier
    ds_read_b64_tr_b16 a[16:17], v5 offset:18432
    ds_read_b64_tr_b16 a[18:19], v5 offset:19008
    ds_read_b64_tr_b16 a[20:21], v5 offset:27648
    ds_read_b64_tr_b16 a[22:23], v5 offset:28224
    ds_read_b64_tr_b16 a[24:25], v5 offset:18464
    ds_read_b64_tr_b16 a[26:27], v5 offset:19040
    ds_read_b64_tr_b16 a[28:29], v5 offset:27680
    ds_read_b64_tr_b16 a[30:31], v5 offset:28256
    s_waitcnt vmcnt(28)
    ds_write_b128 v4, v[160:163] offset:0
    ds_write_b128 v4, v[164:167] offset:4608
    ds_write_b128 v4, v[168:171] offset:9216
    ds_write_b128 v4, v[172:175] offset:13824
    s_waitcnt lgkmcnt(0)
    s_mov_b32 s56, 819200
    buffer_load_dwordx4 v[160:163], v3, s[12:15], s56 offen
    s_mov_b32 s56, 839680
    buffer_load_dwordx4 v[164:167], v3, s[12:15], s56 offen
    s_mov_b32 s56, 860160
    buffer_load_dwordx4 v[168:171], v3, s[12:15], s56 offen
    s_mov_b32 s56, 880640
    buffer_load_dwordx4 v[172:175], v3, s[12:15], s56 offen
    s_barrier
    ds_read_b64_tr_b16 a[32:33], v5 offset:0
    ds_read_b64_tr_b16 a[34:35], v5 offset:576
    ds_read_b64_tr_b16 a[36:37], v5 offset:9216
    ds_read_b64_tr_b16 a[38:39], v5 offset:9792
    ds_read_b64_tr_b16 a[40:41], v5 offset:32
    ds_read_b64_tr_b16 a[42:43], v5 offset:608
    ds_read_b64_tr_b16 a[44:45], v5 offset:9248
    ds_read_b64_tr_b16 a[46:47], v5 offset:9824
    s_waitcnt vmcnt(28)
    ds_write_b128 v4, v[176:179] offset:18432
    ds_write_b128 v4, v[180:183] offset:23040
    ds_write_b128 v4, v[184:187] offset:27648
    ds_write_b128 v4, v[188:191] offset:32256
    s_waitcnt lgkmcnt(0)
    s_mov_b32 s56, 901120
    buffer_load_dwordx4 v[176:179], v3, s[12:15], s56 offen
    s_mov_b32 s56, 921600
    buffer_load_dwordx4 v[180:183], v3, s[12:15], s56 offen
    s_mov_b32 s56, 942080
    buffer_load_dwordx4 v[184:187], v3, s[12:15], s56 offen
    s_mov_b32 s56, 962560
    buffer_load_dwordx4 v[188:191], v3, s[12:15], s56 offen
    s_barrier
    ds_read_b64_tr_b16 a[48:49], v5 offset:18432
    ds_read_b64_tr_b16 a[50:51], v5 offset:19008
    ds_read_b64_tr_b16 a[52:53], v5 offset:27648
    ds_read_b64_tr_b16 a[54:55], v5 offset:28224
    ds_read_b64_tr_b16 a[56:57], v5 offset:18464
    ds_read_b64_tr_b16 a[58:59], v5 offset:19040
    ds_read_b64_tr_b16 a[60:61], v5 offset:27680
    ds_read_b64_tr_b16 a[62:63], v5 offset:28256
    s_waitcnt vmcnt(28)
    ds_write_b128 v4, v[192:195] offset:0
    ds_write_b128 v4, v[196:199] offset:4608
    ds_write_b128 v4, v[200:203] offset:9216
    ds_write_b128 v4, v[204:207] offset:13824
    s_waitcnt lgkmcnt(0)
    s_mov_b32 s56, 983040
    buffer_load_dwordx4 v[192:195], v3, s[12:15], s56 offen
    s_mov_b32 s56, 1003520
    buffer_load_dwordx4 v[196:199], v3, s[12:15], s56 offen
    s_mov_b32 s56, 1024000
    buffer_load_dwordx4 v[200:203], v3, s[12:15], s56 offen
    s_mov_b32 s56, 1044480
    buffer_load_dwordx4 v[204:207], v3, s[12:15], s56 offen
    s_barrier
    ds_read_b64_tr_b16 a[64:65], v5 offset:0
    ds_read_b64_tr_b16 a[66:67], v5 offset:576
    ds_read_b64_tr_b16 a[68:69], v5 offset:9216
    ds_read_b64_tr_b16 a[70:71], v5 offset:9792
    ds_read_b64_tr_b16 a[72:73], v5 offset:32
    ds_read_b64_tr_b16 a[74:75], v5 offset:608
    ds_read_b64_tr_b16 a[76:77], v5 offset:9248
    ds_read_b64_tr_b16 a[78:79], v5 offset:9824
    s_waitcnt vmcnt(28)
    ds_write_b128 v4, v[208:211] offset:18432
    ds_write_b128 v4, v[212:215] offset:23040
    ds_write_b128 v4, v[216:219] offset:27648
    ds_write_b128 v4, v[220:223] offset:32256
    s_waitcnt lgkmcnt(0)
    s_mov_b32 s56, 1064960
    buffer_load_dwordx4 v[208:211], v3, s[12:15], s56 offen
    s_mov_b32 s56, 1085440
    buffer_load_dwordx4 v[212:215], v3, s[12:15], s56 offen
    s_mov_b32 s56, 1105920
    buffer_load_dwordx4 v[216:219], v3, s[12:15], s56 offen
    s_mov_b32 s56, 1126400
    buffer_load_dwordx4 v[220:223], v3, s[12:15], s56 offen
    s_barrier
    ds_read_b64_tr_b16 a[80:81], v5 offset:18432
    ds_read_b64_tr_b16 a[82:83], v5 offset:19008
    ds_read_b64_tr_b16 a[84:85], v5 offset:27648
    ds_read_b64_tr_b16 a[86:87], v5 offset:28224
    ds_read_b64_tr_b16 a[88:89], v5 offset:18464
    ds_read_b64_tr_b16 a[90:91], v5 offset:19040
    ds_read_b64_tr_b16 a[92:93], v5 offset:27680
    ds_read_b64_tr_b16 a[94:95], v5 offset:28256
    s_waitcnt vmcnt(28)
    ds_write_b128 v4, v[224:227] offset:0
    ds_write_b128 v4, v[228:231] offset:4608
    ds_write_b128 v4, v[232:235] offset:9216
    ds_write_b128 v4, v[236:239] offset:13824
    s_waitcnt lgkmcnt(0)
    s_mov_b32 s56, 1146880
    buffer_load_dwordx4 v[224:227], v3, s[12:15], s56 offen
    s_mov_b32 s56, 1167360
    buffer_load_dwordx4 v[228:231], v3, s[12:15], s56 offen
    s_mov_b32 s56, 1187840
    buffer_load_dwordx4 v[232:235], v3, s[12:15], s56 offen
    s_mov_b32 s56, 1208320
    buffer_load_dwordx4 v[236:239], v3, s[12:15], s56 offen
    s_barrier
    ds_read_b64_tr_b16 a[96:97], v5 offset:0
    ds_read_b64_tr_b16 a[98:99], v5 offset:576
    ds_read_b64_tr_b16 a[100:101], v5 offset:9216
    ds_read_b64_tr_b16 a[102:103], v5 offset:9792
    ds_read_b64_tr_b16 a[104:105], v5 offset:32
    ds_read_b64_tr_b16 a[106:107], v5 offset:608
    ds_read_b64_tr_b16 a[108:109], v5 offset:9248
    ds_read_b64_tr_b16 a[110:111], v5 offset:9824
    s_waitcnt vmcnt(28)
    ds_write_b128 v4, v[240:243] offset:18432
    ds_write_b128 v4, v[244:247] offset:23040
    ds_write_b128 v4, v[248:251] offset:27648
    ds_write_b128 v4, v[252:255] offset:32256
    s_waitcnt lgkmcnt(0)
    s_mov_b32 s56, 1228800
    buffer_load_dwordx4 v[240:243], v3, s[12:15], s56 offen
    s_mov_b32 s56, 1249280
    buffer_load_dwordx4 v[244:247], v3, s[12:15], s56 offen
    s_mov_b32 s56, 1269760
    buffer_load_dwordx4 v[248:251], v3, s[12:15], s56 offen
    s_mov_b32 s56, 1290240
    buffer_load_dwordx4 v[252:255], v3, s[12:15], s56 offen
    s_barrier
    ds_read_b64_tr_b16 a[112:113], v5 offset:18432
    ds_read_b64_tr_b16 a[114:115], v5 offset:19008
    ds_read_b64_tr_b16 a[116:117], v5 offset:27648
    ds_read_b64_tr_b16 a[118:119], v5 offset:28224
    ds_read_b64_tr_b16 a[120:121], v5 offset:18464
    ds_read_b64_tr_b16 a[122:123], v5 offset:19040
    ds_read_b64_tr_b16 a[124:125], v5 offset:27680
    ds_read_b64_tr_b16 a[126:127], v5 offset:28256
    s_waitcnt vmcnt(28)
    ds_write_b128 v4, v[128:131] offset:0
    ds_write_b128 v4, v[132:135] offset:4608
    ds_write_b128 v4, v[136:139] offset:9216
    ds_write_b128 v4, v[140:143] offset:13824
    s_waitcnt lgkmcnt(0)
    s_barrier
    ds_read_b64_tr_b16 a[128:129], v5 offset:0
    ds_read_b64_tr_b16 a[130:131], v5 offset:576
    ds_read_b64_tr_b16 a[132:133], v5 offset:9216
    ds_read_b64_tr_b16 a[134:135], v5 offset:9792
    ds_read_b64_tr_b16 a[136:137], v5 offset:32
    ds_read_b64_tr_b16 a[138:139], v5 offset:608
    ds_read_b64_tr_b16 a[140:141], v5 offset:9248
    ds_read_b64_tr_b16 a[142:143], v5 offset:9824
    s_waitcnt vmcnt(24)
    ds_write_b128 v4, v[144:147] offset:18432
    ds_write_b128 v4, v[148:151] offset:23040
    ds_write_b128 v4, v[152:155] offset:27648
    ds_write_b128 v4, v[156:159] offset:32256
    s_waitcnt lgkmcnt(0)
    s_barrier
    ds_read_b64_tr_b16 a[144:145], v5 offset:18432
    ds_read_b64_tr_b16 a[146:147], v5 offset:19008
    ds_read_b64_tr_b16 a[148:149], v5 offset:27648
    ds_read_b64_tr_b16 a[150:151], v5 offset:28224
    ds_read_b64_tr_b16 a[152:153], v5 offset:18464
    ds_read_b64_tr_b16 a[154:155], v5 offset:19040
    ds_read_b64_tr_b16 a[156:157], v5 offset:27680
    ds_read_b64_tr_b16 a[158:159], v5 offset:28256
    s_waitcnt vmcnt(20)
    ds_write_b128 v4, v[160:163] offset:0
    ds_write_b128 v4, v[164:167] offset:4608
    ds_write_b128 v4, v[168:171] offset:9216
    ds_write_b128 v4, v[172:175] offset:13824
    s_waitcnt lgkmcnt(0)
    s_barrier
    ds_read_b64_tr_b16 a[160:161], v5 offset:0
    ds_read_b64_tr_b16 a[162:163], v5 offset:576
    ds_read_b64_tr_b16 a[164:165], v5 offset:9216
    ds_read_b64_tr_b16 a[166:167], v5 offset:9792
    ds_read_b64_tr_b16 a[168:169], v5 offset:32
    ds_read_b64_tr_b16 a[170:171], v5 offset:608
    ds_read_b64_tr_b16 a[172:173], v5 offset:9248
    ds_read_b64_tr_b16 a[174:175], v5 offset:9824
    s_waitcnt vmcnt(16)
    ds_write_b128 v4, v[176:179] offset:18432
    ds_write_b128 v4, v[180:183] offset:23040
    ds_write_b128 v4, v[184:187] offset:27648
    ds_write_b128 v4, v[188:191] offset:32256
    s_waitcnt lgkmcnt(0)
    s_barrier
    ds_read_b64_tr_b16 a[176:177], v5 offset:18432
    ds_read_b64_tr_b16 a[178:179], v5 offset:19008
    ds_read_b64_tr_b16 a[180:181], v5 offset:27648
    ds_read_b64_tr_b16 a[182:183], v5 offset:28224
    ds_read_b64_tr_b16 a[184:185], v5 offset:18464
    ds_read_b64_tr_b16 a[186:187], v5 offset:19040
    ds_read_b64_tr_b16 a[188:189], v5 offset:27680
    ds_read_b64_tr_b16 a[190:191], v5 offset:28256
    s_waitcnt vmcnt(12)
    ds_write_b128 v4, v[192:195] offset:0
    ds_write_b128 v4, v[196:199] offset:4608
    ds_write_b128 v4, v[200:203] offset:9216
    ds_write_b128 v4, v[204:207] offset:13824
    s_waitcnt lgkmcnt(0)
    s_barrier
    ds_read_b64_tr_b16 a[192:193], v5 offset:0
    ds_read_b64_tr_b16 a[194:195], v5 offset:576
    ds_read_b64_tr_b16 a[196:197], v5 offset:9216
    ds_read_b64_tr_b16 a[198:199], v5 offset:9792
    ds_read_b64_tr_b16 a[200:201], v5 offset:32
    ds_read_b64_tr_b16 a[202:203], v5 offset:608
    ds_read_b64_tr_b16 a[204:205], v5 offset:9248
    ds_read_b64_tr_b16 a[206:207], v5 offset:9824
    s_waitcnt vmcnt(8)
    ds_write_b128 v4, v[208:211] offset:18432
    ds_write_b128 v4, v[212:215] offset:23040
    ds_write_b128 v4, v[216:219] offset:27648
    ds_write_b128 v4, v[220:223] offset:32256
    s_waitcnt lgkmcnt(0)
    s_barrier
    ds_read_b64_tr_b16 a[208:209], v5 offset:18432
    ds_read_b64_tr_b16 a[210:211], v5 offset:19008
    ds_read_b64_tr_b16 a[212:213], v5 offset:27648
    ds_read_b64_tr_b16 a[214:215], v5 offset:28224
    ds_read_b64_tr_b16 a[216:217], v5 offset:18464
    ds_read_b64_tr_b16 a[218:219], v5 offset:19040
    ds_read_b64_tr_b16 a[220:221], v5 offset:27680
    ds_read_b64_tr_b16 a[222:223], v5 offset:28256
    s_waitcnt vmcnt(4)
    ds_write_b128 v4, v[224:227] offset:0
    ds_write_b128 v4, v[228:231] offset:4608
    ds_write_b128 v4, v[232:235] offset:9216
    ds_write_b128 v4, v[236:239] offset:13824
    s_waitcnt lgkmcnt(0)
    s_barrier
    ds_read_b64_tr_b16 a[224:225], v5 offset:0
    ds_read_b64_tr_b16 a[226:227], v5 offset:576
    ds_read_b64_tr_b16 a[228:229], v5 offset:9216
    ds_read_b64_tr_b16 a[230:231], v5 offset:9792
    ds_read_b64_tr_b16 a[232:233], v5 offset:32
    ds_read_b64_tr_b16 a[234:235], v5 offset:608
    ds_read_b64_tr_b16 a[236:237], v5 offset:9248
    ds_read_b64_tr_b16 a[238:239], v5 offset:9824
    s_waitcnt vmcnt(0)
    ds_write_b128 v4, v[240:243] offset:18432
    ds_write_b128 v4, v[244:247] offset:23040
    ds_write_b128 v4, v[248:251] offset:27648
    ds_write_b128 v4, v[252:255] offset:32256
    s_waitcnt lgkmcnt(0)
    s_barrier
    ds_read_b64_tr_b16 a[240:241], v5 offset:18432
    ds_read_b64_tr_b16 a[242:243], v5 offset:19008
    ds_read_b64_tr_b16 a[244:245], v5 offset:27648
    ds_read_b64_tr_b16 a[246:247], v5 offset:28224
    ds_read_b64_tr_b16 a[248:249], v5 offset:18464
    ds_read_b64_tr_b16 a[250:251], v5 offset:19040
    ds_read_b64_tr_b16 a[252:253], v5 offset:27680
    ds_read_b64_tr_b16 a[254:255], v5 offset:28256
    s_waitcnt lgkmcnt(0)
    s_barrier
    v_and_b32 v12, 7, v1
    s_lshl_b32 s32, s5, 10
    s_lshl_b32 s58, s5, 10
    s_add_u32 s58, s58, 114688
    v_lshlrev_b32 v6, 7, v12
    v_mov_b32 v13, 2147418112
    v_cmp_gt_u32 vcc, 8, v1
    s_nop 1
    v_cndmask_b32 v6, v13, v6, vcc
    v_mov_b32 v7, 0x4444
    v_mov_b32 v15, 0xeeee
    v_and_b32 v16, 2, v1
    v_cmp_eq_u32 vcc, 2, v16
    s_nop 1
    v_cndmask_b32 v7, v7, v15, vcc
    v_and_b32 v13, 15, v1
    v_lshrrev_b32 v14, 4, v1
    v_lshl_add_u32 v8, v13, 2, s32
    v_lshl_add_u32 v8, v14, 8, v8
    v_and_b32 v13, 31, v1
    s_lshl_b32 s33, s5, 8
    v_lshl_add_u32 v9, v13, 3, s33
    v_lshrrev_b32 v14, 4, v13
    v_lshl_add_u32 v14, s5, 1, v14
    v_mul_u32_u24 v10, 2560, v14
    v_and_b32 v13, 15, v1
    v_lshl_add_u32 v10, v13, 2, v10
    v_mov_b32 v13, 2147418112
    v_cmp_gt_u32 vcc, 32, v1
    s_nop 1
    v_cndmask_b32 v10, v13, v10, vcc
    s_mul_i32 s57, s49, 20480
    s_lshl_b32 s32, s50, 6
    s_add_u32 s57, s57, s32
    s_lshl_b32 s55, s49, 17
    s_lshl_b32 s32, s5, 15
    s_add_u32 s55, s55, s32
    s_add_u32 s55, s55, 104857600
    s_mov_b32 s51, 0
    s_mov_b32 s53, 0
    s_mov_b32 s54, 0
    s_mov_b32 s30, 131072
    v_mov_b32 v12, 16
Lpol_24:
    global_load_dword v13, v12, s[6:7] sc1
    s_sub_u32 s30, s30, 1
    s_cbranch_scc1 L_abort
    s_waitcnt vmcnt(0)
    v_readfirstlane_b32 s53, v13
    s_nop 0
    s_cmp_lg_u32 s53, 0
    s_cbranch_scc1 Lpol_24_ok
    s_sleep 4
    s_branch Lpol_24
Lpol_24_ok:
    s_and_b32 s53, s53, 2
    s_lshl_b32 s53, s53, 12
    s_add_u32 s55, s55, s53
    s_add_u32 s58, s58, s53
    v_mov_b64 v[24:25], 0
    v_mov_b64 v[26:27], 0
    v_mov_b64 v[28:29], 0
    v_mov_b64 v[30:31], 0
    s_mov_b32 s52, 1
    s_mov_b32 s30, 131072
L_op_first:
    buffer_load_dword v12, v6, s[8:11], s58 offen sc1
    s_sub_u32 s30, s30, 1
    s_cbranch_scc1 L_abort
    s_waitcnt vmcnt(0)
    v_cmp_gt_u32 vcc, s52, v12
    s_nop 0
    s_and_b32 s32, vcc_lo, 0xff
    s_cbranch_scc1 L_op_first
    s_xor_b32 s58, s58, 4096
    buffer_load_dword v13, v6, s[8:11], s58 offen sc1
    s_add_u32 s56, s55, 0
    buffer_load_dwordx4 v[64:67], v2, s[8:11], s56 offen offset:0 sc1
    s_nop 0
    buffer_load_dwordx4 v[68:71], v2, s[8:11], s56 offen offset:1024 sc1
    s_nop 0
    buffer_load_dwordx4 v[72:75], v2, s[8:11], s56 offen offset:2048 sc1
    s_nop 0
    buffer_load_dwordx4 v[76:79], v2, s[8:11], s56 offen offset:3072 sc1
    s_add_u32 s56, s55, 4096
    buffer_load_dwordx4 v[80:83], v2, s[8:11], s56 offen offset:0 sc1
    s_nop 0
    buffer_load_dwordx4 v[84:87], v2, s[8:11], s56 offen offset:1024 sc1
    s_nop 0
    buffer_load_dwordx4 v[88:91], v2, s[8:11], s56 offen offset:2048 sc1
    s_nop 0
    buffer_load_dwordx4 v[92:95], v2, s[8:11], s56 offen offset:3072 sc1
    s_add_u32 s56, s55, 16384
    buffer_load_dwordx4 v[96:99], v2, s[8:11], s56 offen offset:0 sc1
    s_nop 0
    buffer_load_dwordx4 v[100:103], v2, s[8:11], s56 offen offset:1024 sc1
    s_nop 0
    buffer_load_dwordx4 v[104:107], v2, s[8:11], s56 offen offset:2048 sc1
    s_nop 0
    buffer_load_dwordx4 v[108:111], v2, s[8:11], s56 offen offset:3072 sc1
    s_add_u32 s56, s55, 20480
    buffer_load_dwordx4 v[112:115], v2, s[8:11], s56 offen offset:0 sc1
    s_nop 0
    buffer_load_dwordx4 v[116:119], v2, s[8:11], s56 offen offset:1024 sc1
    s_nop 0
    buffer_load_dwordx4 v[120:123], v2, s[8:11], s56 offen offset:2048 sc1
    s_nop 0
    buffer_load_dwordx4 v[124:127], v2, s[8:11], s56 offen offset:3072 sc1
    s_add_u32 s55, s55, 524288
    s_and_b32 s32, s55, 1572864
    s_cselect_b32 s32, 0, 8192
    s_xor_b32 s55, s55, s32
L_op_0:
    s_add_u32 s51, s51, 1
    s_lshr_b32 s52, s51, 1
    s_add_u32 s52, s52, 1
    s_waitcnt vmcnt(16)
    v_cmp_gt_u32 vcc, s52, v13
    s_nop 0
    s_and_b32 s32, vcc_lo, 0xff
    s_cbranch_scc0 L_op_early_0
L_op_late_0:
    s_waitcnt vmcnt(15)
    v_smfmac_f32_16x16x64_bf16 v[24:27], v[64:67], a[0:7], v7
    v_smfmac_f32_16x16x64_bf16 v[28:31], v[64:67], a[8:15], v7
    s_waitcnt vmcnt(14)
    v_smfmac_f32_16x16x64_bf16 v[24:27], v[68:71], a[16:23], v7
    v_smfmac_f32_16x16x64_bf16 v[28:31], v[68:71], a[24:31], v7
    s_waitcnt vmcnt(13)
    v_smfmac_f32_16x16x64_bf16 v[24:27], v[72:75], a[32:39], v7
    v_smfmac_f32_16x16x64_bf16 v[28:31], v[72:75], a[40:47], v7
    s_waitcnt vmcnt(12)
    v_smfmac_f32_16x16x64_bf16 v[24:27], v[76:79], a[48:55], v7
    v_smfmac_f32_16x16x64_bf16 v[28:31], v[76:79], a[56:63], v7
    s_waitcnt vmcnt(11)
    v_smfmac_f32_16x16x64_bf16 v[24:27], v[80:83], a[64:71], v7
    v_smfmac_f32_16x16x64_bf16 v[28:31], v[80:83], a[72:79], v7
    s_waitcnt vmcnt(10)
    v_smfmac_f32_16x16x64_bf16 v[24:27], v[84:87], a[80:87], v7
    v_smfmac_f32_16x16x64_bf16 v[28:31], v[84:87], a[88:95], v7
    s_waitcnt vmcnt(9)
    v_smfmac_f32_16x16x64_bf16 v[24:27], v[88:91], a[96:103], v7
    v_smfmac_f32_16x16x64_bf16 v[28:31], v[88:91], a[104:111], v7
    s_waitcnt vmcnt(8)
    v_smfmac_f32_16x16x64_bf16 v[24:27], v[92:95], a[112:119], v7
    v_smfmac_f32_16x16x64_bf16 v[28:31], v[92:95], a[120:127], v7
    s_waitcnt vmcnt(7)
    v_smfmac_f32_16x16x64_bf16 v[24:27], v[96:99], a[128:135], v7
    v_smfmac_f32_16x16x64_bf16 v[28:31], v[96:99], a[136:143], v7
    s_waitcnt vmcnt(6)
    v_smfmac_f32_16x16x64_bf16 v[24:27], v[100:103], a[144:151], v7
    v_smfmac_f32_16x16x64_bf16 v[28:31], v[100:103], a[152:159], v7
    s_waitcnt vmcnt(5)
    v_smfmac_f32_16x16x64_bf16 v[24:27], v[104:107], a[160:167], v7
    v_smfmac_f32_16x16x64_bf16 v[28:31], v[104:107], a[168:175], v7
    s_waitcnt vmcnt(4)
    v_smfmac_f32_16x16x64_bf16 v[24:27], v[108:111], a[176:183], v7
    v_smfmac_f32_16x16x64_bf16 v[28:31], v[108:111], a[184:191], v7
    s_waitcnt vmcnt(3)
    v_smfmac_f32_16x16x64_bf16 v[24:27], v[112:115], a[192:199], v7
    v_smfmac_f32_16x16x64_bf16 v[28:31], v[112:115], a[200:207], v7
    s_waitcnt vmcnt(2)
    v_smfmac_f32_16x16x64_bf16 v[24:27], v[116:119], a[208:215], v7
    v_smfmac_f32_16x16x64_bf16 v[28:31], v[116:119], a[216:223], v7
    s_waitcnt vmcnt(1)
    v_smfmac_f32_16x16x64_bf16 v[24:27], v[120:123], a[224:231], v7
    v_smfmac_f32_16x16x64_bf16 v[28:31], v[120:123], a[232:239], v7
    s_waitcnt vmcnt(0)
    v_smfmac_f32_16x16x64_bf16 v[24:27], v[124:127], a[240:247], v7
    v_smfmac_f32_16x16x64_bf16 v[28:31], v[124:127], a[248:255], v7
    s_nop 3
    v_add_f32 v24, v24, v26
    v_add_f32 v25, v25, v27
    s_nop 1
    v_add_f32 v28, v28, v30
    v_add_f32 v29, v29, v31
    ds_write2_b32 v8, v24, v25 offset0:0 offset1:32
    ds_write2_b32 v8, v28, v29 offset0:16 offset1:48
    s_waitcnt lgkmcnt(0)
    s_barrier
    ds_read_b64 v[32:33], v9 offset:0
    ds_read_b64 v[34:35], v9 offset:1024
    ds_read_b64 v[36:37], v9 offset:2048
    ds_read_b64 v[38:39], v9 offset:3072
    v_xor_b32 v8, 4096, v8
    v_xor_b32 v9, 4096, v9
    v_mov_b64 v[24:25], 0
    v_mov_b64 v[26:27], 0
    v_mov_b64 v[28:29], 0
    v_mov_b64 v[30:31], 0
    s_waitcnt lgkmcnt(0)
    v_pk_add_f32 v[32:33], v[32:33], v[34:35]
    v_pk_add_f32 v[36:37], v[36:37], v[38:39]
    v_pk_add_f32 v[32:33], v[32:33], v[36:37]
    v_cvt_pk_bf16_f32 v32, v32, v33
    buffer_store_dword v32, v10, s[16:19], s57 offen
    s_add_u32 s57, s57, 81920
    s_mov_b32 s30, 131072
L_op_poll_0:
    buffer_load_dword v12, v6, s[8:11], s58 offen sc1
    s_sub_u32 s30, s30, 1
    s_cbranch_scc1 L_abort
    s_waitcnt vmcnt(0)
    v_cmp_gt_u32 vcc, s52, v12
    s_nop 0
    s_and_b32 s32, vcc_lo, 0xff
    s_cbranch_scc1 L_op_poll_0
    s_xor_b32 s58, s58, 4096
    buffer_load_dword v13, v6, s[8:11], s58 offen sc1
    s_add_u32 s56, s55, 0
    buffer_load_dwordx4 v[128:131], v2, s[8:11], s56 offen offset:0 sc1
    s_nop 0
    buffer_load_dwordx4 v[132:135], v2, s[8:11], s56 offen offset:1024 sc1
    s_nop 0
    buffer_load_dwordx4 v[136:139], v2, s[8:11], s56 offen offset:2048 sc1
    s_nop 0
    buffer_load_dwordx4 v[140:143], v2, s[8:11], s56 offen offset:3072 sc1
    s_add_u32 s56, s55, 4096
    buffer_load_dwordx4 v[144:147], v2, s[8:11], s56 offen offset:0 sc1
    s_nop 0
    buffer_load_dwordx4 v[148:151], v2, s[8:11], s56 offen offset:1024 sc1
    s_nop 0
    buffer_load_dwordx4 v[152:155], v2, s[8:11], s56 offen offset:2048 sc1
    s_nop 0
    buffer_load_dwordx4 v[156:159], v2, s[8:11], s56 offen offset:3072 sc1
    s_add_u32 s56, s55, 16384
    buffer_load_dwordx4 v[160:163], v2, s[8:11], s56 offen offset:0 sc1
    s_nop 0
    buffer_load_dwordx4 v[164:167], v2, s[8:11], s56 offen offset:1024 sc1
    s_nop 0
    buffer_load_dwordx4 v[168:171], v2, s[8:11], s56 offen offset:2048 sc1
    s_nop 0
    buffer_load_dwordx4 v[172:175], v2, s[8:11], s56 offen offset:3072 sc1
    s_add_u32 s56, s55, 20480
    buffer_load_dwordx4 v[176:179], v2, s[8:11], s56 offen offset:0 sc1
    s_nop 0
    buffer_load_dwordx4 v[180:183], v2, s[8:11], s56 offen offset:1024 sc1
    s_nop 0
    buffer_load_dwordx4 v[184:187], v2, s[8:11], s56 offen offset:2048 sc1
    s_nop 0
    buffer_load_dwordx4 v[188:191], v2, s[8:11], s56 offen offset:3072 sc1
    s_add_u32 s55, s55, 524288
    s_and_b32 s32, s55, 1572864
    s_cselect_b32 s32, 0, 8192
    s_xor_b32 s55, s55, s32
    s_branch L_op_1
L_op_early_0:
    s_xor_b32 s58, s58, 4096
    buffer_load_dword v13, v6, s[8:11], s58 offen sc1
    s_add_u32 s56, s55, 0
    buffer_load_dwordx4 v[128:131], v2, s[8:11], s56 offen offset:0 sc1
    s_nop 0
    buffer_load_dwordx4 v[132:135], v2, s[8:11], s56 offen offset:1024 sc1
    s_nop 0
    buffer_load_dwordx4 v[136:139], v2, s[8:11], s56 offen offset:2048 sc1
    s_nop 0
    buffer_load_dwordx4 v[140:143], v2, s[8:11], s56 offen offset:3072 sc1
    s_add_u32 s56, s55, 4096
    buffer_load_dwordx4 v[144:147], v2, s[8:11], s56 offen offset:0 sc1
    s_nop 0
    buffer_load_dwordx4 v[148:151], v2, s[8:11], s56 offen offset:1024 sc1
    s_nop 0
    buffer_load_dwordx4 v[152:155], v2, s[8:11], s56 offen offset:2048 sc1
    s_nop 0
    buffer_load_dwordx4 v[156:159], v2, s[8:11], s56 offen offset:3072 sc1
    s_add_u32 s56, s55, 16384
    buffer_load_dwordx4 v[160:163], v2, s[8:11], s56 offen offset:0 sc1
    s_nop 0
    buffer_load_dwordx4 v[164:167], v2, s[8:11], s56 offen offset:1024 sc1
    s_nop 0
    buffer_load_dwordx4 v[168:171], v2, s[8:11], s56 offen offset:2048 sc1
    s_nop 0
    buffer_load_dwordx4 v[172:175], v2, s[8:11], s56 offen offset:3072 sc1
    s_add_u32 s56, s55, 20480
    buffer_load_dwordx4 v[176:179], v2, s[8:11], s56 offen offset:0 sc1
    s_nop 0
    buffer_load_dwordx4 v[180:183], v2, s[8:11], s56 offen offset:1024 sc1
    s_nop 0
    buffer_load_dwordx4 v[184:187], v2, s[8:11], s56 offen offset:2048 sc1
    s_nop 0
    buffer_load_dwordx4 v[188:191], v2, s[8:11], s56 offen offset:3072 sc1
    s_add_u32 s55, s55, 524288
    s_and_b32 s32, s55, 1572864
    s_cselect_b32 s32, 0, 8192
    s_xor_b32 s55, s55, s32
    s_waitcnt vmcnt(32)
    v_smfmac_f32_16x16x64_bf16 v[24:27], v[64:67], a[0:7], v7
    v_smfmac_f32_16x16x64_bf16 v[28:31], v[64:67], a[8:15], v7
    s_waitcnt vmcnt(31)
    v_smfmac_f32_16x16x64_bf16 v[24:27], v[68:71], a[16:23], v7
    v_smfmac_f32_16x16x64_bf16 v[28:31], v[68:71], a[24:31], v7
    s_waitcnt vmcnt(30)
    v_smfmac_f32_16x16x64_bf16 v[24:27], v[72:75], a[32:39], v7
    v_smfmac_f32_16x16x64_bf16 v[28:31], v[72:75], a[40:47], v7
    s_waitcnt vmcnt(29)
    v_smfmac_f32_16x16x64_bf16 v[24:27], v[76:79], a[48:55], v7
    v_smfmac_f32_16x16x64_bf16 v[28:31], v[76:79], a[56:63], v7
    s_waitcnt vmcnt(28)
    v_smfmac_f32_16x16x64_bf16 v[24:27], v[80:83], a[64:71], v7
    v_smfmac_f32_16x16x64_bf16 v[28:31], v[80:83], a[72:79], v7
    s_waitcnt vmcnt(27)
    v_smfmac_f32_16x16x64_bf16 v[24:27], v[84:87], a[80:87], v7
    v_smfmac_f32_16x16x64_bf16 v[28:31], v[84:87], a[88:95], v7
    s_waitcnt vmcnt(26)
    v_smfmac_f32_16x16x64_bf16 v[24:27], v[88:91], a[96:103], v7
    v_smfmac_f32_16x16x64_bf16 v[28:31], v[88:91], a[104:111], v7
    s_waitcnt vmcnt(25)
    v_smfmac_f32_16x16x64_bf16 v[24:27], v[92:95], a[112:119], v7
    v_smfmac_f32_16x16x64_bf16 v[28:31], v[92:95], a[120:127], v7
    s_waitcnt vmcnt(24)
    v_smfmac_f32_16x16x64_bf16 v[24:27], v[96:99], a[128:135], v7
    v_smfmac_f32_16x16x64_bf16 v[28:31], v[96:99], a[136:143], v7
    s_waitcnt vmcnt(23)
    v_smfmac_f32_16x16x64_bf16 v[24:27], v[100:103], a[144:151], v7
    v_smfmac_f32_16x16x64_bf16 v[28:31], v[100:103], a[152:159], v7
    s_waitcnt vmcnt(22)
    v_smfmac_f32_16x16x64_bf16 v[24:27], v[104:107], a[160:167], v7
    v_smfmac_f32_16x16x64_bf16 v[28:31], v[104:107], a[168:175], v7
    s_waitcnt vmcnt(21)
    v_smfmac_f32_16x16x64_bf16 v[24:27], v[108:111], a[176:183], v7
    v_smfmac_f32_16x16x64_bf16 v[28:31], v[108:111], a[184:191], v7
    s_waitcnt vmcnt(20)
    v_smfmac_f32_16x16x64_bf16 v[24:27], v[112:115], a[192:199], v7
    v_smfmac_f32_16x16x64_bf16 v[28:31], v[112:115], a[200:207], v7
    s_waitcnt vmcnt(19)
    v_smfmac_f32_16x16x64_bf16 v[24:27], v[116:119], a[208:215], v7
    v_smfmac_f32_16x16x64_bf16 v[28:31], v[116:119], a[216:223], v7
    s_waitcnt vmcnt(18)
    v_smfmac_f32_16x16x64_bf16 v[24:27], v[120:123], a[224:231], v7
    v_smfmac_f32_16x16x64_bf16 v[28:31], v[120:123], a[232:239], v7
    s_waitcnt vmcnt(17)
    v_smfmac_f32_16x16x64_bf16 v[24:27], v[124:127], a[240:247], v7
    v_smfmac_f32_16x16x64_bf16 v[28:31], v[124:127], a[248:255], v7
    s_nop 3
    v_add_f32 v24, v24, v26
    v_add_f32 v25, v25, v27
    s_nop 1
    v_add_f32 v28, v28, v30
    v_add_f32 v29, v29, v31
    ds_write2_b32 v8, v24, v25 offset0:0 offset1:32
    ds_write2_b32 v8, v28, v29 offset0:16 offset1:48
    s_waitcnt lgkmcnt(0)
    s_barrier
    ds_read_b64 v[32:33], v9 offset:0
    ds_read_b64 v[34:35], v9 offset:1024
    ds_read_b64 v[36:37], v9 offset:2048
    ds_read_b64 v[38:39], v9 offset:3072
    v_xor_b32 v8, 4096, v8
    v_xor_b32 v9, 4096, v9
    v_mov_b64 v[24:25], 0
    v_mov_b64 v[26:27], 0
    v_mov_b64 v[28:29], 0
    v_mov_b64 v[30:31], 0
    s_waitcnt lgkmcnt(0)
    v_pk_add_f32 v[32:33], v[32:33], v[34:35]
    v_pk_add_f32 v[36:37], v[36:37], v[38:39]
    v_pk_add_f32 v[32:33], v[32:33], v[36:37]
    v_cvt_pk_bf16_f32 v32, v32, v33
    buffer_store_dword v32, v10, s[16:19], s57 offen
    s_add_u32 s57, s57, 81920
L_op_1:
    s_add_u32 s51, s51, 1
    s_lshr_b32 s52, s51, 1
    s_add_u32 s52, s52, 1
    s_cmp_eq_u32 s51, 64
    s_cbranch_scc1 L_op_late_1
    s_waitcnt vmcnt(16)
    v_cmp_gt_u32 vcc, s52, v13
    s_nop 0
    s_and_b32 s32, vcc_lo, 0xff
    s_cbranch_scc0 L_op_early_1
L_op_late_1:
    s_waitcnt vmcnt(15)
    v_smfmac_f32_16x16x64_bf16 v[24:27], v[128:131], a[0:7], v7
    v_smfmac_f32_16x16x64_bf16 v[28:31], v[128:131], a[8:15], v7
    s_waitcnt vmcnt(14)
    v_smfmac_f32_16x16x64_bf16 v[24:27], v[132:135], a[16:23], v7
    v_smfmac_f32_16x16x64_bf16 v[28:31], v[132:135], a[24:31], v7
    s_waitcnt vmcnt(13)
    v_smfmac_f32_16x16x64_bf16 v[24:27], v[136:139], a[32:39], v7
    v_smfmac_f32_16x16x64_bf16 v[28:31], v[136:139], a[40:47], v7
    s_waitcnt vmcnt(12)
    v_smfmac_f32_16x16x64_bf16 v[24:27], v[140:143], a[48:55], v7
    v_smfmac_f32_16x16x64_bf16 v[28:31], v[140:143], a[56:63], v7
    s_waitcnt vmcnt(11)
    v_smfmac_f32_16x16x64_bf16 v[24:27], v[144:147], a[64:71], v7
    v_smfmac_f32_16x16x64_bf16 v[28:31], v[144:147], a[72:79], v7
    s_waitcnt vmcnt(10)
    v_smfmac_f32_16x16x64_bf16 v[24:27], v[148:151], a[80:87], v7
    v_smfmac_f32_16x16x64_bf16 v[28:31], v[148:151], a[88:95], v7
    s_waitcnt vmcnt(9)
    v_smfmac_f32_16x16x64_bf16 v[24:27], v[152:155], a[96:103], v7
    v_smfmac_f32_16x16x64_bf16 v[28:31], v[152:155], a[104:111], v7
    s_waitcnt vmcnt(8)
    v_smfmac_f32_16x16x64_bf16 v[24:27], v[156:159], a[112:119], v7
    v_smfmac_f32_16x16x64_bf16 v[28:31], v[156:159], a[120:127], v7
    s_waitcnt vmcnt(7)
    v_smfmac_f32_16x16x64_bf16 v[24:27], v[160:163], a[128:135], v7
    v_smfmac_f32_16x16x64_bf16 v[28:31], v[160:163], a[136:143], v7
    s_waitcnt vmcnt(6)
    v_smfmac_f32_16x16x64_bf16 v[24:27], v[164:167], a[144:151], v7
    v_smfmac_f32_16x16x64_bf16 v[28:31], v[164:167], a[152:159], v7
    s_waitcnt vmcnt(5)
    v_smfmac_f32_16x16x64_bf16 v[24:27], v[168:171], a[160:167], v7
    v_smfmac_f32_16x16x64_bf16 v[28:31], v[168:171], a[168:175], v7
    s_waitcnt vmcnt(4)
    v_smfmac_f32_16x16x64_bf16 v[24:27], v[172:175], a[176:183], v7
    v_smfmac_f32_16x16x64_bf16 v[28:31], v[172:175], a[184:191], v7
    s_waitcnt vmcnt(3)
    v_smfmac_f32_16x16x64_bf16 v[24:27], v[176:179], a[192:199], v7
    v_smfmac_f32_16x16x64_bf16 v[28:31], v[176:179], a[200:207], v7
    s_waitcnt vmcnt(2)
    v_smfmac_f32_16x16x64_bf16 v[24:27], v[180:183], a[208:215], v7
    v_smfmac_f32_16x16x64_bf16 v[28:31], v[180:183], a[216:223], v7
    s_waitcnt vmcnt(1)
    v_smfmac_f32_16x16x64_bf16 v[24:27], v[184:187], a[224:231], v7
    v_smfmac_f32_16x16x64_bf16 v[28:31], v[184:187], a[232:239], v7
    s_waitcnt vmcnt(0)
    v_smfmac_f32_16x16x64_bf16 v[24:27], v[188:191], a[240:247], v7
    v_smfmac_f32_16x16x64_bf16 v[28:31], v[188:191], a[248:255], v7
    s_nop 3
    v_add_f32 v24, v24, v26
    v_add_f32 v25, v25, v27
    s_nop 1
    v_add_f32 v28, v28, v30
    v_add_f32 v29, v29, v31
    ds_write2_b32 v8, v24, v25 offset0:0 offset1:32
    ds_write2_b32 v8, v28, v29 offset0:16 offset1:48
    s_waitcnt lgkmcnt(0)
    s_barrier
    ds_read_b64 v[32:33], v9 offset:0
    ds_read_b64 v[34:35], v9 offset:1024
    ds_read_b64 v[36:37], v9 offset:2048
    ds_read_b64 v[38:39], v9 offset:3072
    v_xor_b32 v8, 4096, v8
    v_xor_b32 v9, 4096, v9
    v_mov_b64 v[24:25], 0
    v_mov_b64 v[26:27], 0
    v_mov_b64 v[28:29], 0
    v_mov_b64 v[30:31], 0
    s_waitcnt lgkmcnt(0)
    v_pk_add_f32 v[32:33], v[32:33], v[34:35]
    v_pk_add_f32 v[36:37], v[36:37], v[38:39]
    v_pk_add_f32 v[32:33], v[32:33], v[36:37]
    v_cvt_pk_bf16_f32 v32, v32, v33
    buffer_store_dword v32, v10, s[16:19], s57 offen
    s_add_u32 s57, s57, 81920
    s_cmp_eq_u32 s51, 64
    s_cbranch_scc1 L_op_done
    s_mov_b32 s30, 131072
L_op_poll_1:
    buffer_load_dword v12, v6, s[8:11], s58 offen sc1
    s_sub_u32 s30, s30, 1
    s_cbranch_scc1 L_abort
    s_waitcnt vmcnt(0)
    v_cmp_gt_u32 vcc, s52, v12
    s_nop 0
    s_and_b32 s32, vcc_lo, 0xff
    s_cbranch_scc1 L_op_poll_1
    s_xor_b32 s58, s58, 4096
    buffer_load_dword v13, v6, s[8:11], s58 offen sc1
    s_add_u32 s56, s55, 0
    buffer_load_dwordx4 v[64:67], v2, s[8:11], s56 offen offset:0 sc1
    s_nop 0
    buffer_load_dwordx4 v[68:71], v2, s[8:11], s56 offen offset:1024 sc1
    s_nop 0
    buffer_load_dwordx4 v[72:75], v2, s[8:11], s56 offen offset:2048 sc1
    s_nop 0
    buffer_load_dwordx4 v[76:79], v2, s[8:11], s56 offen offset:3072 sc1
    s_add_u32 s56, s55, 4096
    buffer_load_dwordx4 v[80:83], v2, s[8:11], s56 offen offset:0 sc1
    s_nop 0
    buffer_load_dwordx4 v[84:87], v2, s[8:11], s56 offen offset:1024 sc1
    s_nop 0
    buffer_load_dwordx4 v[88:91], v2, s[8:11], s56 offen offset:2048 sc1
    s_nop 0
    buffer_load_dwordx4 v[92:95], v2, s[8:11], s56 offen offset:3072 sc1
    s_add_u32 s56, s55, 16384
    buffer_load_dwordx4 v[96:99], v2, s[8:11], s56 offen offset:0 sc1
    s_nop 0
    buffer_load_dwordx4 v[100:103], v2, s[8:11], s56 offen offset:1024 sc1
    s_nop 0
    buffer_load_dwordx4 v[104:107], v2, s[8:11], s56 offen offset:2048 sc1
    s_nop 0
    buffer_load_dwordx4 v[108:111], v2, s[8:11], s56 offen offset:3072 sc1
    s_add_u32 s56, s55, 20480
    buffer_load_dwordx4 v[112:115], v2, s[8:11], s56 offen offset:0 sc1
    s_nop 0
    buffer_load_dwordx4 v[116:119], v2, s[8:11], s56 offen offset:1024 sc1
    s_nop 0
    buffer_load_dwordx4 v[120:123], v2, s[8:11], s56 offen offset:2048 sc1
    s_nop 0
    buffer_load_dwordx4 v[124:127], v2, s[8:11], s56 offen offset:3072 sc1
    s_add_u32 s55, s55, 524288
    s_and_b32 s32, s55, 1572864
    s_cselect_b32 s32, 0, 8192
    s_xor_b32 s55, s55, s32
    s_branch L_op_0
L_op_early_1:
    s_xor_b32 s58, s58, 4096
    buffer_load_dword v13, v6, s[8:11], s58 offen sc1
    s_add_u32 s56, s55, 0
    buffer_load_dwordx4 v[64:67], v2, s[8:11], s56 offen offset:0 sc1
    s_nop 0
    buffer_load_dwordx4 v[68:71], v2, s[8:11], s56 offen offset:1024 sc1
    s_nop 0
    buffer_load_dwordx4 v[72:75], v2, s[8:11], s56 offen offset:2048 sc1
    s_nop 0
    buffer_load_dwordx4 v[76:79], v2, s[8:11], s56 offen offset:3072 sc1
    s_add_u32 s56, s55, 4096
    buffer_load_dwordx4 v[80:83], v2, s[8:11], s56 offen offset:0 sc1
    s_nop 0
    buffer_load_dwordx4 v[84:87], v2, s[8:11], s56 offen offset:1024 sc1
    s_nop 0
    buffer_load_dwordx4 v[88:91], v2, s[8:11], s56 offen offset:2048 sc1
    s_nop 0
    buffer_load_dwordx4 v[92:95], v2, s[8:11], s56 offen offset:3072 sc1
    s_add_u32 s56, s55, 16384
    buffer_load_dwordx4 v[96:99], v2, s[8:11], s56 offen offset:0 sc1
    s_nop 0
    buffer_load_dwordx4 v[100:103], v2, s[8:11], s56 offen offset:1024 sc1
    s_nop 0
    buffer_load_dwordx4 v[104:107], v2, s[8:11], s56 offen offset:2048 sc1
    s_nop 0
    buffer_load_dwordx4 v[108:111], v2, s[8:11], s56 offen offset:3072 sc1
    s_add_u32 s56, s55, 20480
    buffer_load_dwordx4 v[112:115], v2, s[8:11], s56 offen offset:0 sc1
    s_nop 0
    buffer_load_dwordx4 v[116:119], v2, s[8:11], s56 offen offset:1024 sc1
    s_nop 0
    buffer_load_dwordx4 v[120:123], v2, s[8:11], s56 offen offset:2048 sc1
    s_nop 0
    buffer_load_dwordx4 v[124:127], v2, s[8:11], s56 offen offset:3072 sc1
    s_add_u32 s55, s55, 524288
    s_and_b32 s32, s55, 1572864
    s_cselect_b32 s32, 0, 8192
    s_xor_b32 s55, s55, s32
    s_waitcnt vmcnt(32)
    v_smfmac_f32_16x16x64_bf16 v[24:27], v[128:131], a[0:7], v7
    v_smfmac_f32_16x16x64_bf16 v[28:31], v[128:131], a[8:15], v7
    s_waitcnt vmcnt(31)
    v_smfmac_f32_16x16x64_bf16 v[24:27], v[132:135], a[16:23], v7
    v_smfmac_f32_16x16x64_bf16 v[28:31], v[132:135], a[24:31], v7
    s_waitcnt vmcnt(30)
    v_smfmac_f32_16x16x64_bf16 v[24:27], v[136:139], a[32:39], v7
    v_smfmac_f32_16x16x64_bf16 v[28:31], v[136:139], a[40:47], v7
    s_waitcnt vmcnt(29)
    v_smfmac_f32_16x16x64_bf16 v[24:27], v[140:143], a[48:55], v7
    v_smfmac_f32_16x16x64_bf16 v[28:31], v[140:143], a[56:63], v7
    s_waitcnt vmcnt(28)
    v_smfmac_f32_16x16x64_bf16 v[24:27], v[144:147], a[64:71], v7
    v_smfmac_f32_16x16x64_bf16 v[28:31], v[144:147], a[72:79], v7
    s_waitcnt vmcnt(27)
    v_smfmac_f32_16x16x64_bf16 v[24:27], v[148:151], a[80:87], v7
    v_smfmac_f32_16x16x64_bf16 v[28:31], v[148:151], a[88:95], v7
    s_waitcnt vmcnt(26)
    v_smfmac_f32_16x16x64_bf16 v[24:27], v[152:155], a[96:103], v7
    v_smfmac_f32_16x16x64_bf16 v[28:31], v[152:155], a[104:111], v7
    s_waitcnt vmcnt(25)
    v_smfmac_f32_16x16x64_bf16 v[24:27], v[156:159], a[112:119], v7
    v_smfmac_f32_16x16x64_bf16 v[28:31], v[156:159], a[120:127], v7
    s_waitcnt vmcnt(24)
    v_smfmac_f32_16x16x64_bf16 v[24:27], v[160:163], a[128:135], v7
    v_smfmac_f32_16x16x64_bf16 v[28:31], v[160:163], a[136:143], v7
    s_waitcnt vmcnt(23)
    v_smfmac_f32_16x16x64_bf16 v[24:27], v[164:167], a[144:151], v7
    v_smfmac_f32_16x16x64_bf16 v[28:31], v[164:167], a[152:159], v7
    s_waitcnt vmcnt(22)
    v_smfmac_f32_16x16x64_bf16 v[24:27], v[168:171], a[160:167], v7
    v_smfmac_f32_16x16x64_bf16 v[28:31], v[168:171], a[168:175], v7
    s_waitcnt vmcnt(21)
    v_smfmac_f32_16x16x64_bf16 v[24:27], v[172:175], a[176:183], v7
    v_smfmac_f32_16x16x64_bf16 v[28:31], v[172:175], a[184:191], v7
    s_waitcnt vmcnt(20)
    v_smfmac_f32_16x16x64_bf16 v[24:27], v[176:179], a[192:199], v7
    v_smfmac_f32_16x16x64_bf16 v[28:31], v[176:179], a[200:207], v7
    s_waitcnt vmcnt(19)
    v_smfmac_f32_16x16x64_bf16 v[24:27], v[180:183], a[208:215], v7
    v_smfmac_f32_16x16x64_bf16 v[28:31], v[180:183], a[216:223], v7
    s_waitcnt vmcnt(18)
    v_smfmac_f32_16x16x64_bf16 v[24:27], v[184:187], a[224:231], v7
    v_smfmac_f32_16x16x64_bf16 v[28:31], v[184:187], a[232:239], v7
    s_waitcnt vmcnt(17)
    v_smfmac_f32_16x16x64_bf16 v[24:27], v[188:191], a[240:247], v7
    v_smfmac_f32_16x16x64_bf16 v[28:31], v[188:191], a[248:255], v7
    s_nop 3
    v_add_f32 v24, v24, v26
    v_add_f32 v25, v25, v27
    s_nop 1
    v_add_f32 v28, v28, v30
    v_add_f32 v29, v29, v31
    ds_write2_b32 v8, v24, v25 offset0:0 offset1:32
    ds_write2_b32 v8, v28, v29 offset0:16 offset1:48
    s_waitcnt lgkmcnt(0)
    s_barrier
    ds_read_b64 v[32:33], v9 offset:0
    ds_read_b64 v[34:35], v9 offset:1024
    ds_read_b64 v[36:37], v9 offset:2048
    ds_read_b64 v[38:39], v9 offset:3072
    v_xor_b32 v8, 4096, v8
    v_xor_b32 v9, 4096, v9
    v_mov_b64 v[24:25], 0
    v_mov_b64 v[26:27], 0
    v_mov_b64 v[28:29], 0
    v_mov_b64 v[30:31], 0
    s_waitcnt lgkmcnt(0)
    v_pk_add_f32 v[32:33], v[32:33], v[34:35]
    v_pk_add_f32 v[36:37], v[36:37], v[38:39]
    v_pk_add_f32 v[32:33], v[32:33], v[36:37]
    v_cvt_pk_bf16_f32 v32, v32, v33
    buffer_store_dword v32, v10, s[16:19], s57 offen
    s_add_u32 s57, s57, 81920
    s_branch L_op_0
L_op_done:
    s_endpgm
L_code_end:
    s_endpgm
.section .rodata,"a"
.p2align 6
.amdhsa_kernel concat_heads__memory_aug_recurrent_mem_tr__ssm_conv_s4__prompt_kernel
  .amdhsa_next_free_vgpr 512
  .amdhsa_next_free_sgpr 102
  .amdhsa_accum_offset 256
  .amdhsa_group_segment_fixed_size 0
  .amdhsa_kernarg_size 152
  .amdhsa_user_sgpr_count 2
  .amdhsa_user_sgpr_kernarg_segment_ptr 1
  .amdhsa_system_sgpr_workgroup_id_x 1
  .amdhsa_float_denorm_mode_32 3
.end_amdhsa_kernel
```
